```python
import torch

def _softmax(x, axis=-1):
    return torch.softmax(x, dim=axis)

def _gelu(x):
    return torch.nn.functional.gelu(x, approximate='tanh')

def _silu(x):
    return torch.nn.functional.silu(x)

def _sigmoid(x):
    return torch.sigmoid(x)

def _layernorm(x, axis=-1, eps=1e-05):
    m = x.mean(dim=axis, keepdim=True)
    v = x.var(dim=axis, keepdim=True, unbiased=False)
    return (x - m) / torch.sqrt(v + eps)

def _scatter_add(tgt, idx, src, axis=0):
    return tgt.clone().index_add_(axis, idx, src)

def _segment_sum(src, seg, n):
    out = torch.zeros((n,) + src.shape[1:], dtype=src.dtype)
    return out.index_add_(0, seg, src)

def _pad(x, pw):
    flat = tuple((v for pair in reversed(pw) for v in pair))
    return torch.nn.functional.pad(x, flat)
kernel_name = 'recurrent_scan__memory_aug_recurrent_mem_tr__dense_activation_squared_relu__prompt'

def setup_inputs():

    _w = lambda a: (lambda t: t.to(torch.bfloat16) if t.is_floating_point() else t)(torch.as_tensor(a))

    def _A_setup():
        B, S, Dm = (1, 2048, 640)
        H, Dh = (32, 192)
        M, seg = (8, 32)
        seg = min(seg, S)
        S = S // seg * seg
        return {'x': _w((lambda *s: torch.randn(*s, dtype=torch.bfloat16) * 0.05)(B, S, Dm)), 'mem0': _w((lambda *s: torch.randn(*s, dtype=torch.bfloat16) * 0.05)(B, M, Dm)), 'Wq': _w((lambda *s: torch.randn(*s, dtype=torch.bfloat16) * 1.6)(Dm, H, Dh) * Dm ** (-0.5)), 'Wk': _w((lambda *s: torch.randn(*s, dtype=torch.bfloat16) * 1.6)(Dm, H, Dh) * Dm ** (-0.5)), 'Wv': _w((lambda *s: torch.randn(*s, dtype=torch.bfloat16) * 0.05)(Dm, H, Dh) * Dm ** (-0.5)), 'Wo': _w((lambda *s: torch.randn(*s, dtype=torch.bfloat16) * 0.05)(H, Dh, Dm) * (H * Dh) ** (-0.5)), 'seg_len': seg}
    _A_in = _A_setup()

    def _B_setup():
        B, S, D, F = (1, 2048, 640, 1536)
        return {'x': _w((lambda *s: torch.randn(*s, dtype=torch.bfloat16) * 0.05)(B, S, D)), 'w1': _w((lambda *s: torch.randn(*s, dtype=torch.bfloat16) * 0.05)(D, F)), 'b1': _w((lambda *s: torch.randn(*s, dtype=torch.bfloat16) * 0.4)(F)), 'w2': _w((lambda *s: torch.randn(*s, dtype=torch.bfloat16) * 0.05)(F, D)), 'b2': _w((lambda *s: torch.randn(*s, dtype=torch.bfloat16) * 1.6)(D))}
    _B_in = _B_setup()
    return {'A_x': _A_in['x'], 'A_mem0': _A_in['mem0'], 'A_Wq': _A_in['Wq'], 'A_Wk': _A_in['Wk'], 'A_Wv': _A_in['Wv'], 'A_Wo': _A_in['Wo'], 'A_seg_len': _A_in['seg_len'], 'B_x': _B_in['x'], 'B_w1': _B_in['w1'], 'B_b1': _B_in['b1'], 'B_w2': _B_in['w2'], 'B_b2': _B_in['b2']}

def reference(A_x, A_mem0, A_Wq, A_Wk, A_Wv, A_Wo, A_seg_len, B_x, B_w1, B_b1, B_w2, B_b2):

    def _A_ref(x, mem0, Wq, Wk, Wv, Wo, seg_len):
        B, S, Dm = x.shape
        H, Dh = (Wq.shape[1], Wq.shape[2])
        M = mem0.shape[1]
        scale = Dh ** (-0.5)
        n_seg = S // seg_len
        L = M + seg_len
        idx = torch.arange(L)
        mask = (idx[:, None] < M) | (idx[:, None] >= idx[None, :])
        mem = mem0
        outs = []
        for s in range(n_seg):
            xs = x[:, s * seg_len:(s + 1) * seg_len, :].clone()
            h = torch.concatenate([mem, xs], axis=1)
            q = torch.einsum('btd,dhe->bhte', h, Wq)
            k = torch.einsum('btd,dhe->bhte', h, Wk)
            v = torch.einsum('btd,dhe->bhte', h, Wv)
            scores = torch.einsum('bhqe,bhke->bhqk', q, k) * scale
            scores = torch.where(mask[None, None], scores, -1000000000.0)
            p = _softmax(scores, axis=-1)
            o = torch.einsum('bhqk,bhke->bhqe', p, v)
            o = torch.einsum('bhte,hed->btd', o, Wo)
            mem = o[:, :M, :].clone()
            outs.append(o[:, M:, :])
        return torch.concatenate(outs, axis=1)

    def _B_ref(x, w1, b1, w2, b2):
        h = torch.einsum('bsd,df->bsf', x, w1) + b1
        zero = torch.zeros_like(h)
        r = torch.where(h > zero, h, zero)
        h = r * r
        out = torch.einsum('bsf,fd->bsd', h, w2) + b2
        return out
    x = A_x
    xn = _layernorm(x, axis=-1)
    s = _A_ref(xn, A_mem0, A_Wq, A_Wk, A_Wv, A_Wo, A_seg_len)
    g = _silu(_B_ref(xn, B_w1, B_b1, B_w2, B_b2))
    return x + s * g
```

```asm
; @launch grid=(256,1,1) block=(256,1,1) lds=163840
.amdgcn_target "amdgcn-amd-amdhsa--gfx950"
.text
.globl recurrent_scan__memory_aug_recurrent_mem_tr__dense_activation_squared_relu__prompt_kernel
.p2align 8
.type recurrent_scan__memory_aug_recurrent_mem_tr__dense_activation_squared_relu__prompt_kernel,@function
recurrent_scan__memory_aug_recurrent_mem_tr__dense_activation_squared_relu__prompt_kernel:
    s_cmp_ge_u32 s2, 256
    s_cbranch_scc1 K_end
    s_and_b32 s40, s2, 7
    s_lshr_b32 s41, s2, 3
    s_load_dwordx2 s[4:5], s[0:1], 112
    s_load_dwordx2 s[8:9], s[0:1], 16
    s_load_dwordx2 s[12:13], s[0:1], 24
    s_load_dwordx2 s[16:17], s[0:1], 64
    s_load_dwordx2 s[20:21], s[0:1], 72
    s_load_dwordx2 s[24:25], s[0:1], 104
    s_load_dwordx2 s[28:29], s[0:1], 0
    s_load_dwordx2 s[32:33], s[0:1], 8
    s_load_dwordx2 s[36:37], s[0:1], 96
    s_mov_b32 s6, 0x10000000
    s_mov_b32 s7, 0x20000
    s_mov_b32 s10, 0x780000
    s_mov_b32 s11, 0x20000
    s_mov_b32 s14, 0x780000
    s_mov_b32 s15, 0x20000
    s_mov_b32 s18, 0x1e0000
    s_mov_b32 s19, 0x20000
    s_mov_b32 s22, 0xc00
    s_mov_b32 s23, 0x20000
    s_mov_b32 s26, 0x100
    s_mov_b32 s27, 0x20000
    s_mov_b32 s30, 0x280000
    s_mov_b32 s31, 0x20000
    s_mov_b32 s34, 0x2800
    s_mov_b32 s35, 0x20000
    s_mov_b32 s38, 0x280000
    s_mov_b32 s39, 0x20000
    s_waitcnt lgkmcnt(0)
    s_cmp_lt_u32 s41, 12
    s_cbranch_scc1 K_srdok
    s_load_dwordx2 s[8:9], s[0:1], 32
    s_load_dwordx2 s[12:13], s[0:1], 40
    s_load_dwordx2 s[16:17], s[0:1], 80
    s_load_dwordx2 s[20:21], s[0:1], 88
    s_mov_b32 s22, 1280
    s_waitcnt lgkmcnt(0)
K_srdok:
    v_and_b32 v1, 63, v0
    v_lshrrev_b32 v11, 6, v0
    s_nop 0
    v_readfirstlane_b32 s42, v11
    v_and_b32 v2, 15, v1
    v_lshrrev_b32 v3, 4, v1
    v_lshlrev_b32 v4, 4, v0
    v_lshlrev_b32 v5, 4, v1
    v_lshlrev_b32 v31, 2, v1
    s_mov_b32 s46, 131072
    v_mov_b32 v244, -1
    v_mov_b32 v245, -1
    v_mov_b32 v246, -1
    v_mov_b32 v247, -1
    s_mul_i32 s75, s42, 10240
    s_add_u32 s74, s75, 0
    v_mov_b32 v6, v4
    v_add_u32 v7, 4096, v4
    v_add_u32 v8, 8192, v4
    v_min_u32 v8, 10224, v8
    v_add_u32 v9, 81920, v5
    v_mov_b32 v10, v5
    s_mul_i32 s90, s42, 40960
    v_and_b32 v11, 2, v2
    v_mov_b32 v30, 0x4444
    v_mov_b32 v12, 0xeeee
    v_cmp_ne_u32 vcc, 0, v11
    s_nop 1
    v_cndmask_b32 v30, v30, v12, vcc
    s_mul_i32 s60, s40, 10240
    s_add_u32 s60, s60, 11534336
    s_mov_b32 s43, 0
    s_mov_b32 s88, 0x3dd53b95
    s_mov_b32 s89, 0x3dd53b95
    v_lshrrev_b32 v11, 2, v2
    v_lshl_add_u32 v11, v3, 3, v11
    v_lshlrev_b32 v148, 6, v11
    v_and_b32 v11, 3, v2
    v_lshl_add_u32 v148, v11, 4, v148
    v_add_u32 v148, s90, v148
    s_cmp_ge_u32 s41, 12
    s_cbranch_scc1 K_red
    s_mul_i32 s51, s41, 86
    s_lshr_b32 s53, s51, 8
    s_mul_i32 s52, s53, 3
    s_sub_u32 s45, s41, s52
    s_lshl_b32 s44, s40, 2
    s_add_u32 s44, s44, s53
    s_lshl_b32 s51, s53, 10
    v_add_u32 v168, s51, v5
    s_lshl_b32 s51, s53, 2
    s_add_u32 s51, s51, 4096
    v_add_u32 v169, s51, v5
    s_lshl_b32 s51, s40, 1
    s_add_u32 s51, s51, s45
    s_mul_i32 s65, s51, 5120
    s_add_u32 s65, s65, 16777216
    s_load_dwordx2 s[36:37], s[0:1], 80
    s_mov_b32 s38, 0x1e0000
    s_waitcnt lgkmcnt(0)
    s_cmp_lt_u32 s42, 2
    s_cbranch_scc1 QK_wq
    s_load_dwordx2 s[8:9], s[0:1], 24
    s_waitcnt lgkmcnt(0)
QK_wq:
    s_mul_i32 s80, s40, 12
    s_add_u32 s80, s80, s41
    s_lshl_b32 s51, s80, 2
    s_add_u32 s51, s51, s42
    s_lshl_b32 s51, s51, 2
    v_add_u32 v170, s51, v3
    v_add_u32 v171, 1536, v170
    s_movk_i32 s51, 1280
    v_mul_lo_u32 v172, v170, s51
    v_lshl_add_u32 v172, v2, 4, v172
    buffer_load_dwordx4 v[32:35], v172, s[28:31], 0 offen offset:0
    buffer_load_dwordx4 v[36:39], v172, s[28:31], 0 offen offset:256
    buffer_load_dwordx4 v[40:43], v172, s[28:31], 0 offen offset:512
    buffer_load_dwordx4 v[44:47], v172, s[28:31], 0 offen offset:768
    buffer_load_dwordx4 v[48:51], v172, s[28:31], 0 offen offset:1024
    s_mov_b32 s51, 1966080
    buffer_load_dwordx4 v[52:55], v172, s[28:31], s51 offen offset:0
    buffer_load_dwordx4 v[56:59], v172, s[28:31], s51 offen offset:256
    buffer_load_dwordx4 v[60:63], v172, s[28:31], s51 offen offset:512
    buffer_load_dwordx4 v[64:67], v172, s[28:31], s51 offen offset:768
    buffer_load_dwordx4 v[68:71], v172, s[28:31], s51 offen offset:1024
    v_min_u32 v11, 159, v0
    v_mul_u32_u24 v11, 3072, v11
    s_and_b32 s51, s41, 3
    s_mul_i32 s51, s51, 491520
    s_lshl_b32 s52, s80, 5
    s_add_u32 s51, s51, s52
    buffer_load_dword v248, v11, s[16:19], s51 offen
    v_lshrrev_b32 v11, 3, v1
    v_mul_u32_u24 v149, 12288, v11
    v_and_b32 v11, 7, v1
    v_lshl_add_u32 v149, v11, 4, v149
    s_mul_i32 s51, s44, 384
    s_lshl_b32 s52, s45, 7
    s_add_u32 s51, s51, s52
    s_and_b32 s52, s42, 1
    s_mul_i32 s52, s52, 3932160
    s_add_u32 s99, s51, s52
    s_add_u32 m0, s90, 0
    s_add_u32 s50, s99, 0
    buffer_load_dwordx4 v149, s[8:11], s50 offen nt lds
    s_add_u32 m0, s90, 1024
    s_add_u32 s50, s99, 98304
    buffer_load_dwordx4 v149, s[8:11], s50 offen nt lds
    v_and_b32 v11, 7, v2
    v_lshlrev_b32 v15, 4, v11
    v_lshl_add_u32 v15, v3, 7, v15
    s_mov_b32 s51, 106496
    s_cmp_eq_u32 s42, 1
    s_cselect_b32 s51, 102400, s51
    s_cmp_eq_u32 s42, 2
    s_cselect_b32 s51, 104448, s51
    s_cmp_eq_u32 s42, 3
    s_cselect_b32 s51, 108544, s51
    s_cmp_ge_u32 s51, 106496
    s_cselect_b64 vcc, -1, 0
    v_cndmask_b32 v11, v5, v15, vcc
    v_add_u32 v154, s51, v11
    s_mov_b32 s51, 108544
    s_cmp_eq_u32 s42, 1
    s_cselect_b32 s51, 106496, s51
    s_cmp_eq_u32 s42, 2
    s_cselect_b32 s51, 106496, s51
    s_cmp_eq_u32 s42, 3
    s_cselect_b32 s51, 100352, s51
    s_cmp_ge_u32 s51, 106496
    s_cselect_b64 vcc, -1, 0
    v_cndmask_b32 v11, v5, v15, vcc
    v_add_u32 v155, s51, v11
    s_mov_b32 s51, 108544
    s_cmp_eq_u32 s42, 1
    s_cselect_b32 s51, 102400, s51
    s_cmp_eq_u32 s42, 2
    s_cselect_b32 s51, 102400, s51
    s_cmp_eq_u32 s42, 3
    s_cselect_b32 s51, 104448, s51
    s_cmp_ge_u32 s51, 106496
    s_cselect_b64 vcc, -1, 0
    v_cndmask_b32 v11, v5, v15, vcc
    v_add_u32 v156, s51, v11
    s_mov_b32 s51, 98304
    s_cmp_eq_u32 s42, 1
    s_cselect_b32 s51, 98304, s51
    s_cmp_eq_u32 s42, 2
    s_cselect_b32 s51, 100352, s51
    s_cmp_eq_u32 s42, 3
    s_cselect_b32 s51, 100352, s51
    s_cmp_ge_u32 s51, 106496
    s_cselect_b64 vcc, -1, 0
    v_cndmask_b32 v11, v5, v15, vcc
    v_add_u32 v157, s51, v11
    v_lshlrev_b32 v11, 5, v2
    v_lshl_add_u32 v11, v3, 4, v11
    s_cmp_eq_u32 s42, 0
    s_cselect_b64 vcc, -1, 0
    v_cndmask_b32 v11, v5, v11, vcc
    s_mov_b32 s51, 1024
    s_cmp_eq_u32 s42, 1
    s_cselect_b32 s51, 0, s51
    s_cmp_eq_u32 s42, 2
    s_cselect_b32 s51, 128, s51
    s_cmp_eq_u32 s42, 3
    s_cselect_b32 s51, 512, s51
    v_add_u32 v158, s51, v11
    s_lshl_b32 s51, s42, 10
    v_add_u32 v159, s51, v5
    s_mov_b32 s54, 0x00ff00ff
    s_cmp_eq_u32 s42, 1
    s_cselect_b32 s54, 0x00ff00ff, s54
    s_cmp_eq_u32 s42, 2
    s_cselect_b32 s54, 0x00ff00ff, s54
    s_cmp_eq_u32 s42, 3
    s_cselect_b32 s54, -1, s54
    s_mov_b32 s55, 0
    s_cmp_eq_u32 s42, 1
    s_cselect_b32 s55, 0x00ff00ff, s55
    s_cmp_eq_u32 s42, 2
    s_cselect_b32 s55, 0x00ff00ff, s55
    s_cmp_eq_u32 s42, 3
    s_cselect_b32 s55, 0, s55
    s_mov_b32 s56, -1
    s_mov_b32 s57, 0
    s_cmp_eq_u32 s42, 1
    s_cselect_b32 s57, -1, s57
    s_cmp_eq_u32 s42, 2
    s_cselect_b32 s57, -1, s57
    s_cmp_eq_u32 s42, 3
    s_cselect_b32 s57, -1, s57
    s_mul_i32 s51, s44, 3
    s_add_u32 s51, s51, s45
    s_lshl_b32 s63, s51, 12
    s_add_u32 s63, s63, 14680064
    s_mul_i32 s51, s80, 1280
    s_add_u32 s51, s51, 12058624
    s_cmp_eq_u32 s42, 3
    s_cselect_b32 s61, s63, s51
    s_mov_b32 s62, 122880
    s_cselect_b32 s62, 393216, s62
    s_mul_i32 s64, s44, 12288
    s_add_u32 s64, s64, 14680064
    v_lshrrev_b32 v11, 2, v2
    v_lshlrev_b32 v160, 7, v11
    v_lshl_add_u32 v160, v3, 5, v160
    v_and_b32 v11, 3, v2
    v_lshl_add_u32 v160, v11, 1, v160
    s_lshl_b32 s51, s42, 10
    s_add_u32 s51, s51, 106496
    v_add_u32 v160, s51, v160
    s_mov_b32 s51, 98304
    s_cmp_eq_u32 s42, 1
    s_cselect_b32 s51, 99328, s51
    s_cmp_eq_u32 s42, 2
    s_cselect_b32 s51, 102400, s51
    s_cmp_eq_u32 s42, 3
    s_cselect_b32 s51, 103424, s51
    v_add_u32 v161, s51, v5
    v_add_u32 v162, 81920, v6
    v_add_u32 v163, 81920, v7
    v_add_u32 v164, 81920, v8
    v_lshrrev_b32 v11, 1, v3
    v_lshlrev_b32 v11, 8, v11
    v_lshl_add_u32 v11, v2, 4, v11
    v_and_b32 v12, 1, v3
    v_lshl_add_u32 v11, v12, 3, v11
    s_lshl_b32 s51, s45, 9
    v_add_u32 v212, s51, v11
    s_lshl_b32 s51, s45, 10
    s_add_u32 s51, s51, 1024
    v_add_u32 v213, s51, v5
    s_lshl_b32 s51, s45, 11
    s_add_u32 s51, s51, 1024
    v_add_u32 v214, s51, v5
    v_add_u32 v215, 4096, v212
    v_add_u32 v216, 4096, v213
    v_add_u32 v217, 4096, v214
    v_add_u32 v218, 8192, v212
    v_add_u32 v219, 8192, v213
    v_add_u32 v220, 8192, v214
    s_lshl_b32 s51, s45, 4
    v_add_u32 v165, s51, v2
    v_lshlrev_b32 v11, 2, v3
    v_sub_u32 v165, v165, v11
    v_lshlrev_b32 v166, 3, v1
    s_lshl_b32 s76, s80, 10
    s_lshl_b32 s51, s42, 3
    s_add_u32 s76, s76, s51
    s_add_u32 s76, s76, 4718592
    s_cmp_eq_u32 s42, 3
    s_cselect_b32 s81, 1, 0
    s_cmp_lt_u32 s45, 2
    s_cselect_b32 s81, s81, 0
    s_mul_i32 s51, s62, 0
    s_add_u32 s51, s51, s61
    s_mov_b64 exec, s[54:55]
    buffer_store_dwordx4 v[244:247], v158, s[4:7], s51 offen offset:0 sc1
    s_add_u32 s51, s63, 0
    s_mov_b64 exec, s[56:57]
    buffer_store_dwordx4 v[244:247], v159, s[4:7], s51 offen offset:0 sc1
    s_mul_i32 s51, s62, 1
    s_add_u32 s51, s51, s61
    s_mov_b64 exec, s[54:55]
    buffer_store_dwordx4 v[244:247], v158, s[4:7], s51 offen offset:0 sc1
    s_add_u32 s51, s63, 393216
    s_mov_b64 exec, s[56:57]
    buffer_store_dwordx4 v[244:247], v159, s[4:7], s51 offen offset:0 sc1
    s_mul_i32 s51, s62, 2
    s_add_u32 s51, s51, s61
    s_mov_b64 exec, s[54:55]
    buffer_store_dwordx4 v[244:247], v158, s[4:7], s51 offen offset:0 sc1
    s_add_u32 s51, s63, 786432
    s_mov_b64 exec, s[56:57]
    buffer_store_dwordx4 v[244:247], v159, s[4:7], s51 offen offset:0 sc1
    s_mul_i32 s51, s62, 3
    s_add_u32 s51, s51, s61
    s_mov_b64 exec, s[54:55]
    buffer_store_dwordx4 v[244:247], v158, s[4:7], s51 offen offset:0 sc1
    s_add_u32 s51, s63, 1179648
    s_mov_b64 exec, s[56:57]
    buffer_store_dwordx4 v[244:247], v159, s[4:7], s51 offen offset:0 sc1
    s_mov_b64 exec, -1
    s_waitcnt vmcnt(11)
    v_lshrrev_b32 v22, 4, v170
    s_movk_i32 s51, 20480
    v_mul_lo_u32 v22, v22, s51
    v_lshrrev_b32 v19, 2, v2
    v_lshl_add_u32 v22, v19, 10, v22
    v_and_b32 v19, 3, v2
    v_lshl_add_u32 v22, v19, 8, v22
    v_and_b32 v19, 15, v170
    v_lshl_add_u32 v22, v19, 4, v22
    v_lshlrev_b32 v72, 16, v32
    v_and_b32 v73, 0xffff0000, v32
    v_lshlrev_b32 v74, 16, v33
    v_and_b32 v75, 0xffff0000, v33
    v_lshlrev_b32 v76, 16, v34
    v_and_b32 v77, 0xffff0000, v34
    v_lshlrev_b32 v78, 16, v35
    v_and_b32 v79, 0xffff0000, v35
    v_lshlrev_b32 v80, 16, v36
    v_and_b32 v81, 0xffff0000, v36
    v_lshlrev_b32 v82, 16, v37
    v_and_b32 v83, 0xffff0000, v37
    v_lshlrev_b32 v84, 16, v38
    v_and_b32 v85, 0xffff0000, v38
    v_lshlrev_b32 v86, 16, v39
    v_and_b32 v87, 0xffff0000, v39
    v_lshlrev_b32 v88, 16, v40
    v_and_b32 v89, 0xffff0000, v40
    v_lshlrev_b32 v90, 16, v41
    v_and_b32 v91, 0xffff0000, v41
    v_lshlrev_b32 v92, 16, v42
    v_and_b32 v93, 0xffff0000, v42
    v_lshlrev_b32 v94, 16, v43
    v_and_b32 v95, 0xffff0000, v43
    v_lshlrev_b32 v96, 16, v44
    v_and_b32 v97, 0xffff0000, v44
    v_lshlrev_b32 v98, 16, v45
    v_and_b32 v99, 0xffff0000, v45
    v_lshlrev_b32 v100, 16, v46
    v_and_b32 v101, 0xffff0000, v46
    v_lshlrev_b32 v102, 16, v47
    v_and_b32 v103, 0xffff0000, v47
    v_lshlrev_b32 v104, 16, v48
    v_and_b32 v105, 0xffff0000, v48
    v_lshlrev_b32 v106, 16, v49
    v_and_b32 v107, 0xffff0000, v49
    v_lshlrev_b32 v108, 16, v50
    v_and_b32 v109, 0xffff0000, v50
    v_lshlrev_b32 v110, 16, v51
    v_and_b32 v111, 0xffff0000, v51
    v_add_f32 v16, v72, v73
    v_add_f32 v17, v74, v75
    v_add_f32 v16, v16, v76
    v_add_f32 v17, v17, v77
    v_add_f32 v16, v16, v78
    v_add_f32 v17, v17, v79
    v_add_f32 v16, v16, v80
    v_add_f32 v17, v17, v81
    v_add_f32 v16, v16, v82
    v_add_f32 v17, v17, v83
    v_add_f32 v16, v16, v84
    v_add_f32 v17, v17, v85
    v_add_f32 v16, v16, v86
    v_add_f32 v17, v17, v87
    v_add_f32 v16, v16, v88
    v_add_f32 v17, v17, v89
    v_add_f32 v16, v16, v90
    v_add_f32 v17, v17, v91
    v_add_f32 v16, v16, v92
    v_add_f32 v17, v17, v93
    v_add_f32 v16, v16, v94
    v_add_f32 v17, v17, v95
    v_add_f32 v16, v16, v96
    v_add_f32 v17, v17, v97
    v_add_f32 v16, v16, v98
    v_add_f32 v17, v17, v99
    v_add_f32 v16, v16, v100
    v_add_f32 v17, v17, v101
    v_add_f32 v16, v16, v102
    v_add_f32 v17, v17, v103
    v_add_f32 v16, v16, v104
    v_add_f32 v17, v17, v105
    v_add_f32 v16, v16, v106
    v_add_f32 v17, v17, v107
    v_add_f32 v16, v16, v108
    v_add_f32 v17, v17, v109
    v_add_f32 v16, v16, v110
    v_add_f32 v17, v17, v111
    v_add_f32 v16, v16, v17
    s_nop 1
    v_add_f32_dpp v16, v16, v16 row_ror:8 row_mask:0xf bank_mask:0xf
    s_nop 1
    v_add_f32_dpp v16, v16, v16 row_ror:4 row_mask:0xf bank_mask:0xf
    s_nop 1
    v_add_f32_dpp v16, v16, v16 row_ror:2 row_mask:0xf bank_mask:0xf
    s_nop 1
    v_add_f32_dpp v16, v16, v16 row_ror:1 row_mask:0xf bank_mask:0xf
    v_mul_f32 v16, 0x3acccccd, v16
    v_mov_b32 v17, 0
    v_mov_b32 v18, 0
    v_sub_f32 v19, v72, v16
    v_sub_f32 v20, v73, v16
    v_fmac_f32 v17, v19, v19
    v_fmac_f32 v18, v20, v20
    v_sub_f32 v19, v74, v16
    v_sub_f32 v20, v75, v16
    v_fmac_f32 v17, v19, v19
    v_fmac_f32 v18, v20, v20
    v_sub_f32 v19, v76, v16
    v_sub_f32 v20, v77, v16
    v_fmac_f32 v17, v19, v19
    v_fmac_f32 v18, v20, v20
    v_sub_f32 v19, v78, v16
    v_sub_f32 v20, v79, v16
    v_fmac_f32 v17, v19, v19
    v_fmac_f32 v18, v20, v20
    v_sub_f32 v19, v80, v16
    v_sub_f32 v20, v81, v16
    v_fmac_f32 v17, v19, v19
    v_fmac_f32 v18, v20, v20
    v_sub_f32 v19, v82, v16
    v_sub_f32 v20, v83, v16
    v_fmac_f32 v17, v19, v19
    v_fmac_f32 v18, v20, v20
    v_sub_f32 v19, v84, v16
    v_sub_f32 v20, v85, v16
    v_fmac_f32 v17, v19, v19
    v_fmac_f32 v18, v20, v20
    v_sub_f32 v19, v86, v16
    v_sub_f32 v20, v87, v16
    v_fmac_f32 v17, v19, v19
    v_fmac_f32 v18, v20, v20
    v_sub_f32 v19, v88, v16
    v_sub_f32 v20, v89, v16
    v_fmac_f32 v17, v19, v19
    v_fmac_f32 v18, v20, v20
    v_sub_f32 v19, v90, v16
    v_sub_f32 v20, v91, v16
    v_fmac_f32 v17, v19, v19
    v_fmac_f32 v18, v20, v20
    v_sub_f32 v19, v92, v16
    v_sub_f32 v20, v93, v16
    v_fmac_f32 v17, v19, v19
    v_fmac_f32 v18, v20, v20
    v_sub_f32 v19, v94, v16
    v_sub_f32 v20, v95, v16
    v_fmac_f32 v17, v19, v19
    v_fmac_f32 v18, v20, v20
    v_sub_f32 v19, v96, v16
    v_sub_f32 v20, v97, v16
    v_fmac_f32 v17, v19, v19
    v_fmac_f32 v18, v20, v20
    v_sub_f32 v19, v98, v16
    v_sub_f32 v20, v99, v16
    v_fmac_f32 v17, v19, v19
    v_fmac_f32 v18, v20, v20
    v_sub_f32 v19, v100, v16
    v_sub_f32 v20, v101, v16
    v_fmac_f32 v17, v19, v19
    v_fmac_f32 v18, v20, v20
    v_sub_f32 v19, v102, v16
    v_sub_f32 v20, v103, v16
    v_fmac_f32 v17, v19, v19
    v_fmac_f32 v18, v20, v20
    v_sub_f32 v19, v104, v16
    v_sub_f32 v20, v105, v16
    v_fmac_f32 v17, v19, v19
    v_fmac_f32 v18, v20, v20
    v_sub_f32 v19, v106, v16
    v_sub_f32 v20, v107, v16
    v_fmac_f32 v17, v19, v19
    v_fmac_f32 v18, v20, v20
    v_sub_f32 v19, v108, v16
    v_sub_f32 v20, v109, v16
    v_fmac_f32 v17, v19, v19
    v_fmac_f32 v18, v20, v20
    v_sub_f32 v19, v110, v16
    v_sub_f32 v20, v111, v16
    v_fmac_f32 v17, v19, v19
    v_fmac_f32 v18, v20, v20
    v_add_f32 v17, v17, v18
    s_nop 1
    v_add_f32_dpp v17, v17, v17 row_ror:8 row_mask:0xf bank_mask:0xf
    s_nop 1
    v_add_f32_dpp v17, v17, v17 row_ror:4 row_mask:0xf bank_mask:0xf
    s_nop 1
    v_add_f32_dpp v17, v17, v17 row_ror:2 row_mask:0xf bank_mask:0xf
    s_nop 1
    v_add_f32_dpp v17, v17, v17 row_ror:1 row_mask:0xf bank_mask:0xf
    v_mul_f32 v17, 0x3acccccd, v17
    v_cvt_pk_bf16_f32 v19, v16, v17
    v_lshlrev_b32 v16, 16, v19
    v_and_b32 v17, 0xffff0000, v19
    v_add_f32 v17, 0x3727c5ac, v17
    v_cvt_pk_bf16_f32 v19, v17, v18
    v_lshlrev_b32 v17, 16, v19
    v_and_b32 v18, 0xffff0000, v19
    v_sqrt_f32 v17, v17
    s_nop 0
    v_cvt_pk_bf16_f32 v19, v17, v18
    v_lshlrev_b32 v17, 16, v19
    v_and_b32 v18, 0xffff0000, v19
    v_rcp_f32 v18, v17
    v_sub_f32 v72, v72, v16
    v_sub_f32 v73, v73, v16
    v_cvt_pk_bf16_f32 v19, v72, v73
    v_lshlrev_b32 v72, 16, v19
    v_and_b32 v73, 0xffff0000, v19
    v_mul_f32 v20, v72, v18
    v_fma_f32 v21, -v20, v17, v72
    v_fma_f32 v72, v21, v18, v20
    v_mul_f32 v20, v73, v18
    v_fma_f32 v21, -v20, v17, v73
    v_fma_f32 v73, v21, v18, v20
    v_cvt_pk_bf16_f32 v32, v72, v73
    v_sub_f32 v74, v74, v16
    v_sub_f32 v75, v75, v16
    v_cvt_pk_bf16_f32 v19, v74, v75
    v_lshlrev_b32 v74, 16, v19
    v_and_b32 v75, 0xffff0000, v19
    v_mul_f32 v20, v74, v18
    v_fma_f32 v21, -v20, v17, v74
    v_fma_f32 v74, v21, v18, v20
    v_mul_f32 v20, v75, v18
    v_fma_f32 v21, -v20, v17, v75
    v_fma_f32 v75, v21, v18, v20
    v_cvt_pk_bf16_f32 v33, v74, v75
    v_sub_f32 v76, v76, v16
    v_sub_f32 v77, v77, v16
    v_cvt_pk_bf16_f32 v19, v76, v77
    v_lshlrev_b32 v76, 16, v19
    v_and_b32 v77, 0xffff0000, v19
    v_mul_f32 v20, v76, v18
    v_fma_f32 v21, -v20, v17, v76
    v_fma_f32 v76, v21, v18, v20
    v_mul_f32 v20, v77, v18
    v_fma_f32 v21, -v20, v17, v77
    v_fma_f32 v77, v21, v18, v20
    v_cvt_pk_bf16_f32 v34, v76, v77
    v_sub_f32 v78, v78, v16
    v_sub_f32 v79, v79, v16
    v_cvt_pk_bf16_f32 v19, v78, v79
    v_lshlrev_b32 v78, 16, v19
    v_and_b32 v79, 0xffff0000, v19
    v_mul_f32 v20, v78, v18
    v_fma_f32 v21, -v20, v17, v78
    v_fma_f32 v78, v21, v18, v20
    v_mul_f32 v20, v79, v18
    v_fma_f32 v21, -v20, v17, v79
    v_fma_f32 v79, v21, v18, v20
    v_cvt_pk_bf16_f32 v35, v78, v79
    v_sub_f32 v80, v80, v16
    v_sub_f32 v81, v81, v16
    v_cvt_pk_bf16_f32 v19, v80, v81
    v_lshlrev_b32 v80, 16, v19
    v_and_b32 v81, 0xffff0000, v19
    v_mul_f32 v20, v80, v18
    v_fma_f32 v21, -v20, v17, v80
    v_fma_f32 v80, v21, v18, v20
    v_mul_f32 v20, v81, v18
    v_fma_f32 v21, -v20, v17, v81
    v_fma_f32 v81, v21, v18, v20
    v_cvt_pk_bf16_f32 v36, v80, v81
    v_sub_f32 v82, v82, v16
    v_sub_f32 v83, v83, v16
    v_cvt_pk_bf16_f32 v19, v82, v83
    v_lshlrev_b32 v82, 16, v19
    v_and_b32 v83, 0xffff0000, v19
    v_mul_f32 v20, v82, v18
    v_fma_f32 v21, -v20, v17, v82
    v_fma_f32 v82, v21, v18, v20
    v_mul_f32 v20, v83, v18
    v_fma_f32 v21, -v20, v17, v83
    v_fma_f32 v83, v21, v18, v20
    v_cvt_pk_bf16_f32 v37, v82, v83
    v_sub_f32 v84, v84, v16
    v_sub_f32 v85, v85, v16
    v_cvt_pk_bf16_f32 v19, v84, v85
    v_lshlrev_b32 v84, 16, v19
    v_and_b32 v85, 0xffff0000, v19
    v_mul_f32 v20, v84, v18
    v_fma_f32 v21, -v20, v17, v84
    v_fma_f32 v84, v21, v18, v20
    v_mul_f32 v20, v85, v18
    v_fma_f32 v21, -v20, v17, v85
    v_fma_f32 v85, v21, v18, v20
    v_cvt_pk_bf16_f32 v38, v84, v85
    v_sub_f32 v86, v86, v16
    v_sub_f32 v87, v87, v16
    v_cvt_pk_bf16_f32 v19, v86, v87
    v_lshlrev_b32 v86, 16, v19
    v_and_b32 v87, 0xffff0000, v19
    v_mul_f32 v20, v86, v18
    v_fma_f32 v21, -v20, v17, v86
    v_fma_f32 v86, v21, v18, v20
    v_mul_f32 v20, v87, v18
    v_fma_f32 v21, -v20, v17, v87
    v_fma_f32 v87, v21, v18, v20
    v_cvt_pk_bf16_f32 v39, v86, v87
    v_sub_f32 v88, v88, v16
    v_sub_f32 v89, v89, v16
    v_cvt_pk_bf16_f32 v19, v88, v89
    v_lshlrev_b32 v88, 16, v19
    v_and_b32 v89, 0xffff0000, v19
    v_mul_f32 v20, v88, v18
    v_fma_f32 v21, -v20, v17, v88
    v_fma_f32 v88, v21, v18, v20
    v_mul_f32 v20, v89, v18
    v_fma_f32 v21, -v20, v17, v89
    v_fma_f32 v89, v21, v18, v20
    v_cvt_pk_bf16_f32 v40, v88, v89
    v_sub_f32 v90, v90, v16
    v_sub_f32 v91, v91, v16
    v_cvt_pk_bf16_f32 v19, v90, v91
    v_lshlrev_b32 v90, 16, v19
    v_and_b32 v91, 0xffff0000, v19
    v_mul_f32 v20, v90, v18
    v_fma_f32 v21, -v20, v17, v90
    v_fma_f32 v90, v21, v18, v20
    v_mul_f32 v20, v91, v18
    v_fma_f32 v21, -v20, v17, v91
    v_fma_f32 v91, v21, v18, v20
    v_cvt_pk_bf16_f32 v41, v90, v91
    v_sub_f32 v92, v92, v16
    v_sub_f32 v93, v93, v16
    v_cvt_pk_bf16_f32 v19, v92, v93
    v_lshlrev_b32 v92, 16, v19
    v_and_b32 v93, 0xffff0000, v19
    v_mul_f32 v20, v92, v18
    v_fma_f32 v21, -v20, v17, v92
    v_fma_f32 v92, v21, v18, v20
    v_mul_f32 v20, v93, v18
    v_fma_f32 v21, -v20, v17, v93
    v_fma_f32 v93, v21, v18, v20
    v_cvt_pk_bf16_f32 v42, v92, v93
    v_sub_f32 v94, v94, v16
    v_sub_f32 v95, v95, v16
    v_cvt_pk_bf16_f32 v19, v94, v95
    v_lshlrev_b32 v94, 16, v19
    v_and_b32 v95, 0xffff0000, v19
    v_mul_f32 v20, v94, v18
    v_fma_f32 v21, -v20, v17, v94
    v_fma_f32 v94, v21, v18, v20
    v_mul_f32 v20, v95, v18
    v_fma_f32 v21, -v20, v17, v95
    v_fma_f32 v95, v21, v18, v20
    v_cvt_pk_bf16_f32 v43, v94, v95
    v_sub_f32 v96, v96, v16
    v_sub_f32 v97, v97, v16
    v_cvt_pk_bf16_f32 v19, v96, v97
    v_lshlrev_b32 v96, 16, v19
    v_and_b32 v97, 0xffff0000, v19
    v_mul_f32 v20, v96, v18
    v_fma_f32 v21, -v20, v17, v96
    v_fma_f32 v96, v21, v18, v20
    v_mul_f32 v20, v97, v18
    v_fma_f32 v21, -v20, v17, v97
    v_fma_f32 v97, v21, v18, v20
    v_cvt_pk_bf16_f32 v44, v96, v97
    v_sub_f32 v98, v98, v16
    v_sub_f32 v99, v99, v16
    v_cvt_pk_bf16_f32 v19, v98, v99
    v_lshlrev_b32 v98, 16, v19
    v_and_b32 v99, 0xffff0000, v19
    v_mul_f32 v20, v98, v18
    v_fma_f32 v21, -v20, v17, v98
    v_fma_f32 v98, v21, v18, v20
    v_mul_f32 v20, v99, v18
    v_fma_f32 v21, -v20, v17, v99
    v_fma_f32 v99, v21, v18, v20
    v_cvt_pk_bf16_f32 v45, v98, v99
    v_sub_f32 v100, v100, v16
    v_sub_f32 v101, v101, v16
    v_cvt_pk_bf16_f32 v19, v100, v101
    v_lshlrev_b32 v100, 16, v19
    v_and_b32 v101, 0xffff0000, v19
    v_mul_f32 v20, v100, v18
    v_fma_f32 v21, -v20, v17, v100
    v_fma_f32 v100, v21, v18, v20
    v_mul_f32 v20, v101, v18
    v_fma_f32 v21, -v20, v17, v101
    v_fma_f32 v101, v21, v18, v20
    v_cvt_pk_bf16_f32 v46, v100, v101
    v_sub_f32 v102, v102, v16
    v_sub_f32 v103, v103, v16
    v_cvt_pk_bf16_f32 v19, v102, v103
    v_lshlrev_b32 v102, 16, v19
    v_and_b32 v103, 0xffff0000, v19
    v_mul_f32 v20, v102, v18
    v_fma_f32 v21, -v20, v17, v102
    v_fma_f32 v102, v21, v18, v20
    v_mul_f32 v20, v103, v18
    v_fma_f32 v21, -v20, v17, v103
    v_fma_f32 v103, v21, v18, v20
    v_cvt_pk_bf16_f32 v47, v102, v103
    v_sub_f32 v104, v104, v16
    v_sub_f32 v105, v105, v16
    v_cvt_pk_bf16_f32 v19, v104, v105
    v_lshlrev_b32 v104, 16, v19
    v_and_b32 v105, 0xffff0000, v19
    v_mul_f32 v20, v104, v18
    v_fma_f32 v21, -v20, v17, v104
    v_fma_f32 v104, v21, v18, v20
    v_mul_f32 v20, v105, v18
    v_fma_f32 v21, -v20, v17, v105
    v_fma_f32 v105, v21, v18, v20
    v_cvt_pk_bf16_f32 v48, v104, v105
    v_sub_f32 v106, v106, v16
    v_sub_f32 v107, v107, v16
    v_cvt_pk_bf16_f32 v19, v106, v107
    v_lshlrev_b32 v106, 16, v19
    v_and_b32 v107, 0xffff0000, v19
    v_mul_f32 v20, v106, v18
    v_fma_f32 v21, -v20, v17, v106
    v_fma_f32 v106, v21, v18, v20
    v_mul_f32 v20, v107, v18
    v_fma_f32 v21, -v20, v17, v107
    v_fma_f32 v107, v21, v18, v20
    v_cvt_pk_bf16_f32 v49, v106, v107
    v_sub_f32 v108, v108, v16
    v_sub_f32 v109, v109, v16
    v_cvt_pk_bf16_f32 v19, v108, v109
    v_lshlrev_b32 v108, 16, v19
    v_and_b32 v109, 0xffff0000, v19
    v_mul_f32 v20, v108, v18
    v_fma_f32 v21, -v20, v17, v108
    v_fma_f32 v108, v21, v18, v20
    v_mul_f32 v20, v109, v18
    v_fma_f32 v21, -v20, v17, v109
    v_fma_f32 v109, v21, v18, v20
    v_cvt_pk_bf16_f32 v50, v108, v109
    v_sub_f32 v110, v110, v16
    v_sub_f32 v111, v111, v16
    v_cvt_pk_bf16_f32 v19, v110, v111
    v_lshlrev_b32 v110, 16, v19
    v_and_b32 v111, 0xffff0000, v19
    v_mul_f32 v20, v110, v18
    v_fma_f32 v21, -v20, v17, v110
    v_fma_f32 v110, v21, v18, v20
    v_mul_f32 v20, v111, v18
    v_fma_f32 v21, -v20, v17, v111
    v_fma_f32 v111, v21, v18, v20
    v_cvt_pk_bf16_f32 v51, v110, v111
    s_movk_i32 s51, 0
    buffer_store_dwordx4 v[32:35], v22, s[4:7], s51 offen offset:0 sc1
    s_movk_i32 s51, 4096
    buffer_store_dwordx4 v[36:39], v22, s[4:7], s51 offen offset:0 sc1
    s_movk_i32 s51, 8192
    buffer_store_dwordx4 v[40:43], v22, s[4:7], s51 offen offset:0 sc1
    s_movk_i32 s51, 12288
    buffer_store_dwordx4 v[44:47], v22, s[4:7], s51 offen offset:0 sc1
    s_movk_i32 s51, 16384
    buffer_store_dwordx4 v[48:51], v22, s[4:7], s51 offen offset:0 sc1
    s_add_u32 m0, s90, 2048
    s_add_u32 s50, s99, 196608
    buffer_load_dwordx4 v149, s[8:11], s50 offen nt lds
    s_add_u32 m0, s90, 3072
    s_add_u32 s50, s99, 294912
    buffer_load_dwordx4 v149, s[8:11], s50 offen nt lds
    s_add_u32 m0, s90, 4096
    s_add_u32 s50, s99, 393216
    buffer_load_dwordx4 v149, s[8:11], s50 offen nt lds
    s_add_u32 m0, s90, 5120
    s_add_u32 s50, s99, 491520
    buffer_load_dwordx4 v149, s[8:11], s50 offen nt lds
    s_add_u32 m0, s90, 6144
    s_add_u32 s50, s99, 589824
    buffer_load_dwordx4 v149, s[8:11], s50 offen nt lds
    s_add_u32 m0, s90, 7168
    s_add_u32 s50, s99, 688128
    buffer_load_dwordx4 v149, s[8:11], s50 offen nt lds
    s_add_u32 m0, s90, 8192
    s_add_u32 s50, s99, 786432
    buffer_load_dwordx4 v149, s[8:11], s50 offen nt lds
    s_add_u32 m0, s90, 9216
    s_add_u32 s50, s99, 884736
    buffer_load_dwordx4 v149, s[8:11], s50 offen nt lds
    s_add_u32 m0, s90, 10240
    s_add_u32 s50, s99, 983040
    buffer_load_dwordx4 v149, s[8:11], s50 offen nt lds
    s_add_u32 m0, s90, 11264
    s_add_u32 s50, s99, 1081344
    buffer_load_dwordx4 v149, s[8:11], s50 offen nt lds
    s_add_u32 m0, s90, 12288
    s_add_u32 s50, s99, 1179648
    buffer_load_dwordx4 v149, s[8:11], s50 offen nt lds
    s_add_u32 m0, s90, 13312
    s_add_u32 s50, s99, 1277952
    buffer_load_dwordx4 v149, s[8:11], s50 offen nt lds
    s_add_u32 m0, s90, 14336
    s_add_u32 s50, s99, 1376256
    buffer_load_dwordx4 v149, s[8:11], s50 offen nt lds
    s_add_u32 m0, s90, 15360
    s_add_u32 s50, s99, 1474560
    buffer_load_dwordx4 v149, s[8:11], s50 offen nt lds
    s_cmp_ge_u32 s80, 32
    s_cbranch_scc1 QK_ln2
    v_lshrrev_b32 v22, 4, v171
    s_movk_i32 s51, 20480
    v_mul_lo_u32 v22, v22, s51
    v_lshrrev_b32 v19, 2, v2
    v_lshl_add_u32 v22, v19, 10, v22
    v_and_b32 v19, 3, v2
    v_lshl_add_u32 v22, v19, 8, v22
    v_and_b32 v19, 15, v171
    v_lshl_add_u32 v22, v19, 4, v22
    v_lshlrev_b32 v72, 16, v52
    v_and_b32 v73, 0xffff0000, v52
    v_lshlrev_b32 v74, 16, v53
    v_and_b32 v75, 0xffff0000, v53
    v_lshlrev_b32 v76, 16, v54
    v_and_b32 v77, 0xffff0000, v54
    v_lshlrev_b32 v78, 16, v55
    v_and_b32 v79, 0xffff0000, v55
    v_lshlrev_b32 v80, 16, v56
    v_and_b32 v81, 0xffff0000, v56
    v_lshlrev_b32 v82, 16, v57
    v_and_b32 v83, 0xffff0000, v57
    v_lshlrev_b32 v84, 16, v58
    v_and_b32 v85, 0xffff0000, v58
    v_lshlrev_b32 v86, 16, v59
    v_and_b32 v87, 0xffff0000, v59
    v_lshlrev_b32 v88, 16, v60
    v_and_b32 v89, 0xffff0000, v60
    v_lshlrev_b32 v90, 16, v61
    v_and_b32 v91, 0xffff0000, v61
    v_lshlrev_b32 v92, 16, v62
    v_and_b32 v93, 0xffff0000, v62
    v_lshlrev_b32 v94, 16, v63
    v_and_b32 v95, 0xffff0000, v63
    v_lshlrev_b32 v96, 16, v64
    v_and_b32 v97, 0xffff0000, v64
    v_lshlrev_b32 v98, 16, v65
    v_and_b32 v99, 0xffff0000, v65
    v_lshlrev_b32 v100, 16, v66
    v_and_b32 v101, 0xffff0000, v66
    v_lshlrev_b32 v102, 16, v67
    v_and_b32 v103, 0xffff0000, v67
    v_lshlrev_b32 v104, 16, v68
    v_and_b32 v105, 0xffff0000, v68
    v_lshlrev_b32 v106, 16, v69
    v_and_b32 v107, 0xffff0000, v69
    v_lshlrev_b32 v108, 16, v70
    v_and_b32 v109, 0xffff0000, v70
    v_lshlrev_b32 v110, 16, v71
    v_and_b32 v111, 0xffff0000, v71
    v_add_f32 v16, v72, v73
    v_add_f32 v17, v74, v75
    v_add_f32 v16, v16, v76
    v_add_f32 v17, v17, v77
    v_add_f32 v16, v16, v78
    v_add_f32 v17, v17, v79
    v_add_f32 v16, v16, v80
    v_add_f32 v17, v17, v81
    v_add_f32 v16, v16, v82
    v_add_f32 v17, v17, v83
    v_add_f32 v16, v16, v84
    v_add_f32 v17, v17, v85
    v_add_f32 v16, v16, v86
    v_add_f32 v17, v17, v87
    v_add_f32 v16, v16, v88
    v_add_f32 v17, v17, v89
    v_add_f32 v16, v16, v90
    v_add_f32 v17, v17, v91
    v_add_f32 v16, v16, v92
    v_add_f32 v17, v17, v93
    v_add_f32 v16, v16, v94
    v_add_f32 v17, v17, v95
    v_add_f32 v16, v16, v96
    v_add_f32 v17, v17, v97
    v_add_f32 v16, v16, v98
    v_add_f32 v17, v17, v99
    v_add_f32 v16, v16, v100
    v_add_f32 v17, v17, v101
    v_add_f32 v16, v16, v102
    v_add_f32 v17, v17, v103
    v_add_f32 v16, v16, v104
    v_add_f32 v17, v17, v105
    v_add_f32 v16, v16, v106
    v_add_f32 v17, v17, v107
    v_add_f32 v16, v16, v108
    v_add_f32 v17, v17, v109
    v_add_f32 v16, v16, v110
    v_add_f32 v17, v17, v111
    v_add_f32 v16, v16, v17
    s_nop 1
    v_add_f32_dpp v16, v16, v16 row_ror:8 row_mask:0xf bank_mask:0xf
    s_nop 1
    v_add_f32_dpp v16, v16, v16 row_ror:4 row_mask:0xf bank_mask:0xf
    s_nop 1
    v_add_f32_dpp v16, v16, v16 row_ror:2 row_mask:0xf bank_mask:0xf
    s_nop 1
    v_add_f32_dpp v16, v16, v16 row_ror:1 row_mask:0xf bank_mask:0xf
    v_mul_f32 v16, 0x3acccccd, v16
    v_mov_b32 v17, 0
    v_mov_b32 v18, 0
    v_sub_f32 v19, v72, v16
    v_sub_f32 v20, v73, v16
    v_fmac_f32 v17, v19, v19
    v_fmac_f32 v18, v20, v20
    v_sub_f32 v19, v74, v16
    v_sub_f32 v20, v75, v16
    v_fmac_f32 v17, v19, v19
    v_fmac_f32 v18, v20, v20
    v_sub_f32 v19, v76, v16
    v_sub_f32 v20, v77, v16
    v_fmac_f32 v17, v19, v19
    v_fmac_f32 v18, v20, v20
    v_sub_f32 v19, v78, v16
    v_sub_f32 v20, v79, v16
    v_fmac_f32 v17, v19, v19
    v_fmac_f32 v18, v20, v20
    v_sub_f32 v19, v80, v16
    v_sub_f32 v20, v81, v16
    v_fmac_f32 v17, v19, v19
    v_fmac_f32 v18, v20, v20
    v_sub_f32 v19, v82, v16
    v_sub_f32 v20, v83, v16
    v_fmac_f32 v17, v19, v19
    v_fmac_f32 v18, v20, v20
    v_sub_f32 v19, v84, v16
    v_sub_f32 v20, v85, v16
    v_fmac_f32 v17, v19, v19
    v_fmac_f32 v18, v20, v20
    v_sub_f32 v19, v86, v16
    v_sub_f32 v20, v87, v16
    v_fmac_f32 v17, v19, v19
    v_fmac_f32 v18, v20, v20
    v_sub_f32 v19, v88, v16
    v_sub_f32 v20, v89, v16
    v_fmac_f32 v17, v19, v19
    v_fmac_f32 v18, v20, v20
    v_sub_f32 v19, v90, v16
    v_sub_f32 v20, v91, v16
    v_fmac_f32 v17, v19, v19
    v_fmac_f32 v18, v20, v20
    v_sub_f32 v19, v92, v16
    v_sub_f32 v20, v93, v16
    v_fmac_f32 v17, v19, v19
    v_fmac_f32 v18, v20, v20
    v_sub_f32 v19, v94, v16
    v_sub_f32 v20, v95, v16
    v_fmac_f32 v17, v19, v19
    v_fmac_f32 v18, v20, v20
    v_sub_f32 v19, v96, v16
    v_sub_f32 v20, v97, v16
    v_fmac_f32 v17, v19, v19
    v_fmac_f32 v18, v20, v20
    v_sub_f32 v19, v98, v16
    v_sub_f32 v20, v99, v16
    v_fmac_f32 v17, v19, v19
    v_fmac_f32 v18, v20, v20
    v_sub_f32 v19, v100, v16
    v_sub_f32 v20, v101, v16
    v_fmac_f32 v17, v19, v19
    v_fmac_f32 v18, v20, v20
    v_sub_f32 v19, v102, v16
    v_sub_f32 v20, v103, v16
    v_fmac_f32 v17, v19, v19
    v_fmac_f32 v18, v20, v20
    v_sub_f32 v19, v104, v16
    v_sub_f32 v20, v105, v16
    v_fmac_f32 v17, v19, v19
    v_fmac_f32 v18, v20, v20
    v_sub_f32 v19, v106, v16
    v_sub_f32 v20, v107, v16
    v_fmac_f32 v17, v19, v19
    v_fmac_f32 v18, v20, v20
    v_sub_f32 v19, v108, v16
    v_sub_f32 v20, v109, v16
    v_fmac_f32 v17, v19, v19
    v_fmac_f32 v18, v20, v20
    v_sub_f32 v19, v110, v16
    v_sub_f32 v20, v111, v16
    v_fmac_f32 v17, v19, v19
    v_fmac_f32 v18, v20, v20
    v_add_f32 v17, v17, v18
    s_nop 1
    v_add_f32_dpp v17, v17, v17 row_ror:8 row_mask:0xf bank_mask:0xf
    s_nop 1
    v_add_f32_dpp v17, v17, v17 row_ror:4 row_mask:0xf bank_mask:0xf
    s_nop 1
    v_add_f32_dpp v17, v17, v17 row_ror:2 row_mask:0xf bank_mask:0xf
    s_nop 1
    v_add_f32_dpp v17, v17, v17 row_ror:1 row_mask:0xf bank_mask:0xf
    v_mul_f32 v17, 0x3acccccd, v17
    v_cvt_pk_bf16_f32 v19, v16, v17
    v_lshlrev_b32 v16, 16, v19
    v_and_b32 v17, 0xffff0000, v19
    v_add_f32 v17, 0x3727c5ac, v17
    v_cvt_pk_bf16_f32 v19, v17, v18
    v_lshlrev_b32 v17, 16, v19
    v_and_b32 v18, 0xffff0000, v19
    v_sqrt_f32 v17, v17
    s_nop 0
    v_cvt_pk_bf16_f32 v19, v17, v18
    v_lshlrev_b32 v17, 16, v19
    v_and_b32 v18, 0xffff0000, v19
    v_rcp_f32 v18, v17
    v_sub_f32 v72, v72, v16
    v_sub_f32 v73, v73, v16
    v_cvt_pk_bf16_f32 v19, v72, v73
    v_lshlrev_b32 v72, 16, v19
    v_and_b32 v73, 0xffff0000, v19
    v_mul_f32 v20, v72, v18
    v_fma_f32 v21, -v20, v17, v72
    v_fma_f32 v72, v21, v18, v20
    v_mul_f32 v20, v73, v18
    v_fma_f32 v21, -v20, v17, v73
    v_fma_f32 v73, v21, v18, v20
    v_cvt_pk_bf16_f32 v52, v72, v73
    v_sub_f32 v74, v74, v16
    v_sub_f32 v75, v75, v16
    v_cvt_pk_bf16_f32 v19, v74, v75
    v_lshlrev_b32 v74, 16, v19
    v_and_b32 v75, 0xffff0000, v19
    v_mul_f32 v20, v74, v18
    v_fma_f32 v21, -v20, v17, v74
    v_fma_f32 v74, v21, v18, v20
    v_mul_f32 v20, v75, v18
    v_fma_f32 v21, -v20, v17, v75
    v_fma_f32 v75, v21, v18, v20
    v_cvt_pk_bf16_f32 v53, v74, v75
    v_sub_f32 v76, v76, v16
    v_sub_f32 v77, v77, v16
    v_cvt_pk_bf16_f32 v19, v76, v77
    v_lshlrev_b32 v76, 16, v19
    v_and_b32 v77, 0xffff0000, v19
    v_mul_f32 v20, v76, v18
    v_fma_f32 v21, -v20, v17, v76
    v_fma_f32 v76, v21, v18, v20
    v_mul_f32 v20, v77, v18
    v_fma_f32 v21, -v20, v17, v77
    v_fma_f32 v77, v21, v18, v20
    v_cvt_pk_bf16_f32 v54, v76, v77
    v_sub_f32 v78, v78, v16
    v_sub_f32 v79, v79, v16
    v_cvt_pk_bf16_f32 v19, v78, v79
    v_lshlrev_b32 v78, 16, v19
    v_and_b32 v79, 0xffff0000, v19
    v_mul_f32 v20, v78, v18
    v_fma_f32 v21, -v20, v17, v78
    v_fma_f32 v78, v21, v18, v20
    v_mul_f32 v20, v79, v18
    v_fma_f32 v21, -v20, v17, v79
    v_fma_f32 v79, v21, v18, v20
    v_cvt_pk_bf16_f32 v55, v78, v79
    v_sub_f32 v80, v80, v16
    v_sub_f32 v81, v81, v16
    v_cvt_pk_bf16_f32 v19, v80, v81
    v_lshlrev_b32 v80, 16, v19
    v_and_b32 v81, 0xffff0000, v19
    v_mul_f32 v20, v80, v18
    v_fma_f32 v21, -v20, v17, v80
    v_fma_f32 v80, v21, v18, v20
    v_mul_f32 v20, v81, v18
    v_fma_f32 v21, -v20, v17, v81
    v_fma_f32 v81, v21, v18, v20
    v_cvt_pk_bf16_f32 v56, v80, v81
    v_sub_f32 v82, v82, v16
    v_sub_f32 v83, v83, v16
    v_cvt_pk_bf16_f32 v19, v82, v83
    v_lshlrev_b32 v82, 16, v19
    v_and_b32 v83, 0xffff0000, v19
    v_mul_f32 v20, v82, v18
    v_fma_f32 v21, -v20, v17, v82
    v_fma_f32 v82, v21, v18, v20
    v_mul_f32 v20, v83, v18
    v_fma_f32 v21, -v20, v17, v83
    v_fma_f32 v83, v21, v18, v20
    v_cvt_pk_bf16_f32 v57, v82, v83
    v_sub_f32 v84, v84, v16
    v_sub_f32 v85, v85, v16
    v_cvt_pk_bf16_f32 v19, v84, v85
    v_lshlrev_b32 v84, 16, v19
    v_and_b32 v85, 0xffff0000, v19
    v_mul_f32 v20, v84, v18
    v_fma_f32 v21, -v20, v17, v84
    v_fma_f32 v84, v21, v18, v20
    v_mul_f32 v20, v85, v18
    v_fma_f32 v21, -v20, v17, v85
    v_fma_f32 v85, v21, v18, v20
    v_cvt_pk_bf16_f32 v58, v84, v85
    v_sub_f32 v86, v86, v16
    v_sub_f32 v87, v87, v16
    v_cvt_pk_bf16_f32 v19, v86, v87
    v_lshlrev_b32 v86, 16, v19
    v_and_b32 v87, 0xffff0000, v19
    v_mul_f32 v20, v86, v18
    v_fma_f32 v21, -v20, v17, v86
    v_fma_f32 v86, v21, v18, v20
    v_mul_f32 v20, v87, v18
    v_fma_f32 v21, -v20, v17, v87
    v_fma_f32 v87, v21, v18, v20
    v_cvt_pk_bf16_f32 v59, v86, v87
    v_sub_f32 v88, v88, v16
    v_sub_f32 v89, v89, v16
    v_cvt_pk_bf16_f32 v19, v88, v89
    v_lshlrev_b32 v88, 16, v19
    v_and_b32 v89, 0xffff0000, v19
    v_mul_f32 v20, v88, v18
    v_fma_f32 v21, -v20, v17, v88
    v_fma_f32 v88, v21, v18, v20
    v_mul_f32 v20, v89, v18
    v_fma_f32 v21, -v20, v17, v89
    v_fma_f32 v89, v21, v18, v20
    v_cvt_pk_bf16_f32 v60, v88, v89
    v_sub_f32 v90, v90, v16
    v_sub_f32 v91, v91, v16
    v_cvt_pk_bf16_f32 v19, v90, v91
    v_lshlrev_b32 v90, 16, v19
    v_and_b32 v91, 0xffff0000, v19
    v_mul_f32 v20, v90, v18
    v_fma_f32 v21, -v20, v17, v90
    v_fma_f32 v90, v21, v18, v20
    v_mul_f32 v20, v91, v18
    v_fma_f32 v21, -v20, v17, v91
    v_fma_f32 v91, v21, v18, v20
    v_cvt_pk_bf16_f32 v61, v90, v91
    v_sub_f32 v92, v92, v16
    v_sub_f32 v93, v93, v16
    v_cvt_pk_bf16_f32 v19, v92, v93
    v_lshlrev_b32 v92, 16, v19
    v_and_b32 v93, 0xffff0000, v19
    v_mul_f32 v20, v92, v18
    v_fma_f32 v21, -v20, v17, v92
    v_fma_f32 v92, v21, v18, v20
    v_mul_f32 v20, v93, v18
    v_fma_f32 v21, -v20, v17, v93
    v_fma_f32 v93, v21, v18, v20
    v_cvt_pk_bf16_f32 v62, v92, v93
    v_sub_f32 v94, v94, v16
    v_sub_f32 v95, v95, v16
    v_cvt_pk_bf16_f32 v19, v94, v95
    v_lshlrev_b32 v94, 16, v19
    v_and_b32 v95, 0xffff0000, v19
    v_mul_f32 v20, v94, v18
    v_fma_f32 v21, -v20, v17, v94
    v_fma_f32 v94, v21, v18, v20
    v_mul_f32 v20, v95, v18
    v_fma_f32 v21, -v20, v17, v95
    v_fma_f32 v95, v21, v18, v20
    v_cvt_pk_bf16_f32 v63, v94, v95
    v_sub_f32 v96, v96, v16
    v_sub_f32 v97, v97, v16
    v_cvt_pk_bf16_f32 v19, v96, v97
    v_lshlrev_b32 v96, 16, v19
    v_and_b32 v97, 0xffff0000, v19
    v_mul_f32 v20, v96, v18
    v_fma_f32 v21, -v20, v17, v96
    v_fma_f32 v96, v21, v18, v20
    v_mul_f32 v20, v97, v18
    v_fma_f32 v21, -v20, v17, v97
    v_fma_f32 v97, v21, v18, v20
    v_cvt_pk_bf16_f32 v64, v96, v97
    v_sub_f32 v98, v98, v16
    v_sub_f32 v99, v99, v16
    v_cvt_pk_bf16_f32 v19, v98, v99
    v_lshlrev_b32 v98, 16, v19
    v_and_b32 v99, 0xffff0000, v19
    v_mul_f32 v20, v98, v18
    v_fma_f32 v21, -v20, v17, v98
    v_fma_f32 v98, v21, v18, v20
    v_mul_f32 v20, v99, v18
    v_fma_f32 v21, -v20, v17, v99
    v_fma_f32 v99, v21, v18, v20
    v_cvt_pk_bf16_f32 v65, v98, v99
    v_sub_f32 v100, v100, v16
    v_sub_f32 v101, v101, v16
    v_cvt_pk_bf16_f32 v19, v100, v101
    v_lshlrev_b32 v100, 16, v19
    v_and_b32 v101, 0xffff0000, v19
    v_mul_f32 v20, v100, v18
    v_fma_f32 v21, -v20, v17, v100
    v_fma_f32 v100, v21, v18, v20
    v_mul_f32 v20, v101, v18
    v_fma_f32 v21, -v20, v17, v101
    v_fma_f32 v101, v21, v18, v20
    v_cvt_pk_bf16_f32 v66, v100, v101
    v_sub_f32 v102, v102, v16
    v_sub_f32 v103, v103, v16
    v_cvt_pk_bf16_f32 v19, v102, v103
    v_lshlrev_b32 v102, 16, v19
    v_and_b32 v103, 0xffff0000, v19
    v_mul_f32 v20, v102, v18
    v_fma_f32 v21, -v20, v17, v102
    v_fma_f32 v102, v21, v18, v20
    v_mul_f32 v20, v103, v18
    v_fma_f32 v21, -v20, v17, v103
    v_fma_f32 v103, v21, v18, v20
    v_cvt_pk_bf16_f32 v67, v102, v103
    v_sub_f32 v104, v104, v16
    v_sub_f32 v105, v105, v16
    v_cvt_pk_bf16_f32 v19, v104, v105
    v_lshlrev_b32 v104, 16, v19
    v_and_b32 v105, 0xffff0000, v19
    v_mul_f32 v20, v104, v18
    v_fma_f32 v21, -v20, v17, v104
    v_fma_f32 v104, v21, v18, v20
    v_mul_f32 v20, v105, v18
    v_fma_f32 v21, -v20, v17, v105
    v_fma_f32 v105, v21, v18, v20
    v_cvt_pk_bf16_f32 v68, v104, v105
    v_sub_f32 v106, v106, v16
    v_sub_f32 v107, v107, v16
    v_cvt_pk_bf16_f32 v19, v106, v107
    v_lshlrev_b32 v106, 16, v19
    v_and_b32 v107, 0xffff0000, v19
    v_mul_f32 v20, v106, v18
    v_fma_f32 v21, -v20, v17, v106
    v_fma_f32 v106, v21, v18, v20
    v_mul_f32 v20, v107, v18
    v_fma_f32 v21, -v20, v17, v107
    v_fma_f32 v107, v21, v18, v20
    v_cvt_pk_bf16_f32 v69, v106, v107
    v_sub_f32 v108, v108, v16
    v_sub_f32 v109, v109, v16
    v_cvt_pk_bf16_f32 v19, v108, v109
    v_lshlrev_b32 v108, 16, v19
    v_and_b32 v109, 0xffff0000, v19
    v_mul_f32 v20, v108, v18
    v_fma_f32 v21, -v20, v17, v108
    v_fma_f32 v108, v21, v18, v20
    v_mul_f32 v20, v109, v18
    v_fma_f32 v21, -v20, v17, v109
    v_fma_f32 v109, v21, v18, v20
    v_cvt_pk_bf16_f32 v70, v108, v109
    v_sub_f32 v110, v110, v16
    v_sub_f32 v111, v111, v16
    v_cvt_pk_bf16_f32 v19, v110, v111
    v_lshlrev_b32 v110, 16, v19
    v_and_b32 v111, 0xffff0000, v19
    v_mul_f32 v20, v110, v18
    v_fma_f32 v21, -v20, v17, v110
    v_fma_f32 v110, v21, v18, v20
    v_mul_f32 v20, v111, v18
    v_fma_f32 v21, -v20, v17, v111
    v_fma_f32 v111, v21, v18, v20
    v_cvt_pk_bf16_f32 v71, v110, v111
    s_movk_i32 s51, 0
    buffer_store_dwordx4 v[52:55], v22, s[4:7], s51 offen offset:0 sc1
    s_movk_i32 s51, 4096
    buffer_store_dwordx4 v[56:59], v22, s[4:7], s51 offen offset:0 sc1
    s_movk_i32 s51, 8192
    buffer_store_dwordx4 v[60:63], v22, s[4:7], s51 offen offset:0 sc1
    s_movk_i32 s51, 12288
    buffer_store_dwordx4 v[64:67], v22, s[4:7], s51 offen offset:0 sc1
    s_movk_i32 s51, 16384
    buffer_store_dwordx4 v[68:71], v22, s[4:7], s51 offen offset:0 sc1
QK_ln2:
    s_cmp_eq_u32 s81, 0
    s_cbranch_scc1 QK_nopf
    s_add_u32 s51, s65, 0
    buffer_store_dwordx4 v[244:247], v168, s[4:7], s51 offen offset:0 sc1
    buffer_store_dword v244, v169, s[4:7], s51 offen offset:0 sc1
    s_add_u32 s51, s65, 81920
    buffer_store_dwordx4 v[244:247], v168, s[4:7], s51 offen offset:0 sc1
    buffer_store_dword v244, v169, s[4:7], s51 offen offset:0 sc1
    s_add_u32 s51, s65, 163840
    buffer_store_dwordx4 v[244:247], v168, s[4:7], s51 offen offset:0 sc1
    buffer_store_dword v244, v169, s[4:7], s51 offen offset:0 sc1
    s_add_u32 s51, s65, 245760
    buffer_store_dwordx4 v[244:247], v168, s[4:7], s51 offen offset:0 sc1
    buffer_store_dword v244, v169, s[4:7], s51 offen offset:0 sc1
QK_nopf:
    s_add_u32 m0, s90, 16384
    s_add_u32 s50, s99, 1572864
    buffer_load_dwordx4 v149, s[8:11], s50 offen nt lds
    s_add_u32 m0, s90, 17408
    s_add_u32 s50, s99, 1671168
    buffer_load_dwordx4 v149, s[8:11], s50 offen nt lds
    s_add_u32 m0, s90, 18432
    s_add_u32 s50, s99, 1769472
    buffer_load_dwordx4 v149, s[8:11], s50 offen nt lds
    s_add_u32 m0, s90, 19456
    s_add_u32 s50, s99, 1867776
    buffer_load_dwordx4 v149, s[8:11], s50 offen nt lds
    s_add_u32 m0, s90, 20480
    s_add_u32 s50, s99, 1966080
    buffer_load_dwordx4 v149, s[8:11], s50 offen nt lds
    s_add_u32 m0, s90, 21504
    s_add_u32 s50, s99, 2064384
    buffer_load_dwordx4 v149, s[8:11], s50 offen nt lds
    s_add_u32 m0, s90, 22528
    s_add_u32 s50, s99, 2162688
    buffer_load_dwordx4 v149, s[8:11], s50 offen nt lds
    s_add_u32 m0, s90, 23552
    s_add_u32 s50, s99, 2260992
    buffer_load_dwordx4 v149, s[8:11], s50 offen nt lds
    s_add_u32 m0, s90, 24576
    s_add_u32 s50, s99, 2359296
    buffer_load_dwordx4 v149, s[8:11], s50 offen nt lds
    s_add_u32 m0, s90, 25600
    s_add_u32 s50, s99, 2457600
    buffer_load_dwordx4 v149, s[8:11], s50 offen nt lds
    s_add_u32 m0, s90, 26624
    s_add_u32 s50, s99, 2555904
    buffer_load_dwordx4 v149, s[8:11], s50 offen nt lds
    s_add_u32 m0, s90, 27648
    s_add_u32 s50, s99, 2654208
    buffer_load_dwordx4 v149, s[8:11], s50 offen nt lds
    s_add_u32 m0, s90, 28672
    s_add_u32 s50, s99, 2752512
    buffer_load_dwordx4 v149, s[8:11], s50 offen nt lds
    s_add_u32 m0, s90, 29696
    s_add_u32 s50, s99, 2850816
    buffer_load_dwordx4 v149, s[8:11], s50 offen nt lds
    s_add_u32 m0, s90, 30720
    s_add_u32 s50, s99, 2949120
    buffer_load_dwordx4 v149, s[8:11], s50 offen nt lds
    s_add_u32 m0, s90, 31744
    s_add_u32 s50, s99, 3047424
    buffer_load_dwordx4 v149, s[8:11], s50 offen nt lds
    s_add_u32 m0, s90, 32768
    s_add_u32 s50, s99, 3145728
    buffer_load_dwordx4 v149, s[8:11], s50 offen nt lds
    s_add_u32 m0, s90, 33792
    s_add_u32 s50, s99, 3244032
    buffer_load_dwordx4 v149, s[8:11], s50 offen nt lds
    s_add_u32 m0, s90, 34816
    s_add_u32 s50, s99, 3342336
    buffer_load_dwordx4 v149, s[8:11], s50 offen nt lds
    s_add_u32 m0, s90, 35840
    s_add_u32 s50, s99, 3440640
    buffer_load_dwordx4 v149, s[8:11], s50 offen nt lds
    s_add_u32 m0, s90, 36864
    s_add_u32 s50, s99, 3538944
    buffer_load_dwordx4 v149, s[8:11], s50 offen nt lds
    s_add_u32 m0, s90, 37888
    s_add_u32 s50, s99, 3637248
    buffer_load_dwordx4 v149, s[8:11], s50 offen nt lds
    s_add_u32 m0, s90, 38912
    s_add_u32 s50, s99, 3735552
    buffer_load_dwordx4 v149, s[8:11], s50 offen nt lds
    s_add_u32 m0, s90, 39936
    s_add_u32 s50, s99, 3833856
    buffer_load_dwordx4 v149, s[8:11], s50 offen nt lds
    s_waitcnt vmcnt(24)
    s_barrier
    s_getreg_b32 s51, hwreg(HW_REG_XCC_ID)
    s_and_b32 s51, s51, 7
    s_lshl_b32 s51, s51, 3
    s_lshl_b64 s[52:53], 4, s51
    v_mov_b32 v12, s52
    v_mov_b32 v13, s53
    v_mov_b32 v14, 0
    s_lshl_b32 s51, s40, 5
    s_cmp_lg_u32 s42, 3
    s_cbranch_scc1 RG_1
    s_mov_b64 exec, 1
    buffer_atomic_add_x2 v[12:13], v14, s[24:27], s51 offen sc1
    s_mov_b64 exec, -1
RG_1:
    v_lshlrev_b32 v11, 7, v0
    s_mul_i32 s51, s41, 163840
    buffer_load_dword v252, v11, s[36:39], s51 offen
    s_add_u32 s51, s51, 32768
    buffer_load_dword v252, v11, s[36:39], s51 offen
    s_add_u32 s51, s51, 32768
    buffer_load_dword v252, v11, s[36:39], s51 offen
    s_add_u32 s51, s51, 32768
    buffer_load_dword v252, v11, s[36:39], s51 offen
    s_add_u32 s51, s51, 32768
    buffer_load_dword v252, v11, s[36:39], s51 offen
    s_add_u32 s51, s51, 32768
    s_waitcnt vmcnt(5)
    s_barrier
    v_lshrrev_b32 v11, 2, v2
    v_lshl_add_u32 v11, v3, 3, v11
    v_lshlrev_b32 v12, 7, v11
    v_and_b32 v11, 3, v2
    v_lshl_add_u32 v12, v11, 4, v12
    s_mov_b32 s51, 0
    s_cmp_eq_u32 s42, 1
    s_cselect_b32 s51, 64, s51
    s_cmp_eq_u32 s42, 2
    s_cselect_b32 s51, 81920, s51
    s_cmp_eq_u32 s42, 3
    s_cselect_b32 s51, 81984, s51
    v_add_u32 v12, s51, v12
    v_add_u32 v13, 40960, v12
    ds_read_b64_tr_b16 a[0:1], v12 offset:0
    ds_read_b64_tr_b16 a[2:3], v12 offset:512
    ds_read_b64_tr_b16 a[80:81], v12 offset:8
    ds_read_b64_tr_b16 a[82:83], v12 offset:520
    ds_read_b64_tr_b16 a[4:5], v12 offset:4096
    ds_read_b64_tr_b16 a[6:7], v12 offset:4608
    ds_read_b64_tr_b16 a[84:85], v12 offset:4104
    ds_read_b64_tr_b16 a[86:87], v12 offset:4616
    ds_read_b64_tr_b16 a[8:9], v12 offset:8192
    ds_read_b64_tr_b16 a[10:11], v12 offset:8704
    ds_read_b64_tr_b16 a[88:89], v12 offset:8200
    ds_read_b64_tr_b16 a[90:91], v12 offset:8712
    ds_read_b64_tr_b16 a[12:13], v12 offset:12288
    ds_read_b64_tr_b16 a[14:15], v12 offset:12800
    ds_read_b64_tr_b16 a[92:93], v12 offset:12296
    ds_read_b64_tr_b16 a[94:95], v12 offset:12808
    ds_read_b64_tr_b16 a[16:17], v12 offset:16384
    ds_read_b64_tr_b16 a[18:19], v12 offset:16896
    ds_read_b64_tr_b16 a[96:97], v12 offset:16392
    ds_read_b64_tr_b16 a[98:99], v12 offset:16904
    ds_read_b64_tr_b16 a[20:21], v12 offset:20480
    ds_read_b64_tr_b16 a[22:23], v12 offset:20992
    ds_read_b64_tr_b16 a[100:101], v12 offset:20488
    ds_read_b64_tr_b16 a[102:103], v12 offset:21000
    ds_read_b64_tr_b16 a[24:25], v12 offset:24576
    ds_read_b64_tr_b16 a[26:27], v12 offset:25088
    ds_read_b64_tr_b16 a[104:105], v12 offset:24584
    ds_read_b64_tr_b16 a[106:107], v12 offset:25096
    ds_read_b64_tr_b16 a[28:29], v12 offset:28672
    ds_read_b64_tr_b16 a[30:31], v12 offset:29184
    ds_read_b64_tr_b16 a[108:109], v12 offset:28680
    ds_read_b64_tr_b16 a[110:111], v12 offset:29192
    ds_read_b64_tr_b16 a[32:33], v12 offset:32768
    ds_read_b64_tr_b16 a[34:35], v12 offset:33280
    ds_read_b64_tr_b16 a[112:113], v12 offset:32776
    ds_read_b64_tr_b16 a[114:115], v12 offset:33288
    ds_read_b64_tr_b16 a[36:37], v12 offset:36864
    ds_read_b64_tr_b16 a[38:39], v12 offset:37376
    ds_read_b64_tr_b16 a[116:117], v12 offset:36872
    ds_read_b64_tr_b16 a[118:119], v12 offset:37384
    ds_read_b64_tr_b16 a[40:41], v13 offset:0
    ds_read_b64_tr_b16 a[42:43], v13 offset:512
    ds_read_b64_tr_b16 a[120:121], v13 offset:8
    ds_read_b64_tr_b16 a[122:123], v13 offset:520
    ds_read_b64_tr_b16 a[44:45], v13 offset:4096
    ds_read_b64_tr_b16 a[46:47], v13 offset:4608
    ds_read_b64_tr_b16 a[124:125], v13 offset:4104
    ds_read_b64_tr_b16 a[126:127], v13 offset:4616
    ds_read_b64_tr_b16 a[48:49], v13 offset:8192
    ds_read_b64_tr_b16 a[50:51], v13 offset:8704
    ds_read_b64_tr_b16 a[128:129], v13 offset:8200
    ds_read_b64_tr_b16 a[130:131], v13 offset:8712
    ds_read_b64_tr_b16 a[52:53], v13 offset:12288
    ds_read_b64_tr_b16 a[54:55], v13 offset:12800
    ds_read_b64_tr_b16 a[132:133], v13 offset:12296
    ds_read_b64_tr_b16 a[134:135], v13 offset:12808
    ds_read_b64_tr_b16 a[56:57], v13 offset:16384
    ds_read_b64_tr_b16 a[58:59], v13 offset:16896
    ds_read_b64_tr_b16 a[136:137], v13 offset:16392
    ds_read_b64_tr_b16 a[138:139], v13 offset:16904
    ds_read_b64_tr_b16 a[60:61], v13 offset:20480
    ds_read_b64_tr_b16 a[62:63], v13 offset:20992
    ds_read_b64_tr_b16 a[140:141], v13 offset:20488
    ds_read_b64_tr_b16 a[142:143], v13 offset:21000
    ds_read_b64_tr_b16 a[64:65], v13 offset:24576
    ds_read_b64_tr_b16 a[66:67], v13 offset:25088
    ds_read_b64_tr_b16 a[144:145], v13 offset:24584
    ds_read_b64_tr_b16 a[146:147], v13 offset:25096
    ds_read_b64_tr_b16 a[68:69], v13 offset:28672
    ds_read_b64_tr_b16 a[70:71], v13 offset:29184
    ds_read_b64_tr_b16 a[148:149], v13 offset:28680
    ds_read_b64_tr_b16 a[150:151], v13 offset:29192
    ds_read_b64_tr_b16 a[72:73], v13 offset:32768
    ds_read_b64_tr_b16 a[74:75], v13 offset:33280
    ds_read_b64_tr_b16 a[152:153], v13 offset:32776
    ds_read_b64_tr_b16 a[154:155], v13 offset:33288
    ds_read_b64_tr_b16 a[76:77], v13 offset:36864
    ds_read_b64_tr_b16 a[78:79], v13 offset:37376
    ds_read_b64_tr_b16 a[156:157], v13 offset:36872
    ds_read_b64_tr_b16 a[158:159], v13 offset:37384
    v_lshrrev_b32 v11, 1, v1
    s_movk_i32 s51, 3072
    v_mul_lo_u32 v149, v11, s51
    v_and_b32 v11, 1, v1
    v_lshl_add_u32 v149, v11, 4, v149
    s_lshl_b32 s51, s80, 5
    s_waitcnt lgkmcnt(0)
    s_barrier
    s_cmp_gt_u32 s42, 1
    s_cbranch_scc1 QK_now1
    s_add_u32 m0, s90, 0
    s_add_u32 s50, s51, 0
    buffer_load_dwordx4 v149, s[16:19], s50 offen lds
    s_add_u32 m0, s90, 1024
    s_add_u32 s50, s51, 98304
    buffer_load_dwordx4 v149, s[16:19], s50 offen lds
    s_add_u32 m0, s90, 2048
    s_add_u32 s50, s51, 196608
    buffer_load_dwordx4 v149, s[16:19], s50 offen lds
    s_add_u32 m0, s90, 3072
    s_add_u32 s50, s51, 294912
    buffer_load_dwordx4 v149, s[16:19], s50 offen lds
    s_add_u32 m0, s90, 4096
    s_add_u32 s50, s51, 393216
    buffer_load_dwordx4 v149, s[16:19], s50 offen lds
    s_add_u32 m0, s90, 5120
    s_add_u32 s50, s51, 491520
    buffer_load_dwordx4 v149, s[16:19], s50 offen lds
    s_add_u32 m0, s90, 6144
    s_add_u32 s50, s51, 589824
    buffer_load_dwordx4 v149, s[16:19], s50 offen lds
    s_add_u32 m0, s90, 7168
    s_add_u32 s50, s51, 688128
    buffer_load_dwordx4 v149, s[16:19], s50 offen lds
    s_add_u32 m0, s90, 8192
    s_add_u32 s50, s51, 786432
    buffer_load_dwordx4 v149, s[16:19], s50 offen lds
    s_add_u32 m0, s90, 9216
    s_add_u32 s50, s51, 884736
    buffer_load_dwordx4 v149, s[16:19], s50 offen lds
    s_add_u32 m0, s90, 10240
    s_add_u32 s50, s51, 983040
    buffer_load_dwordx4 v149, s[16:19], s50 offen lds
    s_add_u32 m0, s90, 11264
    s_add_u32 s50, s51, 1081344
    buffer_load_dwordx4 v149, s[16:19], s50 offen lds
    s_add_u32 m0, s90, 12288
    s_add_u32 s50, s51, 1179648
    buffer_load_dwordx4 v149, s[16:19], s50 offen lds
    s_add_u32 m0, s90, 13312
    s_add_u32 s50, s51, 1277952
    buffer_load_dwordx4 v149, s[16:19], s50 offen lds
    s_add_u32 m0, s90, 14336
    s_add_u32 s50, s51, 1376256
    buffer_load_dwordx4 v149, s[16:19], s50 offen lds
    s_add_u32 m0, s90, 15360
    s_add_u32 s50, s51, 1474560
    buffer_load_dwordx4 v149, s[16:19], s50 offen lds
    s_add_u32 m0, s90, 16384
    s_add_u32 s50, s51, 1572864
    buffer_load_dwordx4 v149, s[16:19], s50 offen lds
    s_add_u32 m0, s90, 17408
    s_add_u32 s50, s51, 1671168
    buffer_load_dwordx4 v149, s[16:19], s50 offen lds
    s_add_u32 m0, s90, 18432
    s_add_u32 s50, s51, 1769472
    buffer_load_dwordx4 v149, s[16:19], s50 offen lds
    s_add_u32 m0, s90, 19456
    s_add_u32 s50, s51, 1867776
    buffer_load_dwordx4 v149, s[16:19], s50 offen lds
QK_now1:
    v_lshlrev_b32 v11, 3, v3
    buffer_load_dwordx2 v[152:153], v11, s[20:23], s51 offen
    v_subrev_u32 v149, s90, v148
    v_lshrrev_b32 v149, 1, v149
    v_add_u32 v149, s90, v149
    s_waitcnt vmcnt(0)
    ds_read_b64_tr_b16 a[160:161], v149 offset:0
    ds_read_b64_tr_b16 a[162:163], v149 offset:128
    ds_read_b64_tr_b16 a[164:165], v149 offset:1024
    ds_read_b64_tr_b16 a[166:167], v149 offset:1152
    ds_read_b64_tr_b16 a[168:169], v149 offset:2048
    ds_read_b64_tr_b16 a[170:171], v149 offset:2176
    ds_read_b64_tr_b16 a[172:173], v149 offset:3072
    ds_read_b64_tr_b16 a[174:175], v149 offset:3200
    ds_read_b64_tr_b16 a[176:177], v149 offset:4096
    ds_read_b64_tr_b16 a[178:179], v149 offset:4224
    ds_read_b64_tr_b16 a[180:181], v149 offset:5120
    ds_read_b64_tr_b16 a[182:183], v149 offset:5248
    ds_read_b64_tr_b16 a[184:185], v149 offset:6144
    ds_read_b64_tr_b16 a[186:187], v149 offset:6272
    ds_read_b64_tr_b16 a[188:189], v149 offset:7168
    ds_read_b64_tr_b16 a[190:191], v149 offset:7296
    ds_read_b64_tr_b16 a[192:193], v149 offset:8192
    ds_read_b64_tr_b16 a[194:195], v149 offset:8320
    ds_read_b64_tr_b16 a[196:197], v149 offset:9216
    ds_read_b64_tr_b16 a[198:199], v149 offset:9344
    ds_read_b64_tr_b16 a[200:201], v149 offset:10240
    ds_read_b64_tr_b16 a[202:203], v149 offset:10368
    ds_read_b64_tr_b16 a[204:205], v149 offset:11264
    ds_read_b64_tr_b16 a[206:207], v149 offset:11392
    ds_read_b64_tr_b16 a[208:209], v149 offset:12288
    ds_read_b64_tr_b16 a[210:211], v149 offset:12416
    ds_read_b64_tr_b16 a[212:213], v149 offset:13312
    ds_read_b64_tr_b16 a[214:215], v149 offset:13440
    ds_read_b64_tr_b16 a[216:217], v149 offset:14336
    ds_read_b64_tr_b16 a[218:219], v149 offset:14464
    ds_read_b64_tr_b16 a[220:221], v149 offset:15360
    ds_read_b64_tr_b16 a[222:223], v149 offset:15488
    ds_read_b64_tr_b16 a[224:225], v149 offset:16384
    ds_read_b64_tr_b16 a[226:227], v149 offset:16512
    ds_read_b64_tr_b16 a[228:229], v149 offset:17408
    ds_read_b64_tr_b16 a[230:231], v149 offset:17536
    ds_read_b64_tr_b16 a[232:233], v149 offset:18432
    ds_read_b64_tr_b16 a[234:235], v149 offset:18560
    ds_read_b64_tr_b16 a[236:237], v149 offset:19456
    ds_read_b64_tr_b16 a[238:239], v149 offset:19584
    v_lshlrev_b32 v150, 16, v152
    v_and_b32 v151, 0xffff0000, v152
    v_lshlrev_b32 v152, 16, v153
    v_and_b32 v153, 0xffff0000, v153
    s_mul_i32 s51, s41, 3
    s_add_u32 s51, s51, s42
    s_and_b32 s52, s44, 3
    s_add_u32 s52, s52, 36
    s_cmp_eq_u32 s42, 3
    s_cselect_b32 s51, s52, s51
    s_lshl_b32 s79, s51, 8
    s_add_u32 s79, s79, s60
    s_lshr_b32 s52, s51, 1
    s_lshl_b32 s77, s52, 14
    s_and_b32 s51, s51, 1
    s_lshl_b32 s51, s51, 8
    s_add_u32 s77, s77, s51
    s_getreg_b32 s51, hwreg(HW_REG_XCC_ID)
    s_lshr_b32 s51, s51, 2
    s_and_b32 s51, s51, 1
    s_xor_b32 s51, s51, 1
    s_lshl_b32 s51, s51, 13
    s_add_u32 s77, s77, s51
    s_add_u32 s77, s77, 12582912
    s_mov_b64 s[2:3], 0
    v_lshlrev_b32 v240, 4, v2
    v_lshl_add_u32 v240, v3, 10, v240
    v_add_u32 v241, 4096, v240
    v_and_b32 v242, 12, v2
    v_lshrrev_b32 v12, 1, v3
    v_lshl_add_u32 v242, v12, 4, v242
    v_and_b32 v12, 1, v3
    v_lshl_add_u32 v242, v12, 5, v242
    v_and_b32 v12, 3, v2
    v_lshl_add_u32 v242, v12, 6, v242
    s_add_u32 s84, s43, 3
    s_and_b32 s84, s84, 3
    s_add_u32 s85, s43, 4
    s_and_b32 s85, s85, 3
    s_add_u32 s86, s43, 5
    s_and_b32 s86, s86, 3
    s_add_u32 s87, s43, 6
    s_and_b32 s87, s87, 3
    s_mul_i32 s67, s84, s62
    s_add_u32 s67, s67, s61
    s_mul_i32 s68, s86, s62
    s_add_u32 s68, s68, s61
    s_mul_i32 s69, s84, 393216
    s_add_u32 s69, s69, s63
    s_mul_i32 s70, s86, 393216
    s_add_u32 s70, s70, s63
    s_mul_i32 s71, s84, 393216
    s_add_u32 s71, s71, s64
    s_mul_i32 s72, s84, 81920
    s_add_u32 s72, s72, s65
    s_mul_i32 s73, s85, 81920
    s_add_u32 s73, s73, s65
    s_mul_i32 s78, s84, 327680
    s_add_u32 s78, s78, s77
    s_mul_i32 s99, s85, 81920
    s_add_u32 s99, s99, s79
    s_mul_i32 s91, s87, 81920
    s_add_u32 s91, s91, s79
    v_lshlrev_b32 v167, 7, v1
    s_lshl_b32 s51, s41, 13
    v_add_u32 v167, s51, v167
    s_mul_i32 s82, s40, 81920
    s_add_u32 s82, s82, 67108864
    s_mul_i32 s83, s40, 98304
    s_add_u32 s83, s83, 4718592
    s_waitcnt lgkmcnt(0)
    s_waitcnt vmcnt(0)
    s_barrier
    v_mov_b32 v13, 81920
    s_cmp_lg_u32 s42, 1
    s_cbranch_scc1 GWp_5
    s_mov_b64 exec, 1
    s_xor_b32 s97, s77, 0x2000
    s_mov_b32 s96, -1
    s_mov_b32 s47, -1
    s_memtime s[92:93]
    s_waitcnt lgkmcnt(0)
    buffer_load_dword v11, v31, s[4:7], s77 offen offset:512 sc1
    s_waitcnt vmcnt(0)
    s_memtime s[94:95]
    s_waitcnt lgkmcnt(0)
    s_sub_u32 s92, s94, s92
    s_min_u32 s47, s47, s92
    s_memtime s[92:93]
    s_waitcnt lgkmcnt(0)
    buffer_load_dword v11, v31, s[4:7], s97 offen offset:512 sc1
    s_waitcnt vmcnt(0)
    s_memtime s[94:95]
    s_waitcnt lgkmcnt(0)
    s_sub_u32 s92, s94, s92
    s_min_u32 s96, s96, s92
    s_memtime s[92:93]
    s_waitcnt lgkmcnt(0)
    buffer_load_dword v11, v31, s[4:7], s77 offen offset:1536 sc1
    s_waitcnt vmcnt(0)
    s_memtime s[94:95]
    s_waitcnt lgkmcnt(0)
    s_sub_u32 s92, s94, s92
    s_min_u32 s47, s47, s92
    s_memtime s[92:93]
    s_waitcnt lgkmcnt(0)
    buffer_load_dword v11, v31, s[4:7], s97 offen offset:1536 sc1
    s_waitcnt vmcnt(0)
    s_memtime s[94:95]
    s_waitcnt lgkmcnt(0)
    s_sub_u32 s92, s94, s92
    s_min_u32 s96, s96, s92
    s_memtime s[92:93]
    s_waitcnt lgkmcnt(0)
    buffer_load_dword v11, v31, s[4:7], s77 offen offset:2560 sc1
    s_waitcnt vmcnt(0)
    s_memtime s[94:95]
    s_waitcnt lgkmcnt(0)
    s_sub_u32 s92, s94, s92
    s_min_u32 s47, s47, s92
    s_memtime s[92:93]
    s_waitcnt lgkmcnt(0)
    buffer_load_dword v11, v31, s[4:7], s97 offen offset:2560 sc1
    s_waitcnt vmcnt(0)
    s_memtime s[94:95]
    s_waitcnt lgkmcnt(0)
    s_sub_u32 s92, s94, s92
    s_min_u32 s96, s96, s92
    s_memtime s[92:93]
    s_waitcnt lgkmcnt(0)
    buffer_load_dword v11, v31, s[4:7], s77 offen offset:3584 sc1
    s_waitcnt vmcnt(0)
    s_memtime s[94:95]
    s_waitcnt lgkmcnt(0)
    s_sub_u32 s92, s94, s92
    s_min_u32 s47, s47, s92
    s_memtime s[92:93]
    s_waitcnt lgkmcnt(0)
    buffer_load_dword v11, v31, s[4:7], s97 offen offset:3584 sc1
    s_waitcnt vmcnt(0)
    s_memtime s[94:95]
    s_waitcnt lgkmcnt(0)
    s_sub_u32 s92, s94, s92
    s_min_u32 s96, s96, s92
    s_cmp_lt_u32 s96, s47
    s_cselect_b32 s96, 0x2000, 0
    v_mov_b32 v12, s96
    ds_write_b32 v13, v12 offset:4
    s_mov_b64 exec, -1
    s_waitcnt lgkmcnt(0)
GWp_5:
    s_cmp_lg_u32 s42, 0
    s_cbranch_scc1 GWs_4
    s_mov_b32 s47, 0
GW_2:
    buffer_load_dword v12, v31, s[24:27], 0 offen sc1
    s_add_u32 s47, s47, 1
    s_waitcnt vmcnt(0)
    v_sad_u8 v11, v12, 0, 0
    s_nop 1
    v_add_u32_dpp v11, v11, v11 row_ror:8 row_mask:0xf bank_mask:0xf
    s_nop 1
    v_add_u32_dpp v11, v11, v11 row_ror:4 row_mask:0xf bank_mask:0xf
    s_nop 1
    v_add_u32_dpp v11, v11, v11 row_ror:2 row_mask:0xf bank_mask:0xf
    s_nop 1
    v_add_u32_dpp v11, v11, v11 row_ror:1 row_mask:0xf bank_mask:0xf
    v_mov_b32 v14, v11
    s_nop 1
    v_permlane16_swap_b32 v11, v14
    v_add_u32 v11, v11, v14
    v_mov_b32 v14, v11
    s_nop 1
    v_permlane32_swap_b32 v11, v14
    v_add_u32 v11, v11, v14
    v_cmp_ne_u32 vcc, 0x400, v11
    s_cmp_gt_u32 s47, s46
    s_cbranch_vccz GWo_3
    s_sleep 6
    s_cbranch_scc0 GW_2
    s_mov_b32 s46, 0
GWo_3:
    v_and_b32 v12, 0x7f7f7f7f, v12
    v_cmp_ne_u32 vcc, 0, v12
    s_nop 0
    s_cmp_eq_u64 vcc, 0
    s_cselect_b32 s48, 1, 0
    v_mov_b32 v12, s48
    ds_write_b32 v13, v12
    s_waitcnt lgkmcnt(0)
GWs_4:
    s_barrier
    ds_read_b32 v12, v13
    ds_read_b32 v11, v13 offset:4
    s_waitcnt lgkmcnt(0)
    v_readfirstlane_b32 s48, v12
    v_readfirstlane_b32 s96, v11
    s_nop 3
    s_xor_b32 s77, s77, s96
    s_xor_b32 s78, s78, s96
    s_add_u32 m0, s75, 0
    s_add_u32 s49, s74, 0
    buffer_load_dwordx4 v5, s[4:7], s49 offen offset:0 lds
    buffer_load_dwordx4 v5, s[4:7], s49 offen offset:1024 lds
    buffer_load_dwordx4 v5, s[4:7], s49 offen offset:2048 lds
    buffer_load_dwordx4 v5, s[4:7], s49 offen offset:3072 lds
    s_add_u32 m0, s75, 4096
    s_add_u32 s49, s74, 4096
    buffer_load_dwordx4 v5, s[4:7], s49 offen offset:0 lds
    buffer_load_dwordx4 v5, s[4:7], s49 offen offset:1024 lds
    buffer_load_dwordx4 v5, s[4:7], s49 offen offset:2048 lds
    buffer_load_dwordx4 v5, s[4:7], s49 offen offset:3072 lds
    s_add_u32 m0, s75, 8192
    s_add_u32 s49, s74, 8192
    buffer_load_dwordx4 v5, s[4:7], s49 offen offset:0 lds
    buffer_load_dwordx4 v5, s[4:7], s49 offen offset:1024 lds
    s_add_u32 s74, s74, 40960
    s_mul_i32 s49, s42, 20480
    s_add_u32 s49, s49, 40960
    s_sub_u32 s75, s49, s75
    s_waitcnt vmcnt(0)
    s_barrier
    s_cmp_eq_u32 s48, 0
    s_cbranch_scc1 QK_D_s
    s_branch QK_D_f
QK_loop_f:
    s_mov_b32 s47, 0
D_6:
    v_max3_u32 v11, v16, v17, v18
    v_max3_u32 v11, v11, v19, v20
    v_max3_u32 v11, v11, v21, v22
    v_max3_u32 v11, v11, v23, v24
    v_max3_u32 v11, v11, v25, v26
    v_max_u32 v11, v11, v27
    v_cmp_eq_u32 vcc, -1, v11
    s_cbranch_vccz Do_7
    v_max3_u32 v11, v16, v17, v18
    v_max3_u32 v11, v11, v19, v20
    v_max3_u32 v11, v11, v21, v22
    v_max3_u32 v11, v11, v23, v24
    v_max3_u32 v11, v11, v25, v26
    v_max_u32 v11, v11, v27
    v_cmp_eq_u32 vcc, -1, v11
    s_cbranch_vccz Do_7
    s_add_u32 s47, s47, 1
    s_cmp_gt_u32 s47, s46
    v_max3_u32 v12, v16, v17, v18
    v_max_u32 v12, v12, v19
    v_max3_u32 v13, v20, v21, v22
    v_max_u32 v13, v13, v23
    v_max3_u32 v14, v24, v25, v26
    v_max_u32 v14, v14, v27
    v_cmp_eq_u32 vcc, -1, v12
    v_cmp_eq_u32 s[92:93], -1, v13
    v_cmp_eq_u32 s[94:95], -1, v14
    s_mov_b64 exec, vcc
    buffer_load_dwordx4 v[16:19], v6, s[4:7], s66 offen offset:0 sc1
    s_mov_b64 exec, s[92:93]
    buffer_load_dwordx4 v[20:23], v7, s[4:7], s66 offen offset:0 sc1
    s_mov_b64 exec, s[94:95]
    buffer_load_dwordx4 v[24:27], v8, s[4:7], s66 offen offset:0 sc1
    s_mov_b64 exec, -1
    s_cbranch_scc0 D_6
    s_mov_b32 s46, 0
Do_7:
    ds_write_b128 v162, v[16:19]
    ds_write_b128 v163, v[20:23]
    ds_write_b128 v164, v[24:27]
    s_waitcnt lgkmcnt(0)
    s_barrier
    ds_read_b128 v[32:35], v9 offset:0
    ds_read_b128 v[36:39], v9 offset:1024
    ds_read_b128 v[40:43], v9 offset:2048
    ds_read_b128 v[44:47], v9 offset:3072
    ds_read_b128 v[48:51], v9 offset:4096
    ds_read_b128 v[52:55], v9 offset:5120
    ds_read_b128 v[56:59], v9 offset:6144
    ds_read_b128 v[60:63], v9 offset:7168
    ds_read_b128 v[64:67], v9 offset:8192
    ds_read_b128 v[68:71], v9 offset:9216
    s_waitcnt lgkmcnt(9)
    v_smfmac_f32_16x16x64_bf16 v[112:115], v[32:35], a[0:7], v30
    v_smfmac_f32_16x16x64_bf16 v[116:119], v[32:35], a[80:87], v30
    s_waitcnt lgkmcnt(8)
    v_smfmac_f32_16x16x64_bf16 v[112:115], v[36:39], a[8:15], v30
    v_smfmac_f32_16x16x64_bf16 v[116:119], v[36:39], a[88:95], v30
    s_waitcnt lgkmcnt(7)
    v_smfmac_f32_16x16x64_bf16 v[112:115], v[40:43], a[16:23], v30
    v_smfmac_f32_16x16x64_bf16 v[116:119], v[40:43], a[96:103], v30
    s_waitcnt lgkmcnt(6)
    v_smfmac_f32_16x16x64_bf16 v[112:115], v[44:47], a[24:31], v30
    v_smfmac_f32_16x16x64_bf16 v[116:119], v[44:47], a[104:111], v30
    s_waitcnt lgkmcnt(5)
    v_smfmac_f32_16x16x64_bf16 v[112:115], v[48:51], a[32:39], v30
    v_smfmac_f32_16x16x64_bf16 v[116:119], v[48:51], a[112:119], v30
    s_waitcnt lgkmcnt(4)
    v_smfmac_f32_16x16x64_bf16 v[112:115], v[52:55], a[40:47], v30
    v_smfmac_f32_16x16x64_bf16 v[116:119], v[52:55], a[120:127], v30
    s_waitcnt lgkmcnt(3)
    v_smfmac_f32_16x16x64_bf16 v[112:115], v[56:59], a[48:55], v30
    v_smfmac_f32_16x16x64_bf16 v[116:119], v[56:59], a[128:135], v30
    s_waitcnt lgkmcnt(2)
    v_smfmac_f32_16x16x64_bf16 v[112:115], v[60:63], a[56:63], v30
    v_smfmac_f32_16x16x64_bf16 v[116:119], v[60:63], a[136:143], v30
    s_waitcnt lgkmcnt(1)
    v_smfmac_f32_16x16x64_bf16 v[112:115], v[64:67], a[64:71], v30
    v_smfmac_f32_16x16x64_bf16 v[116:119], v[64:67], a[144:151], v30
    s_waitcnt lgkmcnt(0)
    v_smfmac_f32_16x16x64_bf16 v[112:115], v[68:71], a[72:79], v30
    v_smfmac_f32_16x16x64_bf16 v[116:119], v[68:71], a[152:159], v30
    s_nop 6
    v_pk_add_f32 v[112:113], v[112:113], v[114:115]
    v_pk_add_f32 v[116:117], v[116:117], v[118:119]
    v_cvt_pk_bf16_f32 v120, v112, v113
    v_cvt_pk_bf16_f32 v121, v116, v117
    ds_write_b16 v160, v120 offset:0
    ds_write_b16_d16_hi v160, v120 offset:16
    ds_write_b16 v160, v121 offset:8
    ds_write_b16_d16_hi v160, v121 offset:24
    s_waitcnt lgkmcnt(0)
    s_barrier
    ds_read_b128 v[32:35], v154 offset:0
    ds_read_b128 v[36:39], v155 offset:0
    ds_read_b128 v[40:43], v154 offset:1024
    ds_read_b128 v[44:47], v155 offset:1024
    ds_read_b128 v[48:51], v156 offset:0
    ds_read_b128 v[52:55], v157 offset:0
    ds_read_b128 v[56:59], v156 offset:1024
    ds_read_b128 v[60:63], v157 offset:1024
    s_waitcnt lgkmcnt(6)
    v_mfma_f32_16x16x32_bf16 v[124:127], v[32:35], v[36:39], 0
    s_waitcnt lgkmcnt(4)
    v_mfma_f32_16x16x32_bf16 v[124:127], v[40:43], v[44:47], v[124:127]
    s_waitcnt lgkmcnt(2)
    v_mfma_f32_16x16x32_bf16 v[128:131], v[48:51], v[52:55], 0
    s_waitcnt lgkmcnt(0)
    v_mfma_f32_16x16x32_bf16 v[128:131], v[56:59], v[60:63], v[128:131]
    s_mov_b64 exec, s[54:55]
    s_waitcnt vmcnt(0)
    s_nop 1
    v_min_u32 v124, -2, v124
    v_min_u32 v125, -2, v125
    v_min_u32 v126, -2, v126
    v_min_u32 v127, -2, v127
    buffer_store_dwordx4 v[124:127], v158, s[4:7], s67 offen offset:0
    buffer_store_dwordx4 v[244:247], v158, s[4:7], s68 offen offset:0
    s_mov_b64 exec, s[56:57]
    v_min_u32 v128, -2, v128
    v_min_u32 v129, -2, v129
    v_min_u32 v130, -2, v130
    v_min_u32 v131, -2, v131
    buffer_store_dwordx4 v[128:131], v159, s[4:7], s69 offen offset:0
    buffer_store_dwordx4 v[244:247], v159, s[4:7], s70 offen offset:0
    s_mov_b64 exec, -1
    v_xor_b32 v154, 0x4000, v154
    v_xor_b32 v155, 0x4000, v155
    v_xor_b32 v156, 0x4000, v156
    v_xor_b32 v157, 0x4000, v157
    v_xor_b32 v160, 0x4000, v160
    s_cmp_lg_u32 s42, 2
    s_cbranch_scc1 QK_pfe_f
    s_cmp_gt_u32 s41, 4
    s_cbranch_scc1 QK_pf1_f
    s_add_u32 s51, s74, 20480
    buffer_load_dword v175, v167, s[4:7], s51 offen
QK_pf1_f:
    s_sub_u32 s51, s43, s40
    s_sub_u32 s51, s51, 2
    s_cmp_ge_u32 s51, 56
    s_cbranch_scc1 QK_pfe_f
    s_and_b32 s51, s51, 7
    s_cmp_lg_u32 s51, 0
    s_cbranch_scc1 QK_pf2_f
    buffer_load_dword v173, v167, s[4:7], s83 offen
    s_add_u32 s83, s83, 786432
    s_branch QK_pfe_f
QK_pf2_f:
    s_sub_u32 s51, s51, 2
    s_cmp_gt_u32 s51, 3
    s_cbranch_scc1 QK_pfe_f
    s_cmp_gt_u32 s41, 9
    s_cbranch_scc1 QK_pfe_f
    s_mul_i32 s52, s51, 10485760
    s_add_u32 s52, s52, s82
    buffer_load_dword v173, v167, s[4:7], s52 offen
    s_add_u32 s52, s52, 5242880
    buffer_load_dword v174, v167, s[4:7], s52 offen
    s_cmp_eq_u32 s51, 3
    s_cselect_b32 s51, 655360, 0
    s_add_u32 s82, s82, s51
QK_pfe_f:
    s_cmp_lt_u32 s43, 64
    s_cbranch_scc1 QK_D_f
    s_cmp_eq_u32 s81, 0
    s_cbranch_scc1 QK_end_f
    buffer_load_dwordx2 v[184:185], v212, s[4:7], s71 offen offset:0 sc1
    buffer_load_dwordx4 v[176:179], v213, s[4:7], s71 offen offset:0 sc1
    buffer_load_dwordx4 v[180:183], v214, s[4:7], s71 offen offset:0 sc1
    buffer_load_dwordx2 v[196:197], v215, s[4:7], s71 offen offset:0 sc1
    buffer_load_dwordx4 v[188:191], v216, s[4:7], s71 offen offset:0 sc1
    buffer_load_dwordx4 v[192:195], v217, s[4:7], s71 offen offset:0 sc1
    buffer_load_dwordx2 v[208:209], v218, s[4:7], s71 offen offset:0 sc1
    buffer_load_dwordx4 v[200:203], v219, s[4:7], s71 offen offset:0 sc1
    buffer_load_dwordx4 v[204:207], v220, s[4:7], s71 offen offset:0 sc1
    s_branch QK_E_f
QK_D_f:
    s_cmp_gt_u32 s42, 1
    s_cbranch_scc1 QK_g23_f
    s_mul_i32 s51, s42, 20480
    v_add_u32 v15, s51, v10
    ds_read_b128 v[32:35], v15 offset:0
    ds_read_b128 v[36:39], v15 offset:1024
    ds_read_b128 v[40:43], v15 offset:2048
    ds_read_b128 v[44:47], v15 offset:3072
    ds_read_b128 v[48:51], v15 offset:4096
    ds_read_b128 v[52:55], v15 offset:5120
    ds_read_b128 v[56:59], v15 offset:6144
    ds_read_b128 v[60:63], v15 offset:7168
    ds_read_b128 v[64:67], v15 offset:8192
    s_waitcnt lgkmcnt(8)
    v_mfma_f32_16x16x32_bf16 v[136:139], a[160:163], v[32:35], 0
    s_add_u32 m0, s75, 0
    s_add_u32 s49, s74, 0
    buffer_load_dwordx4 v5, s[4:7], s49 offen offset:0 lds
    ds_read_b128 v[68:71], v15 offset:9216
    s_waitcnt lgkmcnt(8)
    v_mfma_f32_16x16x32_bf16 v[136:139], a[164:167], v[36:39], v[136:139]
    ds_read_b128 v[32:35], v15 offset:10240
    s_waitcnt lgkmcnt(8)
    v_mfma_f32_16x16x32_bf16 v[136:139], a[168:171], v[40:43], v[136:139]
    buffer_load_dwordx4 v5, s[4:7], s49 offen offset:1024 lds
    ds_read_b128 v[36:39], v15 offset:11264
    s_waitcnt lgkmcnt(8)
    v_mfma_f32_16x16x32_bf16 v[136:139], a[172:175], v[44:47], v[136:139]
    ds_read_b128 v[40:43], v15 offset:12288
    s_waitcnt lgkmcnt(8)
    v_mfma_f32_16x16x32_bf16 v[136:139], a[176:179], v[48:51], v[136:139]
    buffer_load_dwordx4 v5, s[4:7], s49 offen offset:2048 lds
    ds_read_b128 v[44:47], v15 offset:13312
    s_waitcnt lgkmcnt(8)
    v_mfma_f32_16x16x32_bf16 v[136:139], a[180:183], v[52:55], v[136:139]
    ds_read_b128 v[48:51], v15 offset:14336
    s_waitcnt lgkmcnt(8)
    v_mfma_f32_16x16x32_bf16 v[136:139], a[184:187], v[56:59], v[136:139]
    buffer_load_dwordx4 v5, s[4:7], s49 offen offset:3072 lds
    ds_read_b128 v[52:55], v15 offset:15360
    s_waitcnt lgkmcnt(8)
    v_mfma_f32_16x16x32_bf16 v[136:139], a[188:191], v[60:63], v[136:139]
    ds_read_b128 v[56:59], v15 offset:16384
    s_waitcnt lgkmcnt(8)
    v_mfma_f32_16x16x32_bf16 v[136:139], a[192:195], v[64:67], v[136:139]
    s_add_u32 m0, s75, 4096
    s_add_u32 s49, s74, 4096
    buffer_load_dwordx4 v5, s[4:7], s49 offen offset:0 lds
    ds_read_b128 v[60:63], v15 offset:17408
    s_waitcnt lgkmcnt(8)
    v_mfma_f32_16x16x32_bf16 v[136:139], a[196:199], v[68:71], v[136:139]
    ds_read_b128 v[64:67], v15 offset:18432
    s_waitcnt lgkmcnt(8)
    v_mfma_f32_16x16x32_bf16 v[136:139], a[200:203], v[32:35], v[136:139]
    buffer_load_dwordx4 v5, s[4:7], s49 offen offset:1024 lds
    ds_read_b128 v[68:71], v15 offset:19456
    s_waitcnt lgkmcnt(8)
    v_mfma_f32_16x16x32_bf16 v[136:139], a[204:207], v[36:39], v[136:139]
    s_waitcnt lgkmcnt(7)
    v_mfma_f32_16x16x32_bf16 v[136:139], a[208:211], v[40:43], v[136:139]
    buffer_load_dwordx4 v5, s[4:7], s49 offen offset:2048 lds
    s_waitcnt lgkmcnt(6)
    v_mfma_f32_16x16x32_bf16 v[136:139], a[212:215], v[44:47], v[136:139]
    s_waitcnt lgkmcnt(5)
    v_mfma_f32_16x16x32_bf16 v[136:139], a[216:219], v[48:51], v[136:139]
    buffer_load_dwordx4 v5, s[4:7], s49 offen offset:3072 lds
    s_waitcnt lgkmcnt(4)
    v_mfma_f32_16x16x32_bf16 v[136:139], a[220:223], v[52:55], v[136:139]
    s_waitcnt lgkmcnt(3)
    v_mfma_f32_16x16x32_bf16 v[136:139], a[224:227], v[56:59], v[136:139]
    s_add_u32 m0, s75, 8192
    s_add_u32 s49, s74, 8192
    buffer_load_dwordx4 v5, s[4:7], s49 offen offset:0 lds
    s_waitcnt lgkmcnt(2)
    v_mfma_f32_16x16x32_bf16 v[136:139], a[228:231], v[60:63], v[136:139]
    s_waitcnt lgkmcnt(1)
    v_mfma_f32_16x16x32_bf16 v[136:139], a[232:235], v[64:67], v[136:139]
    buffer_load_dwordx4 v5, s[4:7], s49 offen offset:1024 lds
    s_add_u32 s74, s74, 40960
    s_mul_i32 s49, s42, 20480
    s_add_u32 s49, s49, 40960
    s_sub_u32 s75, s49, s75
    s_waitcnt lgkmcnt(0)
    v_mfma_f32_16x16x32_bf16 v[136:139], a[236:239], v[68:71], v[136:139]
    s_nop 7
    v_cvt_pk_bf16_f32 v11, v136, v137
    v_lshlrev_b32 v136, 16, v11
    v_and_b32 v137, 0xffff0000, v11
    v_add_f32 v136, v136, v150
    v_add_f32 v137, v137, v151
    v_cvt_pk_bf16_f32 v11, v136, v137
    v_lshlrev_b32 v136, 16, v11
    v_and_b32 v137, 0xffff0000, v11
    v_cmp_lt_f32 vcc, 0, v136
    s_nop 1
    v_cndmask_b32 v136, 0, v136, vcc
    v_mul_f32 v136, v136, v136
    v_cmp_lt_f32 vcc, 0, v137
    s_nop 1
    v_cndmask_b32 v137, 0, v137, vcc
    v_mul_f32 v137, v137, v137
    v_cvt_pk_bf16_f32 v140, v136, v137
    v_cvt_pk_bf16_f32 v11, v138, v139
    v_lshlrev_b32 v138, 16, v11
    v_and_b32 v139, 0xffff0000, v11
    v_add_f32 v138, v138, v152
    v_add_f32 v139, v139, v153
    v_cvt_pk_bf16_f32 v11, v138, v139
    v_lshlrev_b32 v138, 16, v11
    v_and_b32 v139, 0xffff0000, v11
    v_cmp_lt_f32 vcc, 0, v138
    s_nop 1
    v_cndmask_b32 v138, 0, v138, vcc
    v_mul_f32 v138, v138, v138
    v_cmp_lt_f32 vcc, 0, v139
    s_nop 1
    v_cndmask_b32 v139, 0, v139, vcc
    v_mul_f32 v139, v139, v139
    v_cvt_pk_bf16_f32 v141, v138, v139
    buffer_store_dwordx2 v[140:141], v5, s[4:7], s76 offen offset:0 sc1
    s_add_u32 s76, s76, 98304
    ds_read_b128 v[32:35], v10 offset:0
    ds_read_b128 v[36:39], v10 offset:1024
    ds_read_b128 v[40:43], v10 offset:2048
    ds_read_b128 v[44:47], v10 offset:3072
    ds_read_b128 v[48:51], v10 offset:4096
    ds_read_b128 v[52:55], v10 offset:5120
    ds_read_b128 v[56:59], v10 offset:6144
    ds_read_b128 v[60:63], v10 offset:7168
    ds_read_b128 v[64:67], v10 offset:8192
    s_waitcnt lgkmcnt(8)
    v_mfma_f32_16x16x32_bf16 v[112:115], a[0:3], v[32:35], 0
    v_mfma_f32_16x16x32_bf16 v[116:119], a[80:83], v[32:35], 0
    v_mov_b32 v176, -1
    v_mov_b32 v177, -1
    v_mov_b32 v178, -1
    v_mov_b32 v179, -1
    ds_read_b128 v[68:71], v10 offset:9216
    s_waitcnt lgkmcnt(8)
    v_mfma_f32_16x16x32_bf16 v[112:115], a[4:7], v[36:39], v[112:115]
    v_mfma_f32_16x16x32_bf16 v[116:119], a[84:87], v[36:39], v[116:119]
    v_mov_b32 v180, -1
    v_mov_b32 v181, -1
    v_mov_b32 v182, -1
    v_mov_b32 v183, -1
    ds_read_b128 v[32:35], v10 offset:10240
    s_waitcnt lgkmcnt(8)
    v_mfma_f32_16x16x32_bf16 v[112:115], a[8:11], v[40:43], v[112:115]
    v_mfma_f32_16x16x32_bf16 v[116:119], a[88:91], v[40:43], v[116:119]
    ds_read_b128 v[36:39], v10 offset:11264
    s_waitcnt lgkmcnt(8)
    v_mfma_f32_16x16x32_bf16 v[112:115], a[12:15], v[44:47], v[112:115]
    v_mfma_f32_16x16x32_bf16 v[116:119], a[92:95], v[44:47], v[116:119]
    ds_read_b128 v[40:43], v10 offset:12288
    s_waitcnt lgkmcnt(8)
    v_mfma_f32_16x16x32_bf16 v[112:115], a[16:19], v[48:51], v[112:115]
    v_mfma_f32_16x16x32_bf16 v[116:119], a[96:99], v[48:51], v[116:119]
    ds_read_b128 v[44:47], v10 offset:13312
    s_waitcnt lgkmcnt(8)
    v_mfma_f32_16x16x32_bf16 v[112:115], a[20:23], v[52:55], v[112:115]
    v_mfma_f32_16x16x32_bf16 v[116:119], a[100:103], v[52:55], v[116:119]
    ds_read_b128 v[48:51], v10 offset:14336
    s_waitcnt lgkmcnt(8)
    v_mfma_f32_16x16x32_bf16 v[112:115], a[24:27], v[56:59], v[112:115]
    v_mfma_f32_16x16x32_bf16 v[116:119], a[104:107], v[56:59], v[116:119]
    ds_read_b128 v[52:55], v10 offset:15360
    s_waitcnt lgkmcnt(8)
    v_mfma_f32_16x16x32_bf16 v[112:115], a[28:31], v[60:63], v[112:115]
    v_mfma_f32_16x16x32_bf16 v[116:119], a[108:111], v[60:63], v[116:119]
    ds_read_b128 v[56:59], v10 offset:16384
    s_waitcnt lgkmcnt(8)
    v_mfma_f32_16x16x32_bf16 v[112:115], a[32:35], v[64:67], v[112:115]
    v_mfma_f32_16x16x32_bf16 v[116:119], a[112:115], v[64:67], v[116:119]
    ds_read_b128 v[60:63], v10 offset:17408
    s_waitcnt lgkmcnt(8)
    v_mfma_f32_16x16x32_bf16 v[112:115], a[36:39], v[68:71], v[112:115]
    v_mfma_f32_16x16x32_bf16 v[116:119], a[116:119], v[68:71], v[116:119]
    ds_read_b128 v[64:67], v10 offset:18432
    s_waitcnt lgkmcnt(8)
    v_mfma_f32_16x16x32_bf16 v[112:115], a[40:43], v[32:35], v[112:115]
    v_mfma_f32_16x16x32_bf16 v[116:119], a[120:123], v[32:35], v[116:119]
    ds_read_b128 v[68:71], v10 offset:19456
    s_waitcnt lgkmcnt(8)
    v_mfma_f32_16x16x32_bf16 v[112:115], a[44:47], v[36:39], v[112:115]
    v_mfma_f32_16x16x32_bf16 v[116:119], a[124:127], v[36:39], v[116:119]
    ds_read_b128 v[32:35], v10 offset:20480
    s_waitcnt lgkmcnt(8)
    v_mfma_f32_16x16x32_bf16 v[112:115], a[48:51], v[40:43], v[112:115]
    v_mfma_f32_16x16x32_bf16 v[116:119], a[128:131], v[40:43], v[116:119]
    ds_read_b128 v[36:39], v10 offset:21504
    s_waitcnt lgkmcnt(8)
    v_mfma_f32_16x16x32_bf16 v[112:115], a[52:55], v[44:47], v[112:115]
    v_mfma_f32_16x16x32_bf16 v[116:119], a[132:135], v[44:47], v[116:119]
    ds_read_b128 v[40:43], v10 offset:22528
    s_waitcnt lgkmcnt(8)
    v_mfma_f32_16x16x32_bf16 v[112:115], a[56:59], v[48:51], v[112:115]
    v_mfma_f32_16x16x32_bf16 v[116:119], a[136:139], v[48:51], v[116:119]
    ds_read_b128 v[44:47], v10 offset:23552
    s_waitcnt lgkmcnt(8)
    v_mfma_f32_16x16x32_bf16 v[112:115], a[60:63], v[52:55], v[112:115]
    v_mfma_f32_16x16x32_bf16 v[116:119], a[140:143], v[52:55], v[116:119]
    ds_read_b128 v[48:51], v10 offset:24576
    s_waitcnt lgkmcnt(8)
    v_mfma_f32_16x16x32_bf16 v[112:115], a[64:67], v[56:59], v[112:115]
    v_mfma_f32_16x16x32_bf16 v[116:119], a[144:147], v[56:59], v[116:119]
    ds_read_b128 v[52:55], v10 offset:25600
    s_waitcnt lgkmcnt(8)
    v_mfma_f32_16x16x32_bf16 v[112:115], a[68:71], v[60:63], v[112:115]
    v_mfma_f32_16x16x32_bf16 v[116:119], a[148:151], v[60:63], v[116:119]
    ds_read_b128 v[56:59], v10 offset:26624
    s_waitcnt lgkmcnt(8)
    v_mfma_f32_16x16x32_bf16 v[112:115], a[72:75], v[64:67], v[112:115]
    v_mfma_f32_16x16x32_bf16 v[116:119], a[152:155], v[64:67], v[116:119]
    ds_read_b128 v[60:63], v10 offset:27648
    s_waitcnt lgkmcnt(8)
    v_mfma_f32_16x16x32_bf16 v[112:115], a[76:79], v[68:71], v[112:115]
    v_mfma_f32_16x16x32_bf16 v[116:119], a[156:159], v[68:71], v[116:119]
    ds_read_b128 v[64:67], v10 offset:28672
    s_waitcnt lgkmcnt(8)
    v_mfma_f32_16x16x32_bf16 v[120:123], a[0:3], v[32:35], 0
    v_mfma_f32_16x16x32_bf16 v[124:127], a[80:83], v[32:35], 0
    ds_read_b128 v[68:71], v10 offset:29696
    s_waitcnt lgkmcnt(8)
    v_mfma_f32_16x16x32_bf16 v[120:123], a[4:7], v[36:39], v[120:123]
    v_mfma_f32_16x16x32_bf16 v[124:127], a[84:87], v[36:39], v[124:127]
    ds_read_b128 v[32:35], v10 offset:30720
    s_waitcnt lgkmcnt(8)
    v_mfma_f32_16x16x32_bf16 v[120:123], a[8:11], v[40:43], v[120:123]
    v_mfma_f32_16x16x32_bf16 v[124:127], a[88:91], v[40:43], v[124:127]
    ds_read_b128 v[36:39], v10 offset:31744
    s_waitcnt lgkmcnt(8)
    v_mfma_f32_16x16x32_bf16 v[120:123], a[12:15], v[44:47], v[120:123]
    v_mfma_f32_16x16x32_bf16 v[124:127], a[92:95], v[44:47], v[124:127]
    ds_read_b128 v[40:43], v10 offset:32768
    s_waitcnt lgkmcnt(8)
    v_mfma_f32_16x16x32_bf16 v[120:123], a[16:19], v[48:51], v[120:123]
    v_mfma_f32_16x16x32_bf16 v[124:127], a[96:99], v[48:51], v[124:127]
    ds_read_b128 v[44:47], v10 offset:33792
    s_waitcnt lgkmcnt(8)
    v_mfma_f32_16x16x32_bf16 v[120:123], a[20:23], v[52:55], v[120:123]
    v_mfma_f32_16x16x32_bf16 v[124:127], a[100:103], v[52:55], v[124:127]
    ds_read_b128 v[48:51], v10 offset:34816
    s_waitcnt lgkmcnt(8)
    v_mfma_f32_16x16x32_bf16 v[120:123], a[24:27], v[56:59], v[120:123]
    v_mfma_f32_16x16x32_bf16 v[124:127], a[104:107], v[56:59], v[124:127]
    ds_read_b128 v[52:55], v10 offset:35840
    s_waitcnt lgkmcnt(8)
    v_mfma_f32_16x16x32_bf16 v[120:123], a[28:31], v[60:63], v[120:123]
    v_mfma_f32_16x16x32_bf16 v[124:127], a[108:111], v[60:63], v[124:127]
    ds_read_b128 v[56:59], v10 offset:36864
    s_waitcnt lgkmcnt(8)
    v_mfma_f32_16x16x32_bf16 v[120:123], a[32:35], v[64:67], v[120:123]
    v_mfma_f32_16x16x32_bf16 v[124:127], a[112:115], v[64:67], v[124:127]
    ds_read_b128 v[60:63], v10 offset:37888
    s_waitcnt lgkmcnt(8)
    v_mfma_f32_16x16x32_bf16 v[120:123], a[36:39], v[68:71], v[120:123]
    v_mfma_f32_16x16x32_bf16 v[124:127], a[116:119], v[68:71], v[124:127]
    ds_read_b128 v[64:67], v10 offset:38912
    s_waitcnt lgkmcnt(8)
    v_mfma_f32_16x16x32_bf16 v[120:123], a[40:43], v[32:35], v[120:123]
    v_mfma_f32_16x16x32_bf16 v[124:127], a[120:123], v[32:35], v[124:127]
    ds_read_b128 v[68:71], v10 offset:39936
    s_waitcnt lgkmcnt(8)
    v_mfma_f32_16x16x32_bf16 v[120:123], a[44:47], v[36:39], v[120:123]
    v_mfma_f32_16x16x32_bf16 v[124:127], a[124:127], v[36:39], v[124:127]
    s_waitcnt lgkmcnt(7)
    v_mfma_f32_16x16x32_bf16 v[120:123], a[48:51], v[40:43], v[120:123]
    v_mfma_f32_16x16x32_bf16 v[124:127], a[128:131], v[40:43], v[124:127]
    s_waitcnt lgkmcnt(6)
    v_mfma_f32_16x16x32_bf16 v[120:123], a[52:55], v[44:47], v[120:123]
    v_mfma_f32_16x16x32_bf16 v[124:127], a[132:135], v[44:47], v[124:127]
    s_waitcnt lgkmcnt(5)
    v_mfma_f32_16x16x32_bf16 v[120:123], a[56:59], v[48:51], v[120:123]
    v_mfma_f32_16x16x32_bf16 v[124:127], a[136:139], v[48:51], v[124:127]
    s_waitcnt lgkmcnt(4)
    v_mfma_f32_16x16x32_bf16 v[120:123], a[60:63], v[52:55], v[120:123]
    v_mfma_f32_16x16x32_bf16 v[124:127], a[140:143], v[52:55], v[124:127]
    s_mov_b64 exec, s[2:3]
    buffer_load_dwordx4 v[176:179], v240, s[4:7], s78 offen offset:0 sc1
    buffer_load_dwordx4 v[180:183], v241, s[4:7], s78 offen offset:0 sc1
    s_mov_b64 exec, -1
    s_waitcnt lgkmcnt(3)
    v_mfma_f32_16x16x32_bf16 v[120:123], a[64:67], v[56:59], v[120:123]
    v_mfma_f32_16x16x32_bf16 v[124:127], a[144:147], v[56:59], v[124:127]
    s_waitcnt lgkmcnt(2)
    v_mfma_f32_16x16x32_bf16 v[120:123], a[68:71], v[60:63], v[120:123]
    v_mfma_f32_16x16x32_bf16 v[124:127], a[148:151], v[60:63], v[124:127]
    s_waitcnt lgkmcnt(1)
    v_mfma_f32_16x16x32_bf16 v[120:123], a[72:75], v[64:67], v[120:123]
    v_mfma_f32_16x16x32_bf16 v[124:127], a[152:155], v[64:67], v[124:127]
    s_waitcnt lgkmcnt(0)
    v_mfma_f32_16x16x32_bf16 v[120:123], a[76:79], v[68:71], v[120:123]
    v_mfma_f32_16x16x32_bf16 v[124:127], a[156:159], v[68:71], v[124:127]
    s_waitcnt vmcnt(2)
    s_nop 5
    s_branch QK_gd_f
QK_g23_f:
    ds_read_b128 v[32:35], v10 offset:0
    ds_read_b128 v[36:39], v10 offset:1024
    ds_read_b128 v[40:43], v10 offset:2048
    ds_read_b128 v[44:47], v10 offset:3072
    ds_read_b128 v[48:51], v10 offset:4096
    ds_read_b128 v[52:55], v10 offset:5120
    ds_read_b128 v[56:59], v10 offset:6144
    ds_read_b128 v[60:63], v10 offset:7168
    ds_read_b128 v[64:67], v10 offset:8192
    s_waitcnt lgkmcnt(8)
    v_mfma_f32_16x16x32_bf16 v[112:115], a[0:3], v[32:35], 0
    v_mfma_f32_16x16x32_bf16 v[116:119], a[80:83], v[32:35], 0
    s_add_u32 m0, s75, 0
    s_add_u32 s49, s74, 0
    buffer_load_dwordx4 v5, s[4:7], s49 offen offset:0 lds
    v_mov_b32 v176, -1
    v_mov_b32 v177, -1
    v_mov_b32 v178, -1
    v_mov_b32 v179, -1
    ds_read_b128 v[68:71], v10 offset:9216
    s_waitcnt lgkmcnt(8)
    v_mfma_f32_16x16x32_bf16 v[112:115], a[4:7], v[36:39], v[112:115]
    v_mfma_f32_16x16x32_bf16 v[116:119], a[84:87], v[36:39], v[116:119]
    v_mov_b32 v180, -1
    v_mov_b32 v181, -1
    v_mov_b32 v182, -1
    v_mov_b32 v183, -1
    ds_read_b128 v[32:35], v10 offset:10240
    s_waitcnt lgkmcnt(8)
    v_mfma_f32_16x16x32_bf16 v[112:115], a[8:11], v[40:43], v[112:115]
    v_mfma_f32_16x16x32_bf16 v[116:119], a[88:91], v[40:43], v[116:119]
    buffer_load_dwordx4 v5, s[4:7], s49 offen offset:1024 lds
    ds_read_b128 v[36:39], v10 offset:11264
    s_waitcnt lgkmcnt(8)
    v_mfma_f32_16x16x32_bf16 v[112:115], a[12:15], v[44:47], v[112:115]
    v_mfma_f32_16x16x32_bf16 v[116:119], a[92:95], v[44:47], v[116:119]
    ds_read_b128 v[40:43], v10 offset:12288
    s_waitcnt lgkmcnt(8)
    v_mfma_f32_16x16x32_bf16 v[112:115], a[16:19], v[48:51], v[112:115]
    v_mfma_f32_16x16x32_bf16 v[116:119], a[96:99], v[48:51], v[116:119]
    buffer_load_dwordx4 v5, s[4:7], s49 offen offset:2048 lds
    ds_read_b128 v[44:47], v10 offset:13312
    s_waitcnt lgkmcnt(8)
    v_mfma_f32_16x16x32_bf16 v[112:115], a[20:23], v[52:55], v[112:115]
    v_mfma_f32_16x16x32_bf16 v[116:119], a[100:103], v[52:55], v[116:119]
    ds_read_b128 v[48:51], v10 offset:14336
    s_waitcnt lgkmcnt(8)
    v_mfma_f32_16x16x32_bf16 v[112:115], a[24:27], v[56:59], v[112:115]
    v_mfma_f32_16x16x32_bf16 v[116:119], a[104:107], v[56:59], v[116:119]
    buffer_load_dwordx4 v5, s[4:7], s49 offen offset:3072 lds
    ds_read_b128 v[52:55], v10 offset:15360
    s_waitcnt lgkmcnt(8)
    v_mfma_f32_16x16x32_bf16 v[112:115], a[28:31], v[60:63], v[112:115]
    v_mfma_f32_16x16x32_bf16 v[116:119], a[108:111], v[60:63], v[116:119]
    ds_read_b128 v[56:59], v10 offset:16384
    s_waitcnt lgkmcnt(8)
    v_mfma_f32_16x16x32_bf16 v[112:115], a[32:35], v[64:67], v[112:115]
    v_mfma_f32_16x16x32_bf16 v[116:119], a[112:115], v[64:67], v[116:119]
    s_add_u32 m0, s75, 4096
    s_add_u32 s49, s74, 4096
    buffer_load_dwordx4 v5, s[4:7], s49 offen offset:0 lds
    ds_read_b128 v[60:63], v10 offset:17408
    s_waitcnt lgkmcnt(8)
    v_mfma_f32_16x16x32_bf16 v[112:115], a[36:39], v[68:71], v[112:115]
    v_mfma_f32_16x16x32_bf16 v[116:119], a[116:119], v[68:71], v[116:119]
    ds_read_b128 v[64:67], v10 offset:18432
    s_waitcnt lgkmcnt(8)
    v_mfma_f32_16x16x32_bf16 v[112:115], a[40:43], v[32:35], v[112:115]
    v_mfma_f32_16x16x32_bf16 v[116:119], a[120:123], v[32:35], v[116:119]
    buffer_load_dwordx4 v5, s[4:7], s49 offen offset:1024 lds
    ds_read_b128 v[68:71], v10 offset:19456
    s_waitcnt lgkmcnt(8)
    v_mfma_f32_16x16x32_bf16 v[112:115], a[44:47], v[36:39], v[112:115]
    v_mfma_f32_16x16x32_bf16 v[116:119], a[124:127], v[36:39], v[116:119]
    ds_read_b128 v[32:35], v10 offset:20480
    s_waitcnt lgkmcnt(8)
    v_mfma_f32_16x16x32_bf16 v[112:115], a[48:51], v[40:43], v[112:115]
    v_mfma_f32_16x16x32_bf16 v[116:119], a[128:131], v[40:43], v[116:119]
    buffer_load_dwordx4 v5, s[4:7], s49 offen offset:2048 lds
    ds_read_b128 v[36:39], v10 offset:21504
    s_waitcnt lgkmcnt(8)
    v_mfma_f32_16x16x32_bf16 v[112:115], a[52:55], v[44:47], v[112:115]
    v_mfma_f32_16x16x32_bf16 v[116:119], a[132:135], v[44:47], v[116:119]
    ds_read_b128 v[40:43], v10 offset:22528
    s_waitcnt lgkmcnt(8)
    v_mfma_f32_16x16x32_bf16 v[112:115], a[56:59], v[48:51], v[112:115]
    v_mfma_f32_16x16x32_bf16 v[116:119], a[136:139], v[48:51], v[116:119]
    buffer_load_dwordx4 v5, s[4:7], s49 offen offset:3072 lds
    ds_read_b128 v[44:47], v10 offset:23552
    s_waitcnt lgkmcnt(8)
    v_mfma_f32_16x16x32_bf16 v[112:115], a[60:63], v[52:55], v[112:115]
    v_mfma_f32_16x16x32_bf16 v[116:119], a[140:143], v[52:55], v[116:119]
    ds_read_b128 v[48:51], v10 offset:24576
    s_waitcnt lgkmcnt(8)
    v_mfma_f32_16x16x32_bf16 v[112:115], a[64:67], v[56:59], v[112:115]
    v_mfma_f32_16x16x32_bf16 v[116:119], a[144:147], v[56:59], v[116:119]
    s_add_u32 m0, s75, 8192
    s_add_u32 s49, s74, 8192
    buffer_load_dwordx4 v5, s[4:7], s49 offen offset:0 lds
    ds_read_b128 v[52:55], v10 offset:25600
    s_waitcnt lgkmcnt(8)
    v_mfma_f32_16x16x32_bf16 v[112:115], a[68:71], v[60:63], v[112:115]
    v_mfma_f32_16x16x32_bf16 v[116:119], a[148:151], v[60:63], v[116:119]
    ds_read_b128 v[56:59], v10 offset:26624
    s_waitcnt lgkmcnt(8)
    v_mfma_f32_16x16x32_bf16 v[112:115], a[72:75], v[64:67], v[112:115]
    v_mfma_f32_16x16x32_bf16 v[116:119], a[152:155], v[64:67], v[116:119]
    buffer_load_dwordx4 v5, s[4:7], s49 offen offset:1024 lds
    s_add_u32 s74, s74, 40960
    s_mul_i32 s49, s42, 20480
    s_add_u32 s49, s49, 40960
    s_sub_u32 s75, s49, s75
    ds_read_b128 v[60:63], v10 offset:27648
    s_waitcnt lgkmcnt(8)
    v_mfma_f32_16x16x32_bf16 v[112:115], a[76:79], v[68:71], v[112:115]
    v_mfma_f32_16x16x32_bf16 v[116:119], a[156:159], v[68:71], v[116:119]
    ds_read_b128 v[64:67], v10 offset:28672
    s_waitcnt lgkmcnt(8)
    v_mfma_f32_16x16x32_bf16 v[120:123], a[0:3], v[32:35], 0
    v_mfma_f32_16x16x32_bf16 v[124:127], a[80:83], v[32:35], 0
    s_cmp_eq_u32 s81, 0
    s_cbranch_scc1 XI_9
    buffer_load_dwordx2 v[184:185], v212, s[4:7], s71 offen offset:0 sc1
    buffer_load_dwordx4 v[176:179], v213, s[4:7], s71 offen offset:0 sc1
    buffer_load_dwordx4 v[180:183], v214, s[4:7], s71 offen offset:0 sc1
    buffer_load_dwordx2 v[196:197], v215, s[4:7], s71 offen offset:0 sc1
    buffer_load_dwordx4 v[188:191], v216, s[4:7], s71 offen offset:0 sc1
    buffer_load_dwordx4 v[192:195], v217, s[4:7], s71 offen offset:0 sc1
    buffer_load_dwordx2 v[208:209], v218, s[4:7], s71 offen offset:0 sc1
    buffer_load_dwordx4 v[200:203], v219, s[4:7], s71 offen offset:0 sc1
    buffer_load_dwordx4 v[204:207], v220, s[4:7], s71 offen offset:0 sc1
XI_9:
    ds_read_b128 v[68:71], v10 offset:29696
    s_waitcnt lgkmcnt(8)
    v_mfma_f32_16x16x32_bf16 v[120:123], a[4:7], v[36:39], v[120:123]
    v_mfma_f32_16x16x32_bf16 v[124:127], a[84:87], v[36:39], v[124:127]
    ds_read_b128 v[32:35], v10 offset:30720
    s_waitcnt lgkmcnt(8)
    v_mfma_f32_16x16x32_bf16 v[120:123], a[8:11], v[40:43], v[120:123]
    v_mfma_f32_16x16x32_bf16 v[124:127], a[88:91], v[40:43], v[124:127]
    ds_read_b128 v[36:39], v10 offset:31744
    s_waitcnt lgkmcnt(8)
    v_mfma_f32_16x16x32_bf16 v[120:123], a[12:15], v[44:47], v[120:123]
    v_mfma_f32_16x16x32_bf16 v[124:127], a[92:95], v[44:47], v[124:127]
    ds_read_b128 v[40:43], v10 offset:32768
    s_waitcnt lgkmcnt(8)
    v_mfma_f32_16x16x32_bf16 v[120:123], a[16:19], v[48:51], v[120:123]
    v_mfma_f32_16x16x32_bf16 v[124:127], a[96:99], v[48:51], v[124:127]
    ds_read_b128 v[44:47], v10 offset:33792
    s_waitcnt lgkmcnt(8)
    v_mfma_f32_16x16x32_bf16 v[120:123], a[20:23], v[52:55], v[120:123]
    v_mfma_f32_16x16x32_bf16 v[124:127], a[100:103], v[52:55], v[124:127]
    ds_read_b128 v[48:51], v10 offset:34816
    s_waitcnt lgkmcnt(8)
    v_mfma_f32_16x16x32_bf16 v[120:123], a[24:27], v[56:59], v[120:123]
    v_mfma_f32_16x16x32_bf16 v[124:127], a[104:107], v[56:59], v[124:127]
    ds_read_b128 v[52:55], v10 offset:35840
    s_waitcnt lgkmcnt(8)
    v_mfma_f32_16x16x32_bf16 v[120:123], a[28:31], v[60:63], v[120:123]
    v_mfma_f32_16x16x32_bf16 v[124:127], a[108:111], v[60:63], v[124:127]
    ds_read_b128 v[56:59], v10 offset:36864
    s_waitcnt lgkmcnt(8)
    v_mfma_f32_16x16x32_bf16 v[120:123], a[32:35], v[64:67], v[120:123]
    v_mfma_f32_16x16x32_bf16 v[124:127], a[112:115], v[64:67], v[124:127]
    ds_read_b128 v[60:63], v10 offset:37888
    s_waitcnt lgkmcnt(8)
    v_mfma_f32_16x16x32_bf16 v[120:123], a[36:39], v[68:71], v[120:123]
    v_mfma_f32_16x16x32_bf16 v[124:127], a[116:119], v[68:71], v[124:127]
    ds_read_b128 v[64:67], v10 offset:38912
    s_waitcnt lgkmcnt(8)
    v_mfma_f32_16x16x32_bf16 v[120:123], a[40:43], v[32:35], v[120:123]
    v_mfma_f32_16x16x32_bf16 v[124:127], a[120:123], v[32:35], v[124:127]
    ds_read_b128 v[68:71], v10 offset:39936
    s_waitcnt lgkmcnt(8)
    v_mfma_f32_16x16x32_bf16 v[120:123], a[44:47], v[36:39], v[120:123]
    v_mfma_f32_16x16x32_bf16 v[124:127], a[124:127], v[36:39], v[124:127]
    s_waitcnt lgkmcnt(7)
    v_mfma_f32_16x16x32_bf16 v[120:123], a[48:51], v[40:43], v[120:123]
    v_mfma_f32_16x16x32_bf16 v[124:127], a[128:131], v[40:43], v[124:127]
    s_waitcnt lgkmcnt(6)
    v_mfma_f32_16x16x32_bf16 v[120:123], a[52:55], v[44:47], v[120:123]
    v_mfma_f32_16x16x32_bf16 v[124:127], a[132:135], v[44:47], v[124:127]
    s_waitcnt lgkmcnt(5)
    v_mfma_f32_16x16x32_bf16 v[120:123], a[56:59], v[48:51], v[120:123]
    v_mfma_f32_16x16x32_bf16 v[124:127], a[136:139], v[48:51], v[124:127]
    s_waitcnt lgkmcnt(4)
    v_mfma_f32_16x16x32_bf16 v[120:123], a[60:63], v[52:55], v[120:123]
    v_mfma_f32_16x16x32_bf16 v[124:127], a[140:143], v[52:55], v[124:127]
    s_waitcnt lgkmcnt(3)
    v_mfma_f32_16x16x32_bf16 v[120:123], a[64:67], v[56:59], v[120:123]
    v_mfma_f32_16x16x32_bf16 v[124:127], a[144:147], v[56:59], v[124:127]
    s_waitcnt lgkmcnt(2)
    v_mfma_f32_16x16x32_bf16 v[120:123], a[68:71], v[60:63], v[120:123]
    v_mfma_f32_16x16x32_bf16 v[124:127], a[148:151], v[60:63], v[124:127]
    s_waitcnt lgkmcnt(1)
    v_mfma_f32_16x16x32_bf16 v[120:123], a[72:75], v[64:67], v[120:123]
    v_mfma_f32_16x16x32_bf16 v[124:127], a[152:155], v[64:67], v[124:127]
    s_waitcnt lgkmcnt(0)
    v_mfma_f32_16x16x32_bf16 v[120:123], a[76:79], v[68:71], v[120:123]
    v_mfma_f32_16x16x32_bf16 v[124:127], a[156:159], v[68:71], v[124:127]
    s_waitcnt vmcnt(0)
    s_cmp_lg_u32 s81, 0
    s_nop 4
    s_cbranch_scc1 QK_gd_f
    s_sleep 4
    s_mov_b64 exec, s[2:3]
    buffer_load_dwordx4 v[176:179], v240, s[4:7], s78 offen offset:0 sc1
    buffer_load_dwordx4 v[180:183], v241, s[4:7], s78 offen offset:0 sc1
    s_mov_b64 exec, -1
QK_gd_f:
    v_cvt_pk_bf16_f32 v128, v112, v113
    v_cvt_pk_bf16_f32 v129, v114, v115
    v_cvt_pk_bf16_f32 v130, v116, v117
    v_cvt_pk_bf16_f32 v131, v118, v119
    v_cvt_pk_bf16_f32 v132, v120, v121
    v_cvt_pk_bf16_f32 v133, v122, v123
    v_cvt_pk_bf16_f32 v134, v124, v125
    v_cvt_pk_bf16_f32 v135, v126, v127
    ds_write_b128 v161, v[128:131]
    ds_write_b128 v161, v[132:135] offset:2048
    v_xor_b32 v161, 0x4000, v161
    v_mov_b32 v16, -1
    v_mov_b32 v17, -1
    v_mov_b32 v18, -1
    v_mov_b32 v19, -1
    v_mov_b32 v20, -1
    v_mov_b32 v21, -1
    v_mov_b32 v22, -1
    v_mov_b32 v23, -1
    v_mov_b32 v24, -1
    v_mov_b32 v25, -1
    v_mov_b32 v26, -1
    v_mov_b32 v27, -1
    v_sub_u32 v11, v10, v5
    v_sub_u32 v11, 40960, v11
    v_add_u32 v10, v11, v5
    s_waitcnt lgkmcnt(0)
    s_cmp_eq_u32 s43, 0
    s_cbranch_scc1 QK_first_f
    s_cmp_lg_u32 s81, 0
    s_cbranch_scc1 QK_E_f
    s_mov_b32 s47, 0
D_10:
    s_waitcnt vmcnt(0)
    v_max3_u32 v11, v176, v177, v178
    v_max3_u32 v11, v11, v179, v180
    v_max3_u32 v11, v11, v181, v182
    v_max_u32 v11, v11, v183
    v_cmp_eq_u32 vcc, -1, v11
    s_cbranch_vccz Do_11
    s_add_u32 s47, s47, 1
    s_cmp_gt_u32 s47, s46
    v_max3_u32 v12, v176, v177, v178
    v_max_u32 v12, v12, v179
    v_max3_u32 v13, v180, v181, v182
    v_max_u32 v13, v13, v183
    v_cmp_eq_u32 vcc, -1, v12
    v_cmp_eq_u32 s[92:93], -1, v13
    s_mov_b64 exec, vcc
    buffer_load_dwordx4 v[176:179], v240, s[4:7], s78 offen offset:0 sc1
    s_mov_b64 exec, s[92:93]
    buffer_load_dwordx4 v[180:183], v241, s[4:7], s78 offen offset:0 sc1
    s_mov_b64 exec, -1
    s_cbranch_scc0 D_10
    s_mov_b32 s46, 0
Do_11:
    v_lshlrev_b32 v192, 16, v176
    v_and_b32 v193, 0xffff0000, v176
    v_lshlrev_b32 v194, 16, v177
    v_and_b32 v195, 0xffff0000, v177
    v_lshlrev_b32 v196, 16, v178
    v_and_b32 v197, 0xffff0000, v178
    v_lshlrev_b32 v198, 16, v179
    v_and_b32 v199, 0xffff0000, v179
    v_lshlrev_b32 v200, 16, v180
    v_and_b32 v201, 0xffff0000, v180
    v_lshlrev_b32 v202, 16, v181
    v_and_b32 v203, 0xffff0000, v181
    v_lshlrev_b32 v204, 16, v182
    v_and_b32 v205, 0xffff0000, v182
    v_lshlrev_b32 v206, 16, v183
    v_and_b32 v207, 0xffff0000, v183
    v_pk_add_f32 v[192:193], v[192:193], v[200:201]
    v_pk_add_f32 v[194:195], v[194:195], v[202:203]
    v_pk_add_f32 v[196:197], v[196:197], v[204:205]
    v_pk_add_f32 v[198:199], v[198:199], v[206:207]
    s_nop 0
    v_permlane32_swap_b32 v192, v196
    v_permlane32_swap_b32 v193, v197
    v_permlane32_swap_b32 v194, v198
    v_permlane32_swap_b32 v195, v199
    v_pk_add_f32 v[192:193], v[192:193], v[196:197]
    v_pk_add_f32 v[194:195], v[194:195], v[198:199]
    s_nop 1
    v_permlane16_swap_b32 v192, v194
    v_permlane16_swap_b32 v193, v195
    v_pk_add_f32 v[192:193], v[192:193], v[194:195]
    v_cvt_pk_bf16_f32 v13, v192, v193
    v_min_u32 v13, -2, v13
    buffer_store_dword v13, v242, s[4:7], s99 offen offset:0
    buffer_store_dword v244, v242, s[4:7], s91 offen offset:0
    s_branch QK_next_f
QK_first_f:
    s_waitcnt vmcnt(0)
    s_cmp_eq_u32 s81, 0
    s_cselect_b64 s[2:3], -1, 0
    s_branch QK_next_f
QK_E_f:
    s_mov_b32 s47, 0
    s_branch Pw_14
P_13:
    buffer_load_dwordx2 v[184:185], v212, s[4:7], s71 offen offset:0 sc1
    buffer_load_dwordx4 v[176:179], v213, s[4:7], s71 offen offset:0 sc1
    buffer_load_dwordx4 v[180:183], v214, s[4:7], s71 offen offset:0 sc1
    buffer_load_dwordx2 v[196:197], v215, s[4:7], s71 offen offset:0 sc1
    buffer_load_dwordx4 v[188:191], v216, s[4:7], s71 offen offset:0 sc1
    buffer_load_dwordx4 v[192:195], v217, s[4:7], s71 offen offset:0 sc1
    buffer_load_dwordx2 v[208:209], v218, s[4:7], s71 offen offset:0 sc1
    buffer_load_dwordx4 v[200:203], v219, s[4:7], s71 offen offset:0 sc1
    buffer_load_dwordx4 v[204:207], v220, s[4:7], s71 offen offset:0 sc1
Pw_14:
    s_add_u32 s47, s47, 1
    s_cmp_gt_u32 s47, s46
    s_waitcnt vmcnt(0)
    v_max3_u32 v11, v184, v185, v176
    v_max3_u32 v11, v11, v177, v178
    v_max3_u32 v11, v11, v179, v180
    v_max3_u32 v11, v11, v181, v182
    v_max3_u32 v11, v11, v183, v196
    v_max3_u32 v11, v11, v197, v188
    v_max3_u32 v11, v11, v189, v190
    v_max3_u32 v11, v11, v191, v192
    v_max3_u32 v11, v11, v193, v194
    v_max3_u32 v11, v11, v195, v208
    v_max3_u32 v11, v11, v209, v200
    v_max3_u32 v11, v11, v201, v202
    v_max3_u32 v11, v11, v203, v204
    v_max3_u32 v11, v11, v205, v206
    v_max_u32 v11, v11, v207
    v_cmp_eq_u32 vcc, -1, v11
    s_cbranch_vccz Po_15
    s_cbranch_scc0 P_13
    s_mov_b32 s46, 0
Po_15:
    v_pk_add_f32 v[176:177], v[176:177], v[188:189]
    v_pk_add_f32 v[178:179], v[178:179], v[190:191]
    v_pk_add_f32 v[180:181], v[180:181], v[192:193]
    v_pk_add_f32 v[182:183], v[182:183], v[194:195]
    v_pk_add_f32 v[184:185], v[184:185], v[196:197]
    v_pk_add_f32 v[176:177], v[176:177], v[200:201]
    v_pk_add_f32 v[178:179], v[178:179], v[202:203]
    v_pk_add_f32 v[180:181], v[180:181], v[204:205]
    v_pk_add_f32 v[182:183], v[182:183], v[206:207]
    v_pk_add_f32 v[184:185], v[184:185], v[208:209]
    v_pk_mul_f32 v[176:177], v[176:177], s[88:89]
    v_pk_mul_f32 v[178:179], v[178:179], s[88:89]
    v_pk_mul_f32 v[180:181], v[180:181], s[88:89]
    v_pk_mul_f32 v[182:183], v[182:183], s[88:89]
    v_pk_mul_f32 v[184:185], v[184:185], s[88:89]
    v_mov_b32 v12, 0xceabfb8f
    v_cmp_le_i32 vcc, 0, v165
    s_nop 1
    v_cndmask_b32 v176, v12, v176, vcc
    v_cmp_le_i32 vcc, 1, v165
    s_nop 1
    v_cndmask_b32 v177, v12, v177, vcc
    v_cmp_le_i32 vcc, 2, v165
    s_nop 1
    v_cndmask_b32 v178, v12, v178, vcc
    v_cmp_le_i32 vcc, 3, v165
    s_nop 1
    v_cndmask_b32 v179, v12, v179, vcc
    v_cmp_le_i32 vcc, 16, v165
    s_nop 1
    v_cndmask_b32 v180, v12, v180, vcc
    v_cmp_le_i32 vcc, 17, v165
    s_nop 1
    v_cndmask_b32 v181, v12, v181, vcc
    v_cmp_le_i32 vcc, 18, v165
    s_nop 1
    v_cndmask_b32 v182, v12, v182, vcc
    v_cmp_le_i32 vcc, 19, v165
    s_nop 1
    v_cndmask_b32 v183, v12, v183, vcc
    v_max3_f32 v11, v176, v177, v178
    v_max3_f32 v11, v11, v179, v180
    v_max3_f32 v11, v11, v181, v182
    v_max3_f32 v11, v11, v183, v184
    v_max_f32 v11, v11, v185
    v_mov_b32 v13, v11
    s_nop 1
    v_permlane16_swap_b32 v11, v13
    v_max_f32 v11, v11, v13
    v_mov_b32 v13, v11
    s_nop 1
    v_permlane32_swap_b32 v11, v13
    v_max_f32 v11, v11, v13
    v_sub_f32 v176, v176, v11
    v_sub_f32 v177, v177, v11
    v_sub_f32 v178, v178, v11
    v_sub_f32 v179, v179, v11
    v_sub_f32 v180, v180, v11
    v_sub_f32 v181, v181, v11
    v_sub_f32 v182, v182, v11
    v_sub_f32 v183, v183, v11
    v_sub_f32 v184, v184, v11
    v_sub_f32 v185, v185, v11
    v_exp_f32 v176, v176
    v_exp_f32 v177, v177
    v_exp_f32 v178, v178
    v_exp_f32 v179, v179
    v_exp_f32 v180, v180
    v_exp_f32 v181, v181
    v_exp_f32 v182, v182
    v_exp_f32 v183, v183
    v_exp_f32 v184, v184
    v_exp_f32 v185, v185
    v_add_f32 v12, v176, v177
    v_add_f32 v12, v12, v178
    v_add_f32 v12, v12, v179
    v_add_f32 v12, v12, v180
    v_add_f32 v12, v12, v181
    v_add_f32 v12, v12, v182
    v_add_f32 v12, v12, v183
    v_add_f32 v12, v12, v184
    v_add_f32 v12, v12, v185
    v_mov_b32 v13, v12
    s_nop 1
    v_permlane16_swap_b32 v12, v13
    v_add_f32 v12, v12, v13
    v_mov_b32 v13, v12
    s_nop 1
    v_permlane32_swap_b32 v12, v13
    v_add_f32 v12, v12, v13
    v_rcp_f32 v12, v12
    s_nop 0
    v_mul_f32 v176, v176, v12
    v_mul_f32 v177, v177, v12
    v_mul_f32 v178, v178, v12
    v_mul_f32 v179, v179, v12
    v_mul_f32 v180, v180, v12
    v_mul_f32 v181, v181, v12
    v_mul_f32 v182, v182, v12
    v_mul_f32 v183, v183, v12
    v_mul_f32 v184, v184, v12
    v_mul_f32 v185, v185, v12
    v_cvt_pk_bf16_f32 v188, v176, v177
    v_cvt_pk_bf16_f32 v189, v178, v179
    v_cvt_pk_bf16_f32 v190, v180, v181
    v_cvt_pk_bf16_f32 v191, v182, v183
    v_cvt_pk_bf16_f32 v192, v184, v185
    v_min_u32 v188, -2, v188
    v_min_u32 v189, -2, v189
    v_min_u32 v190, -2, v190
    v_min_u32 v191, -2, v191
    v_min_u32 v192, -2, v192
    buffer_store_dwordx4 v[188:191], v168, s[4:7], s72 offen offset:0
    buffer_store_dword v192, v169, s[4:7], s72 offen offset:0
    buffer_store_dwordx4 v[244:247], v168, s[4:7], s73 offen offset:0
    buffer_store_dword v244, v169, s[4:7], s73 offen offset:0
QK_next_f:
    s_mul_i32 s66, s85, 81920
    s_add_u32 s66, s66, s60
    buffer_load_dwordx4 v[16:19], v6, s[4:7], s66 offen offset:0 sc1
    buffer_load_dwordx4 v[20:23], v7, s[4:7], s66 offen offset:0 sc1
    buffer_load_dwordx4 v[24:27], v8, s[4:7], s66 offen offset:0 sc1
    s_add_u32 s43, s43, 1
    s_add_u32 s84, s43, 3
    s_and_b32 s84, s84, 3
    s_add_u32 s85, s43, 4
    s_and_b32 s85, s85, 3
    s_add_u32 s86, s43, 5
    s_and_b32 s86, s86, 3
    s_add_u32 s87, s43, 6
    s_and_b32 s87, s87, 3
    s_mul_i32 s67, s84, s62
    s_add_u32 s67, s67, s61
    s_mul_i32 s68, s86, s62
    s_add_u32 s68, s68, s61
    s_mul_i32 s69, s84, 393216
    s_add_u32 s69, s69, s63
    s_mul_i32 s70, s86, 393216
    s_add_u32 s70, s70, s63
    s_mul_i32 s71, s84, 393216
    s_add_u32 s71, s71, s64
    s_mul_i32 s72, s84, 81920
    s_add_u32 s72, s72, s65
    s_mul_i32 s73, s85, 81920
    s_add_u32 s73, s73, s65
    s_mul_i32 s78, s84, 327680
    s_add_u32 s78, s78, s77
    s_mul_i32 s99, s85, 81920
    s_add_u32 s99, s99, s79
    s_mul_i32 s91, s87, 81920
    s_add_u32 s91, s91, s79
    v_mov_b32 v112, 0
    v_mov_b32 v113, 0
    v_mov_b32 v114, 0
    v_mov_b32 v115, 0
    v_mov_b32 v116, 0
    v_mov_b32 v117, 0
    v_mov_b32 v118, 0
    v_mov_b32 v119, 0
    s_cmp_le_u32 s43, 64
    s_cbranch_scc1 QK_loop_f
QK_end_f:
    s_endpgm
QK_loop_s:
    s_mov_b32 s47, 0
D_16:
    v_max3_u32 v11, v16, v17, v18
    v_max3_u32 v11, v11, v19, v20
    v_max3_u32 v11, v11, v21, v22
    v_max3_u32 v11, v11, v23, v24
    v_max3_u32 v11, v11, v25, v26
    v_max_u32 v11, v11, v27
    v_cmp_eq_u32 vcc, -1, v11
    s_cbranch_vccz Do_17
    v_max3_u32 v11, v16, v17, v18
    v_max3_u32 v11, v11, v19, v20
    v_max3_u32 v11, v11, v21, v22
    v_max3_u32 v11, v11, v23, v24
    v_max3_u32 v11, v11, v25, v26
    v_max_u32 v11, v11, v27
    v_cmp_eq_u32 vcc, -1, v11
    s_cbranch_vccz Do_17
    s_add_u32 s47, s47, 1
    s_cmp_gt_u32 s47, s46
    v_max3_u32 v12, v16, v17, v18
    v_max_u32 v12, v12, v19
    v_max3_u32 v13, v20, v21, v22
    v_max_u32 v13, v13, v23
    v_max3_u32 v14, v24, v25, v26
    v_max_u32 v14, v14, v27
    v_cmp_eq_u32 vcc, -1, v12
    v_cmp_eq_u32 s[92:93], -1, v13
    v_cmp_eq_u32 s[94:95], -1, v14
    s_mov_b64 exec, vcc
    buffer_load_dwordx4 v[16:19], v6, s[4:7], s66 offen offset:0 sc1
    s_mov_b64 exec, s[92:93]
    buffer_load_dwordx4 v[20:23], v7, s[4:7], s66 offen offset:0 sc1
    s_mov_b64 exec, s[94:95]
    buffer_load_dwordx4 v[24:27], v8, s[4:7], s66 offen offset:0 sc1
    s_mov_b64 exec, -1
    s_cbranch_scc0 D_16
    s_mov_b32 s46, 0
Do_17:
    ds_write_b128 v162, v[16:19]
    ds_write_b128 v163, v[20:23]
    ds_write_b128 v164, v[24:27]
    s_waitcnt lgkmcnt(0)
    s_barrier
    ds_read_b128 v[32:35], v9 offset:0
    ds_read_b128 v[36:39], v9 offset:1024
    ds_read_b128 v[40:43], v9 offset:2048
    ds_read_b128 v[44:47], v9 offset:3072
    ds_read_b128 v[48:51], v9 offset:4096
    ds_read_b128 v[52:55], v9 offset:5120
    ds_read_b128 v[56:59], v9 offset:6144
    ds_read_b128 v[60:63], v9 offset:7168
    ds_read_b128 v[64:67], v9 offset:8192
    ds_read_b128 v[68:71], v9 offset:9216
    s_waitcnt lgkmcnt(9)
    v_smfmac_f32_16x16x64_bf16 v[112:115], v[32:35], a[0:7], v30
    v_smfmac_f32_16x16x64_bf16 v[116:119], v[32:35], a[80:87], v30
    s_waitcnt lgkmcnt(8)
    v_smfmac_f32_16x16x64_bf16 v[112:115], v[36:39], a[8:15], v30
    v_smfmac_f32_16x16x64_bf16 v[116:119], v[36:39], a[88:95], v30
    s_waitcnt lgkmcnt(7)
    v_smfmac_f32_16x16x64_bf16 v[112:115], v[40:43], a[16:23], v30
    v_smfmac_f32_16x16x64_bf16 v[116:119], v[40:43], a[96:103], v30
    s_waitcnt lgkmcnt(6)
    v_smfmac_f32_16x16x64_bf16 v[112:115], v[44:47], a[24:31], v30
    v_smfmac_f32_16x16x64_bf16 v[116:119], v[44:47], a[104:111], v30
    s_waitcnt lgkmcnt(5)
    v_smfmac_f32_16x16x64_bf16 v[112:115], v[48:51], a[32:39], v30
    v_smfmac_f32_16x16x64_bf16 v[116:119], v[48:51], a[112:119], v30
    s_waitcnt lgkmcnt(4)
    v_smfmac_f32_16x16x64_bf16 v[112:115], v[52:55], a[40:47], v30
    v_smfmac_f32_16x16x64_bf16 v[116:119], v[52:55], a[120:127], v30
    s_waitcnt lgkmcnt(3)
    v_smfmac_f32_16x16x64_bf16 v[112:115], v[56:59], a[48:55], v30
    v_smfmac_f32_16x16x64_bf16 v[116:119], v[56:59], a[128:135], v30
    s_waitcnt lgkmcnt(2)
    v_smfmac_f32_16x16x64_bf16 v[112:115], v[60:63], a[56:63], v30
    v_smfmac_f32_16x16x64_bf16 v[116:119], v[60:63], a[136:143], v30
    s_waitcnt lgkmcnt(1)
    v_smfmac_f32_16x16x64_bf16 v[112:115], v[64:67], a[64:71], v30
    v_smfmac_f32_16x16x64_bf16 v[116:119], v[64:67], a[144:151], v30
    s_waitcnt lgkmcnt(0)
    v_smfmac_f32_16x16x64_bf16 v[112:115], v[68:71], a[72:79], v30
    v_smfmac_f32_16x16x64_bf16 v[116:119], v[68:71], a[152:159], v30
    s_nop 6
    v_pk_add_f32 v[112:113], v[112:113], v[114:115]
    v_pk_add_f32 v[116:117], v[116:117], v[118:119]
    v_cvt_pk_bf16_f32 v120, v112, v113
    v_cvt_pk_bf16_f32 v121, v116, v117
    ds_write_b16 v160, v120 offset:0
    ds_write_b16_d16_hi v160, v120 offset:16
    ds_write_b16 v160, v121 offset:8
    ds_write_b16_d16_hi v160, v121 offset:24
    s_waitcnt lgkmcnt(0)
    s_barrier
    ds_read_b128 v[32:35], v154 offset:0
    ds_read_b128 v[36:39], v155 offset:0
    ds_read_b128 v[40:43], v154 offset:1024
    ds_read_b128 v[44:47], v155 offset:1024
    ds_read_b128 v[48:51], v156 offset:0
    ds_read_b128 v[52:55], v157 offset:0
    ds_read_b128 v[56:59], v156 offset:1024
    ds_read_b128 v[60:63], v157 offset:1024
    s_waitcnt lgkmcnt(6)
    v_mfma_f32_16x16x32_bf16 v[124:127], v[32:35], v[36:39], 0
    s_waitcnt lgkmcnt(4)
    v_mfma_f32_16x16x32_bf16 v[124:127], v[40:43], v[44:47], v[124:127]
    s_waitcnt lgkmcnt(2)
    v_mfma_f32_16x16x32_bf16 v[128:131], v[48:51], v[52:55], 0
    s_waitcnt lgkmcnt(0)
    v_mfma_f32_16x16x32_bf16 v[128:131], v[56:59], v[60:63], v[128:131]
    s_mov_b64 exec, s[54:55]
    s_waitcnt vmcnt(0)
    s_nop 1
    v_min_u32 v124, -2, v124
    v_min_u32 v125, -2, v125
    v_min_u32 v126, -2, v126
    v_min_u32 v127, -2, v127
    buffer_store_dwordx4 v[124:127], v158, s[4:7], s67 offen offset:0 sc1
    buffer_store_dwordx4 v[244:247], v158, s[4:7], s68 offen offset:0 sc1
    s_mov_b64 exec, s[56:57]
    v_min_u32 v128, -2, v128
    v_min_u32 v129, -2, v129
    v_min_u32 v130, -2, v130
    v_min_u32 v131, -2, v131
    buffer_store_dwordx4 v[128:131], v159, s[4:7], s69 offen offset:0 sc1
    buffer_store_dwordx4 v[244:247], v159, s[4:7], s70 offen offset:0 sc1
    s_mov_b64 exec, -1
    v_xor_b32 v154, 0x4000, v154
    v_xor_b32 v155, 0x4000, v155
    v_xor_b32 v156, 0x4000, v156
    v_xor_b32 v157, 0x4000, v157
    v_xor_b32 v160, 0x4000, v160
    s_cmp_lg_u32 s42, 2
    s_cbranch_scc1 QK_pfe_s
    s_cmp_gt_u32 s41, 4
    s_cbranch_scc1 QK_pf1_s
    s_add_u32 s51, s74, 20480
    buffer_load_dword v175, v167, s[4:7], s51 offen
QK_pf1_s:
    s_sub_u32 s51, s43, s40
    s_sub_u32 s51, s51, 2
    s_cmp_ge_u32 s51, 56
    s_cbranch_scc1 QK_pfe_s
    s_and_b32 s51, s51, 7
    s_cmp_lg_u32 s51, 0
    s_cbranch_scc1 QK_pf2_s
    buffer_load_dword v173, v167, s[4:7], s83 offen
    s_add_u32 s83, s83, 786432
    s_branch QK_pfe_s
QK_pf2_s:
    s_sub_u32 s51, s51, 2
    s_cmp_gt_u32 s51, 3
    s_cbranch_scc1 QK_pfe_s
    s_cmp_gt_u32 s41, 9
    s_cbranch_scc1 QK_pfe_s
    s_mul_i32 s52, s51, 10485760
    s_add_u32 s52, s52, s82
    buffer_load_dword v173, v167, s[4:7], s52 offen
    s_add_u32 s52, s52, 5242880
    buffer_load_dword v174, v167, s[4:7], s52 offen
    s_cmp_eq_u32 s51, 3
    s_cselect_b32 s51, 655360, 0
    s_add_u32 s82, s82, s51
QK_pfe_s:
    s_cmp_lt_u32 s43, 64
    s_cbranch_scc1 QK_D_s
    s_cmp_eq_u32 s81, 0
    s_cbranch_scc1 QK_end_s
    buffer_load_dwordx2 v[184:185], v212, s[4:7], s71 offen offset:0 sc1
    buffer_load_dwordx4 v[176:179], v213, s[4:7], s71 offen offset:0 sc1
    buffer_load_dwordx4 v[180:183], v214, s[4:7], s71 offen offset:0 sc1
    buffer_load_dwordx2 v[196:197], v215, s[4:7], s71 offen offset:0 sc1
    buffer_load_dwordx4 v[188:191], v216, s[4:7], s71 offen offset:0 sc1
    buffer_load_dwordx4 v[192:195], v217, s[4:7], s71 offen offset:0 sc1
    buffer_load_dwordx2 v[208:209], v218, s[4:7], s71 offen offset:0 sc1
    buffer_load_dwordx4 v[200:203], v219, s[4:7], s71 offen offset:0 sc1
    buffer_load_dwordx4 v[204:207], v220, s[4:7], s71 offen offset:0 sc1
    s_branch QK_E_s
QK_D_s:
    s_cmp_gt_u32 s42, 1
    s_cbranch_scc1 QK_g23_s
    s_mul_i32 s51, s42, 20480
    v_add_u32 v15, s51, v10
    ds_read_b128 v[32:35], v15 offset:0
    ds_read_b128 v[36:39], v15 offset:1024
    ds_read_b128 v[40:43], v15 offset:2048
    ds_read_b128 v[44:47], v15 offset:3072
    ds_read_b128 v[48:51], v15 offset:4096
    ds_read_b128 v[52:55], v15 offset:5120
    ds_read_b128 v[56:59], v15 offset:6144
    ds_read_b128 v[60:63], v15 offset:7168
    ds_read_b128 v[64:67], v15 offset:8192
    s_waitcnt lgkmcnt(8)
    v_mfma_f32_16x16x32_bf16 v[136:139], a[160:163], v[32:35], 0
    s_add_u32 m0, s75, 0
    s_add_u32 s49, s74, 0
    buffer_load_dwordx4 v5, s[4:7], s49 offen offset:0 lds
    ds_read_b128 v[68:71], v15 offset:9216
    s_waitcnt lgkmcnt(8)
    v_mfma_f32_16x16x32_bf16 v[136:139], a[164:167], v[36:39], v[136:139]
    ds_read_b128 v[32:35], v15 offset:10240
    s_waitcnt lgkmcnt(8)
    v_mfma_f32_16x16x32_bf16 v[136:139], a[168:171], v[40:43], v[136:139]
    buffer_load_dwordx4 v5, s[4:7], s49 offen offset:1024 lds
    ds_read_b128 v[36:39], v15 offset:11264
    s_waitcnt lgkmcnt(8)
    v_mfma_f32_16x16x32_bf16 v[136:139], a[172:175], v[44:47], v[136:139]
    ds_read_b128 v[40:43], v15 offset:12288
    s_waitcnt lgkmcnt(8)
    v_mfma_f32_16x16x32_bf16 v[136:139], a[176:179], v[48:51], v[136:139]
    buffer_load_dwordx4 v5, s[4:7], s49 offen offset:2048 lds
    ds_read_b128 v[44:47], v15 offset:13312
    s_waitcnt lgkmcnt(8)
    v_mfma_f32_16x16x32_bf16 v[136:139], a[180:183], v[52:55], v[136:139]
    ds_read_b128 v[48:51], v15 offset:14336
    s_waitcnt lgkmcnt(8)
    v_mfma_f32_16x16x32_bf16 v[136:139], a[184:187], v[56:59], v[136:139]
    buffer_load_dwordx4 v5, s[4:7], s49 offen offset:3072 lds
    ds_read_b128 v[52:55], v15 offset:15360
    s_waitcnt lgkmcnt(8)
    v_mfma_f32_16x16x32_bf16 v[136:139], a[188:191], v[60:63], v[136:139]
    ds_read_b128 v[56:59], v15 offset:16384
    s_waitcnt lgkmcnt(8)
    v_mfma_f32_16x16x32_bf16 v[136:139], a[192:195], v[64:67], v[136:139]
    s_add_u32 m0, s75, 4096
    s_add_u32 s49, s74, 4096
    buffer_load_dwordx4 v5, s[4:7], s49 offen offset:0 lds
    ds_read_b128 v[60:63], v15 offset:17408
    s_waitcnt lgkmcnt(8)
    v_mfma_f32_16x16x32_bf16 v[136:139], a[196:199], v[68:71], v[136:139]
    ds_read_b128 v[64:67], v15 offset:18432
    s_waitcnt lgkmcnt(8)
    v_mfma_f32_16x16x32_bf16 v[136:139], a[200:203], v[32:35], v[136:139]
    buffer_load_dwordx4 v5, s[4:7], s49 offen offset:1024 lds
    ds_read_b128 v[68:71], v15 offset:19456
    s_waitcnt lgkmcnt(8)
    v_mfma_f32_16x16x32_bf16 v[136:139], a[204:207], v[36:39], v[136:139]
    s_waitcnt lgkmcnt(7)
    v_mfma_f32_16x16x32_bf16 v[136:139], a[208:211], v[40:43], v[136:139]
    buffer_load_dwordx4 v5, s[4:7], s49 offen offset:2048 lds
    s_waitcnt lgkmcnt(6)
    v_mfma_f32_16x16x32_bf16 v[136:139], a[212:215], v[44:47], v[136:139]
    s_waitcnt lgkmcnt(5)
    v_mfma_f32_16x16x32_bf16 v[136:139], a[216:219], v[48:51], v[136:139]
    buffer_load_dwordx4 v5, s[4:7], s49 offen offset:3072 lds
    s_waitcnt lgkmcnt(4)
    v_mfma_f32_16x16x32_bf16 v[136:139], a[220:223], v[52:55], v[136:139]
    s_waitcnt lgkmcnt(3)
    v_mfma_f32_16x16x32_bf16 v[136:139], a[224:227], v[56:59], v[136:139]
    s_add_u32 m0, s75, 8192
    s_add_u32 s49, s74, 8192
    buffer_load_dwordx4 v5, s[4:7], s49 offen offset:0 lds
    s_waitcnt lgkmcnt(2)
    v_mfma_f32_16x16x32_bf16 v[136:139], a[228:231], v[60:63], v[136:139]
    s_waitcnt lgkmcnt(1)
    v_mfma_f32_16x16x32_bf16 v[136:139], a[232:235], v[64:67], v[136:139]
    buffer_load_dwordx4 v5, s[4:7], s49 offen offset:1024 lds
    s_add_u32 s74, s74, 40960
    s_mul_i32 s49, s42, 20480
    s_add_u32 s49, s49, 40960
    s_sub_u32 s75, s49, s75
    s_waitcnt lgkmcnt(0)
    v_mfma_f32_16x16x32_bf16 v[136:139], a[236:239], v[68:71], v[136:139]
    s_nop 7
    v_cvt_pk_bf16_f32 v11, v136, v137
    v_lshlrev_b32 v136, 16, v11
    v_and_b32 v137, 0xffff0000, v11
    v_add_f32 v136, v136, v150
    v_add_f32 v137, v137, v151
    v_cvt_pk_bf16_f32 v11, v136, v137
    v_lshlrev_b32 v136, 16, v11
    v_and_b32 v137, 0xffff0000, v11
    v_cmp_lt_f32 vcc, 0, v136
    s_nop 1
    v_cndmask_b32 v136, 0, v136, vcc
    v_mul_f32 v136, v136, v136
    v_cmp_lt_f32 vcc, 0, v137
    s_nop 1
    v_cndmask_b32 v137, 0, v137, vcc
    v_mul_f32 v137, v137, v137
    v_cvt_pk_bf16_f32 v140, v136, v137
    v_cvt_pk_bf16_f32 v11, v138, v139
    v_lshlrev_b32 v138, 16, v11
    v_and_b32 v139, 0xffff0000, v11
    v_add_f32 v138, v138, v152
    v_add_f32 v139, v139, v153
    v_cvt_pk_bf16_f32 v11, v138, v139
    v_lshlrev_b32 v138, 16, v11
    v_and_b32 v139, 0xffff0000, v11
    v_cmp_lt_f32 vcc, 0, v138
    s_nop 1
    v_cndmask_b32 v138, 0, v138, vcc
    v_mul_f32 v138, v138, v138
    v_cmp_lt_f32 vcc, 0, v139
    s_nop 1
    v_cndmask_b32 v139, 0, v139, vcc
    v_mul_f32 v139, v139, v139
    v_cvt_pk_bf16_f32 v141, v138, v139
    buffer_store_dwordx2 v[140:141], v5, s[4:7], s76 offen offset:0 sc1
    s_add_u32 s76, s76, 98304
    ds_read_b128 v[32:35], v10 offset:0
    ds_read_b128 v[36:39], v10 offset:1024
    ds_read_b128 v[40:43], v10 offset:2048
    ds_read_b128 v[44:47], v10 offset:3072
    ds_read_b128 v[48:51], v10 offset:4096
    ds_read_b128 v[52:55], v10 offset:5120
    ds_read_b128 v[56:59], v10 offset:6144
    ds_read_b128 v[60:63], v10 offset:7168
    ds_read_b128 v[64:67], v10 offset:8192
    s_waitcnt lgkmcnt(8)
    v_mfma_f32_16x16x32_bf16 v[112:115], a[0:3], v[32:35], 0
    v_mfma_f32_16x16x32_bf16 v[116:119], a[80:83], v[32:35], 0
    v_mov_b32 v176, -1
    v_mov_b32 v177, -1
    v_mov_b32 v178, -1
    v_mov_b32 v179, -1
    ds_read_b128 v[68:71], v10 offset:9216
    s_waitcnt lgkmcnt(8)
    v_mfma_f32_16x16x32_bf16 v[112:115], a[4:7], v[36:39], v[112:115]
    v_mfma_f32_16x16x32_bf16 v[116:119], a[84:87], v[36:39], v[116:119]
    v_mov_b32 v180, -1
    v_mov_b32 v181, -1
    v_mov_b32 v182, -1
    v_mov_b32 v183, -1
    ds_read_b128 v[32:35], v10 offset:10240
    s_waitcnt lgkmcnt(8)
    v_mfma_f32_16x16x32_bf16 v[112:115], a[8:11], v[40:43], v[112:115]
    v_mfma_f32_16x16x32_bf16 v[116:119], a[88:91], v[40:43], v[116:119]
    ds_read_b128 v[36:39], v10 offset:11264
    s_waitcnt lgkmcnt(8)
    v_mfma_f32_16x16x32_bf16 v[112:115], a[12:15], v[44:47], v[112:115]
    v_mfma_f32_16x16x32_bf16 v[116:119], a[92:95], v[44:47], v[116:119]
    ds_read_b128 v[40:43], v10 offset:12288
    s_waitcnt lgkmcnt(8)
    v_mfma_f32_16x16x32_bf16 v[112:115], a[16:19], v[48:51], v[112:115]
    v_mfma_f32_16x16x32_bf16 v[116:119], a[96:99], v[48:51], v[116:119]
    ds_read_b128 v[44:47], v10 offset:13312
    s_waitcnt lgkmcnt(8)
    v_mfma_f32_16x16x32_bf16 v[112:115], a[20:23], v[52:55], v[112:115]
    v_mfma_f32_16x16x32_bf16 v[116:119], a[100:103], v[52:55], v[116:119]
    ds_read_b128 v[48:51], v10 offset:14336
    s_waitcnt lgkmcnt(8)
    v_mfma_f32_16x16x32_bf16 v[112:115], a[24:27], v[56:59], v[112:115]
    v_mfma_f32_16x16x32_bf16 v[116:119], a[104:107], v[56:59], v[116:119]
    ds_read_b128 v[52:55], v10 offset:15360
    s_waitcnt lgkmcnt(8)
    v_mfma_f32_16x16x32_bf16 v[112:115], a[28:31], v[60:63], v[112:115]
    v_mfma_f32_16x16x32_bf16 v[116:119], a[108:111], v[60:63], v[116:119]
    ds_read_b128 v[56:59], v10 offset:16384
    s_waitcnt lgkmcnt(8)
    v_mfma_f32_16x16x32_bf16 v[112:115], a[32:35], v[64:67], v[112:115]
    v_mfma_f32_16x16x32_bf16 v[116:119], a[112:115], v[64:67], v[116:119]
    ds_read_b128 v[60:63], v10 offset:17408
    s_waitcnt lgkmcnt(8)
    v_mfma_f32_16x16x32_bf16 v[112:115], a[36:39], v[68:71], v[112:115]
    v_mfma_f32_16x16x32_bf16 v[116:119], a[116:119], v[68:71], v[116:119]
    ds_read_b128 v[64:67], v10 offset:18432
    s_waitcnt lgkmcnt(8)
    v_mfma_f32_16x16x32_bf16 v[112:115], a[40:43], v[32:35], v[112:115]
    v_mfma_f32_16x16x32_bf16 v[116:119], a[120:123], v[32:35], v[116:119]
    ds_read_b128 v[68:71], v10 offset:19456
    s_waitcnt lgkmcnt(8)
    v_mfma_f32_16x16x32_bf16 v[112:115], a[44:47], v[36:39], v[112:115]
    v_mfma_f32_16x16x32_bf16 v[116:119], a[124:127], v[36:39], v[116:119]
    ds_read_b128 v[32:35], v10 offset:20480
    s_waitcnt lgkmcnt(8)
    v_mfma_f32_16x16x32_bf16 v[112:115], a[48:51], v[40:43], v[112:115]
    v_mfma_f32_16x16x32_bf16 v[116:119], a[128:131], v[40:43], v[116:119]
    ds_read_b128 v[36:39], v10 offset:21504
    s_waitcnt lgkmcnt(8)
    v_mfma_f32_16x16x32_bf16 v[112:115], a[52:55], v[44:47], v[112:115]
    v_mfma_f32_16x16x32_bf16 v[116:119], a[132:135], v[44:47], v[116:119]
    ds_read_b128 v[40:43], v10 offset:22528
    s_waitcnt lgkmcnt(8)
    v_mfma_f32_16x16x32_bf16 v[112:115], a[56:59], v[48:51], v[112:115]
    v_mfma_f32_16x16x32_bf16 v[116:119], a[136:139], v[48:51], v[116:119]
    ds_read_b128 v[44:47], v10 offset:23552
    s_waitcnt lgkmcnt(8)
    v_mfma_f32_16x16x32_bf16 v[112:115], a[60:63], v[52:55], v[112:115]
    v_mfma_f32_16x16x32_bf16 v[116:119], a[140:143], v[52:55], v[116:119]
    ds_read_b128 v[48:51], v10 offset:24576
    s_waitcnt lgkmcnt(8)
    v_mfma_f32_16x16x32_bf16 v[112:115], a[64:67], v[56:59], v[112:115]
    v_mfma_f32_16x16x32_bf16 v[116:119], a[144:147], v[56:59], v[116:119]
    ds_read_b128 v[52:55], v10 offset:25600
    s_waitcnt lgkmcnt(8)
    v_mfma_f32_16x16x32_bf16 v[112:115], a[68:71], v[60:63], v[112:115]
    v_mfma_f32_16x16x32_bf16 v[116:119], a[148:151], v[60:63], v[116:119]
    ds_read_b128 v[56:59], v10 offset:26624
    s_waitcnt lgkmcnt(8)
    v_mfma_f32_16x16x32_bf16 v[112:115], a[72:75], v[64:67], v[112:115]
    v_mfma_f32_16x16x32_bf16 v[116:119], a[152:155], v[64:67], v[116:119]
    ds_read_b128 v[60:63], v10 offset:27648
    s_waitcnt lgkmcnt(8)
    v_mfma_f32_16x16x32_bf16 v[112:115], a[76:79], v[68:71], v[112:115]
    v_mfma_f32_16x16x32_bf16 v[116:119], a[156:159], v[68:71], v[116:119]
    ds_read_b128 v[64:67], v10 offset:28672
    s_waitcnt lgkmcnt(8)
    v_mfma_f32_16x16x32_bf16 v[120:123], a[0:3], v[32:35], 0
    v_mfma_f32_16x16x32_bf16 v[124:127], a[80:83], v[32:35], 0
    ds_read_b128 v[68:71], v10 offset:29696
    s_waitcnt lgkmcnt(8)
    v_mfma_f32_16x16x32_bf16 v[120:123], a[4:7], v[36:39], v[120:123]
    v_mfma_f32_16x16x32_bf16 v[124:127], a[84:87], v[36:39], v[124:127]
    ds_read_b128 v[32:35], v10 offset:30720
    s_waitcnt lgkmcnt(8)
    v_mfma_f32_16x16x32_bf16 v[120:123], a[8:11], v[40:43], v[120:123]
    v_mfma_f32_16x16x32_bf16 v[124:127], a[88:91], v[40:43], v[124:127]
    ds_read_b128 v[36:39], v10 offset:31744
    s_waitcnt lgkmcnt(8)
    v_mfma_f32_16x16x32_bf16 v[120:123], a[12:15], v[44:47], v[120:123]
    v_mfma_f32_16x16x32_bf16 v[124:127], a[92:95], v[44:47], v[124:127]
    ds_read_b128 v[40:43], v10 offset:32768
    s_waitcnt lgkmcnt(8)
    v_mfma_f32_16x16x32_bf16 v[120:123], a[16:19], v[48:51], v[120:123]
    v_mfma_f32_16x16x32_bf16 v[124:127], a[96:99], v[48:51], v[124:127]
    ds_read_b128 v[44:47], v10 offset:33792
    s_waitcnt lgkmcnt(8)
    v_mfma_f32_16x16x32_bf16 v[120:123], a[20:23], v[52:55], v[120:123]
    v_mfma_f32_16x16x32_bf16 v[124:127], a[100:103], v[52:55], v[124:127]
    ds_read_b128 v[48:51], v10 offset:34816
    s_waitcnt lgkmcnt(8)
    v_mfma_f32_16x16x32_bf16 v[120:123], a[24:27], v[56:59], v[120:123]
    v_mfma_f32_16x16x32_bf16 v[124:127], a[104:107], v[56:59], v[124:127]
    ds_read_b128 v[52:55], v10 offset:35840
    s_waitcnt lgkmcnt(8)
    v_mfma_f32_16x16x32_bf16 v[120:123], a[28:31], v[60:63], v[120:123]
    v_mfma_f32_16x16x32_bf16 v[124:127], a[108:111], v[60:63], v[124:127]
    ds_read_b128 v[56:59], v10 offset:36864
    s_waitcnt lgkmcnt(8)
    v_mfma_f32_16x16x32_bf16 v[120:123], a[32:35], v[64:67], v[120:123]
    v_mfma_f32_16x16x32_bf16 v[124:127], a[112:115], v[64:67], v[124:127]
    ds_read_b128 v[60:63], v10 offset:37888
    s_waitcnt lgkmcnt(8)
    v_mfma_f32_16x16x32_bf16 v[120:123], a[36:39], v[68:71], v[120:123]
    v_mfma_f32_16x16x32_bf16 v[124:127], a[116:119], v[68:71], v[124:127]
    ds_read_b128 v[64:67], v10 offset:38912
    s_waitcnt lgkmcnt(8)
    v_mfma_f32_16x16x32_bf16 v[120:123], a[40:43], v[32:35], v[120:123]
    v_mfma_f32_16x16x32_bf16 v[124:127], a[120:123], v[32:35], v[124:127]
    ds_read_b128 v[68:71], v10 offset:39936
    s_waitcnt lgkmcnt(8)
    v_mfma_f32_16x16x32_bf16 v[120:123], a[44:47], v[36:39], v[120:123]
    v_mfma_f32_16x16x32_bf16 v[124:127], a[124:127], v[36:39], v[124:127]
    s_waitcnt lgkmcnt(7)
    v_mfma_f32_16x16x32_bf16 v[120:123], a[48:51], v[40:43], v[120:123]
    v_mfma_f32_16x16x32_bf16 v[124:127], a[128:131], v[40:43], v[124:127]
    s_waitcnt lgkmcnt(6)
    v_mfma_f32_16x16x32_bf16 v[120:123], a[52:55], v[44:47], v[120:123]
    v_mfma_f32_16x16x32_bf16 v[124:127], a[132:135], v[44:47], v[124:127]
    s_waitcnt lgkmcnt(5)
    v_mfma_f32_16x16x32_bf16 v[120:123], a[56:59], v[48:51], v[120:123]
    v_mfma_f32_16x16x32_bf16 v[124:127], a[136:139], v[48:51], v[124:127]
    s_waitcnt lgkmcnt(4)
    v_mfma_f32_16x16x32_bf16 v[120:123], a[60:63], v[52:55], v[120:123]
    v_mfma_f32_16x16x32_bf16 v[124:127], a[140:143], v[52:55], v[124:127]
    s_mov_b64 exec, s[2:3]
    buffer_load_dwordx4 v[176:179], v240, s[4:7], s78 offen offset:0 sc1
    buffer_load_dwordx4 v[180:183], v241, s[4:7], s78 offen offset:0 sc1
    s_mov_b64 exec, -1
    s_waitcnt lgkmcnt(3)
    v_mfma_f32_16x16x32_bf16 v[120:123], a[64:67], v[56:59], v[120:123]
    v_mfma_f32_16x16x32_bf16 v[124:127], a[144:147], v[56:59], v[124:127]
    s_waitcnt lgkmcnt(2)
    v_mfma_f32_16x16x32_bf16 v[120:123], a[68:71], v[60:63], v[120:123]
    v_mfma_f32_16x16x32_bf16 v[124:127], a[148:151], v[60:63], v[124:127]
    s_waitcnt lgkmcnt(1)
    v_mfma_f32_16x16x32_bf16 v[120:123], a[72:75], v[64:67], v[120:123]
    v_mfma_f32_16x16x32_bf16 v[124:127], a[152:155], v[64:67], v[124:127]
    s_waitcnt lgkmcnt(0)
    v_mfma_f32_16x16x32_bf16 v[120:123], a[76:79], v[68:71], v[120:123]
    v_mfma_f32_16x16x32_bf16 v[124:127], a[156:159], v[68:71], v[124:127]
    s_waitcnt vmcnt(2)
    s_nop 5
    s_branch QK_gd_s
QK_g23_s:
    ds_read_b128 v[32:35], v10 offset:0
    ds_read_b128 v[36:39], v10 offset:1024
    ds_read_b128 v[40:43], v10 offset:2048
    ds_read_b128 v[44:47], v10 offset:3072
    ds_read_b128 v[48:51], v10 offset:4096
    ds_read_b128 v[52:55], v10 offset:5120
    ds_read_b128 v[56:59], v10 offset:6144
    ds_read_b128 v[60:63], v10 offset:7168
    ds_read_b128 v[64:67], v10 offset:8192
    s_waitcnt lgkmcnt(8)
    v_mfma_f32_16x16x32_bf16 v[112:115], a[0:3], v[32:35], 0
    v_mfma_f32_16x16x32_bf16 v[116:119], a[80:83], v[32:35], 0
    s_add_u32 m0, s75, 0
    s_add_u32 s49, s74, 0
    buffer_load_dwordx4 v5, s[4:7], s49 offen offset:0 lds
    v_mov_b32 v176, -1
    v_mov_b32 v177, -1
    v_mov_b32 v178, -1
    v_mov_b32 v179, -1
    ds_read_b128 v[68:71], v10 offset:9216
    s_waitcnt lgkmcnt(8)
    v_mfma_f32_16x16x32_bf16 v[112:115], a[4:7], v[36:39], v[112:115]
    v_mfma_f32_16x16x32_bf16 v[116:119], a[84:87], v[36:39], v[116:119]
    v_mov_b32 v180, -1
    v_mov_b32 v181, -1
    v_mov_b32 v182, -1
    v_mov_b32 v183, -1
    ds_read_b128 v[32:35], v10 offset:10240
    s_waitcnt lgkmcnt(8)
    v_mfma_f32_16x16x32_bf16 v[112:115], a[8:11], v[40:43], v[112:115]
    v_mfma_f32_16x16x32_bf16 v[116:119], a[88:91], v[40:43], v[116:119]
    buffer_load_dwordx4 v5, s[4:7], s49 offen offset:1024 lds
    ds_read_b128 v[36:39], v10 offset:11264
    s_waitcnt lgkmcnt(8)
    v_mfma_f32_16x16x32_bf16 v[112:115], a[12:15], v[44:47], v[112:115]
    v_mfma_f32_16x16x32_bf16 v[116:119], a[92:95], v[44:47], v[116:119]
    ds_read_b128 v[40:43], v10 offset:12288
    s_waitcnt lgkmcnt(8)
    v_mfma_f32_16x16x32_bf16 v[112:115], a[16:19], v[48:51], v[112:115]
    v_mfma_f32_16x16x32_bf16 v[116:119], a[96:99], v[48:51], v[116:119]
    buffer_load_dwordx4 v5, s[4:7], s49 offen offset:2048 lds
    ds_read_b128 v[44:47], v10 offset:13312
    s_waitcnt lgkmcnt(8)
    v_mfma_f32_16x16x32_bf16 v[112:115], a[20:23], v[52:55], v[112:115]
    v_mfma_f32_16x16x32_bf16 v[116:119], a[100:103], v[52:55], v[116:119]
    ds_read_b128 v[48:51], v10 offset:14336
    s_waitcnt lgkmcnt(8)
    v_mfma_f32_16x16x32_bf16 v[112:115], a[24:27], v[56:59], v[112:115]
    v_mfma_f32_16x16x32_bf16 v[116:119], a[104:107], v[56:59], v[116:119]
    buffer_load_dwordx4 v5, s[4:7], s49 offen offset:3072 lds
    ds_read_b128 v[52:55], v10 offset:15360
    s_waitcnt lgkmcnt(8)
    v_mfma_f32_16x16x32_bf16 v[112:115], a[28:31], v[60:63], v[112:115]
    v_mfma_f32_16x16x32_bf16 v[116:119], a[108:111], v[60:63], v[116:119]
    ds_read_b128 v[56:59], v10 offset:16384
    s_waitcnt lgkmcnt(8)
    v_mfma_f32_16x16x32_bf16 v[112:115], a[32:35], v[64:67], v[112:115]
    v_mfma_f32_16x16x32_bf16 v[116:119], a[112:115], v[64:67], v[116:119]
    s_add_u32 m0, s75, 4096
    s_add_u32 s49, s74, 4096
    buffer_load_dwordx4 v5, s[4:7], s49 offen offset:0 lds
    ds_read_b128 v[60:63], v10 offset:17408
    s_waitcnt lgkmcnt(8)
    v_mfma_f32_16x16x32_bf16 v[112:115], a[36:39], v[68:71], v[112:115]
    v_mfma_f32_16x16x32_bf16 v[116:119], a[116:119], v[68:71], v[116:119]
    ds_read_b128 v[64:67], v10 offset:18432
    s_waitcnt lgkmcnt(8)
    v_mfma_f32_16x16x32_bf16 v[112:115], a[40:43], v[32:35], v[112:115]
    v_mfma_f32_16x16x32_bf16 v[116:119], a[120:123], v[32:35], v[116:119]
    buffer_load_dwordx4 v5, s[4:7], s49 offen offset:1024 lds
    ds_read_b128 v[68:71], v10 offset:19456
    s_waitcnt lgkmcnt(8)
    v_mfma_f32_16x16x32_bf16 v[112:115], a[44:47], v[36:39], v[112:115]
    v_mfma_f32_16x16x32_bf16 v[116:119], a[124:127], v[36:39], v[116:119]
    ds_read_b128 v[32:35], v10 offset:20480
    s_waitcnt lgkmcnt(8)
    v_mfma_f32_16x16x32_bf16 v[112:115], a[48:51], v[40:43], v[112:115]
    v_mfma_f32_16x16x32_bf16 v[116:119], a[128:131], v[40:43], v[116:119]
    buffer_load_dwordx4 v5, s[4:7], s49 offen offset:2048 lds
    ds_read_b128 v[36:39], v10 offset:21504
    s_waitcnt lgkmcnt(8)
    v_mfma_f32_16x16x32_bf16 v[112:115], a[52:55], v[44:47], v[112:115]
    v_mfma_f32_16x16x32_bf16 v[116:119], a[132:135], v[44:47], v[116:119]
    ds_read_b128 v[40:43], v10 offset:22528
    s_waitcnt lgkmcnt(8)
    v_mfma_f32_16x16x32_bf16 v[112:115], a[56:59], v[48:51], v[112:115]
    v_mfma_f32_16x16x32_bf16 v[116:119], a[136:139], v[48:51], v[116:119]
    buffer_load_dwordx4 v5, s[4:7], s49 offen offset:3072 lds
    ds_read_b128 v[44:47], v10 offset:23552
    s_waitcnt lgkmcnt(8)
    v_mfma_f32_16x16x32_bf16 v[112:115], a[60:63], v[52:55], v[112:115]
    v_mfma_f32_16x16x32_bf16 v[116:119], a[140:143], v[52:55], v[116:119]
    ds_read_b128 v[48:51], v10 offset:24576
    s_waitcnt lgkmcnt(8)
    v_mfma_f32_16x16x32_bf16 v[112:115], a[64:67], v[56:59], v[112:115]
    v_mfma_f32_16x16x32_bf16 v[116:119], a[144:147], v[56:59], v[116:119]
    s_add_u32 m0, s75, 8192
    s_add_u32 s49, s74, 8192
    buffer_load_dwordx4 v5, s[4:7], s49 offen offset:0 lds
    ds_read_b128 v[52:55], v10 offset:25600
    s_waitcnt lgkmcnt(8)
    v_mfma_f32_16x16x32_bf16 v[112:115], a[68:71], v[60:63], v[112:115]
    v_mfma_f32_16x16x32_bf16 v[116:119], a[148:151], v[60:63], v[116:119]
    ds_read_b128 v[56:59], v10 offset:26624
    s_waitcnt lgkmcnt(8)
    v_mfma_f32_16x16x32_bf16 v[112:115], a[72:75], v[64:67], v[112:115]
    v_mfma_f32_16x16x32_bf16 v[116:119], a[152:155], v[64:67], v[116:119]
    buffer_load_dwordx4 v5, s[4:7], s49 offen offset:1024 lds
    s_add_u32 s74, s74, 40960
    s_mul_i32 s49, s42, 20480
    s_add_u32 s49, s49, 40960
    s_sub_u32 s75, s49, s75
    ds_read_b128 v[60:63], v10 offset:27648
    s_waitcnt lgkmcnt(8)
    v_mfma_f32_16x16x32_bf16 v[112:115], a[76:79], v[68:71], v[112:115]
    v_mfma_f32_16x16x32_bf16 v[116:119], a[156:159], v[68:71], v[116:119]
    ds_read_b128 v[64:67], v10 offset:28672
    s_waitcnt lgkmcnt(8)
    v_mfma_f32_16x16x32_bf16 v[120:123], a[0:3], v[32:35], 0
    v_mfma_f32_16x16x32_bf16 v[124:127], a[80:83], v[32:35], 0
    s_cmp_eq_u32 s81, 0
    s_cbranch_scc1 XI_19
    buffer_load_dwordx2 v[184:185], v212, s[4:7], s71 offen offset:0 sc1
    buffer_load_dwordx4 v[176:179], v213, s[4:7], s71 offen offset:0 sc1
    buffer_load_dwordx4 v[180:183], v214, s[4:7], s71 offen offset:0 sc1
    buffer_load_dwordx2 v[196:197], v215, s[4:7], s71 offen offset:0 sc1
    buffer_load_dwordx4 v[188:191], v216, s[4:7], s71 offen offset:0 sc1
    buffer_load_dwordx4 v[192:195], v217, s[4:7], s71 offen offset:0 sc1
    buffer_load_dwordx2 v[208:209], v218, s[4:7], s71 offen offset:0 sc1
    buffer_load_dwordx4 v[200:203], v219, s[4:7], s71 offen offset:0 sc1
    buffer_load_dwordx4 v[204:207], v220, s[4:7], s71 offen offset:0 sc1
XI_19:
    ds_read_b128 v[68:71], v10 offset:29696
    s_waitcnt lgkmcnt(8)
    v_mfma_f32_16x16x32_bf16 v[120:123], a[4:7], v[36:39], v[120:123]
    v_mfma_f32_16x16x32_bf16 v[124:127], a[84:87], v[36:39], v[124:127]
    ds_read_b128 v[32:35], v10 offset:30720
    s_waitcnt lgkmcnt(8)
    v_mfma_f32_16x16x32_bf16 v[120:123], a[8:11], v[40:43], v[120:123]
    v_mfma_f32_16x16x32_bf16 v[124:127], a[88:91], v[40:43], v[124:127]
    ds_read_b128 v[36:39], v10 offset:31744
    s_waitcnt lgkmcnt(8)
    v_mfma_f32_16x16x32_bf16 v[120:123], a[12:15], v[44:47], v[120:123]
    v_mfma_f32_16x16x32_bf16 v[124:127], a[92:95], v[44:47], v[124:127]
    ds_read_b128 v[40:43], v10 offset:32768
    s_waitcnt lgkmcnt(8)
    v_mfma_f32_16x16x32_bf16 v[120:123], a[16:19], v[48:51], v[120:123]
    v_mfma_f32_16x16x32_bf16 v[124:127], a[96:99], v[48:51], v[124:127]
    ds_read_b128 v[44:47], v10 offset:33792
    s_waitcnt lgkmcnt(8)
    v_mfma_f32_16x16x32_bf16 v[120:123], a[20:23], v[52:55], v[120:123]
    v_mfma_f32_16x16x32_bf16 v[124:127], a[100:103], v[52:55], v[124:127]
    ds_read_b128 v[48:51], v10 offset:34816
    s_waitcnt lgkmcnt(8)
    v_mfma_f32_16x16x32_bf16 v[120:123], a[24:27], v[56:59], v[120:123]
    v_mfma_f32_16x16x32_bf16 v[124:127], a[104:107], v[56:59], v[124:127]
    ds_read_b128 v[52:55], v10 offset:35840
    s_waitcnt lgkmcnt(8)
    v_mfma_f32_16x16x32_bf16 v[120:123], a[28:31], v[60:63], v[120:123]
    v_mfma_f32_16x16x32_bf16 v[124:127], a[108:111], v[60:63], v[124:127]
    ds_read_b128 v[56:59], v10 offset:36864
    s_waitcnt lgkmcnt(8)
    v_mfma_f32_16x16x32_bf16 v[120:123], a[32:35], v[64:67], v[120:123]
    v_mfma_f32_16x16x32_bf16 v[124:127], a[112:115], v[64:67], v[124:127]
    ds_read_b128 v[60:63], v10 offset:37888
    s_waitcnt lgkmcnt(8)
    v_mfma_f32_16x16x32_bf16 v[120:123], a[36:39], v[68:71], v[120:123]
    v_mfma_f32_16x16x32_bf16 v[124:127], a[116:119], v[68:71], v[124:127]
    ds_read_b128 v[64:67], v10 offset:38912
    s_waitcnt lgkmcnt(8)
    v_mfma_f32_16x16x32_bf16 v[120:123], a[40:43], v[32:35], v[120:123]
    v_mfma_f32_16x16x32_bf16 v[124:127], a[120:123], v[32:35], v[124:127]
    ds_read_b128 v[68:71], v10 offset:39936
    s_waitcnt lgkmcnt(8)
    v_mfma_f32_16x16x32_bf16 v[120:123], a[44:47], v[36:39], v[120:123]
    v_mfma_f32_16x16x32_bf16 v[124:127], a[124:127], v[36:39], v[124:127]
    s_waitcnt lgkmcnt(7)
    v_mfma_f32_16x16x32_bf16 v[120:123], a[48:51], v[40:43], v[120:123]
    v_mfma_f32_16x16x32_bf16 v[124:127], a[128:131], v[40:43], v[124:127]
    s_waitcnt lgkmcnt(6)
    v_mfma_f32_16x16x32_bf16 v[120:123], a[52:55], v[44:47], v[120:123]
    v_mfma_f32_16x16x32_bf16 v[124:127], a[132:135], v[44:47], v[124:127]
    s_waitcnt lgkmcnt(5)
    v_mfma_f32_16x16x32_bf16 v[120:123], a[56:59], v[48:51], v[120:123]
    v_mfma_f32_16x16x32_bf16 v[124:127], a[136:139], v[48:51], v[124:127]
    s_waitcnt lgkmcnt(4)
    v_mfma_f32_16x16x32_bf16 v[120:123], a[60:63], v[52:55], v[120:123]
    v_mfma_f32_16x16x32_bf16 v[124:127], a[140:143], v[52:55], v[124:127]
    s_waitcnt lgkmcnt(3)
    v_mfma_f32_16x16x32_bf16 v[120:123], a[64:67], v[56:59], v[120:123]
    v_mfma_f32_16x16x32_bf16 v[124:127], a[144:147], v[56:59], v[124:127]
    s_waitcnt lgkmcnt(2)
    v_mfma_f32_16x16x32_bf16 v[120:123], a[68:71], v[60:63], v[120:123]
    v_mfma_f32_16x16x32_bf16 v[124:127], a[148:151], v[60:63], v[124:127]
    s_waitcnt lgkmcnt(1)
    v_mfma_f32_16x16x32_bf16 v[120:123], a[72:75], v[64:67], v[120:123]
    v_mfma_f32_16x16x32_bf16 v[124:127], a[152:155], v[64:67], v[124:127]
    s_waitcnt lgkmcnt(0)
    v_mfma_f32_16x16x32_bf16 v[120:123], a[76:79], v[68:71], v[120:123]
    v_mfma_f32_16x16x32_bf16 v[124:127], a[156:159], v[68:71], v[124:127]
    s_waitcnt vmcnt(0)
    s_cmp_lg_u32 s81, 0
    s_nop 4
    s_cbranch_scc1 QK_gd_s
    s_sleep 4
    s_mov_b64 exec, s[2:3]
    buffer_load_dwordx4 v[176:179], v240, s[4:7], s78 offen offset:0 sc1
    buffer_load_dwordx4 v[180:183], v241, s[4:7], s78 offen offset:0 sc1
    s_mov_b64 exec, -1
QK_gd_s:
    v_cvt_pk_bf16_f32 v128, v112, v113
    v_cvt_pk_bf16_f32 v129, v114, v115
    v_cvt_pk_bf16_f32 v130, v116, v117
    v_cvt_pk_bf16_f32 v131, v118, v119
    v_cvt_pk_bf16_f32 v132, v120, v121
    v_cvt_pk_bf16_f32 v133, v122, v123
    v_cvt_pk_bf16_f32 v134, v124, v125
    v_cvt_pk_bf16_f32 v135, v126, v127
    ds_write_b128 v161, v[128:131]
    ds_write_b128 v161, v[132:135] offset:2048
    v_xor_b32 v161, 0x4000, v161
    v_mov_b32 v16, -1
    v_mov_b32 v17, -1
    v_mov_b32 v18, -1
    v_mov_b32 v19, -1
    v_mov_b32 v20, -1
    v_mov_b32 v21, -1
    v_mov_b32 v22, -1
    v_mov_b32 v23, -1
    v_mov_b32 v24, -1
    v_mov_b32 v25, -1
    v_mov_b32 v26, -1
    v_mov_b32 v27, -1
    v_sub_u32 v11, v10, v5
    v_sub_u32 v11, 40960, v11
    v_add_u32 v10, v11, v5
    s_waitcnt lgkmcnt(0)
    s_cmp_eq_u32 s43, 0
    s_cbranch_scc1 QK_first_s
    s_cmp_lg_u32 s81, 0
    s_cbranch_scc1 QK_E_s
    s_mov_b32 s47, 0
D_20:
    s_waitcnt vmcnt(0)
    v_max3_u32 v11, v176, v177, v178
    v_max3_u32 v11, v11, v179, v180
    v_max3_u32 v11, v11, v181, v182
    v_max_u32 v11, v11, v183
    v_cmp_eq_u32 vcc, -1, v11
    s_cbranch_vccz Do_21
    s_add_u32 s47, s47, 1
    s_cmp_gt_u32 s47, s46
    v_max3_u32 v12, v176, v177, v178
    v_max_u32 v12, v12, v179
    v_max3_u32 v13, v180, v181, v182
    v_max_u32 v13, v13, v183
    v_cmp_eq_u32 vcc, -1, v12
    v_cmp_eq_u32 s[92:93], -1, v13
    s_mov_b64 exec, vcc
    buffer_load_dwordx4 v[176:179], v240, s[4:7], s78 offen offset:0 sc1
    s_mov_b64 exec, s[92:93]
    buffer_load_dwordx4 v[180:183], v241, s[4:7], s78 offen offset:0 sc1
    s_mov_b64 exec, -1
    s_cbranch_scc0 D_20
    s_mov_b32 s46, 0
Do_21:
    v_lshlrev_b32 v192, 16, v176
    v_and_b32 v193, 0xffff0000, v176
    v_lshlrev_b32 v194, 16, v177
    v_and_b32 v195, 0xffff0000, v177
    v_lshlrev_b32 v196, 16, v178
    v_and_b32 v197, 0xffff0000, v178
    v_lshlrev_b32 v198, 16, v179
    v_and_b32 v199, 0xffff0000, v179
    v_lshlrev_b32 v200, 16, v180
    v_and_b32 v201, 0xffff0000, v180
    v_lshlrev_b32 v202, 16, v181
    v_and_b32 v203, 0xffff0000, v181
    v_lshlrev_b32 v204, 16, v182
    v_and_b32 v205, 0xffff0000, v182
    v_lshlrev_b32 v206, 16, v183
    v_and_b32 v207, 0xffff0000, v183
    v_pk_add_f32 v[192:193], v[192:193], v[200:201]
    v_pk_add_f32 v[194:195], v[194:195], v[202:203]
    v_pk_add_f32 v[196:197], v[196:197], v[204:205]
    v_pk_add_f32 v[198:199], v[198:199], v[206:207]
    s_nop 0
    v_permlane32_swap_b32 v192, v196
    v_permlane32_swap_b32 v193, v197
    v_permlane32_swap_b32 v194, v198
    v_permlane32_swap_b32 v195, v199
    v_pk_add_f32 v[192:193], v[192:193], v[196:197]
    v_pk_add_f32 v[194:195], v[194:195], v[198:199]
    s_nop 1
    v_permlane16_swap_b32 v192, v194
    v_permlane16_swap_b32 v193, v195
    v_pk_add_f32 v[192:193], v[192:193], v[194:195]
    v_cvt_pk_bf16_f32 v13, v192, v193
    v_min_u32 v13, -2, v13
    buffer_store_dword v13, v242, s[4:7], s99 offen offset:0 sc1
    buffer_store_dword v244, v242, s[4:7], s91 offen offset:0 sc1
    s_branch QK_next_s
QK_first_s:
    s_waitcnt vmcnt(0)
    s_cmp_eq_u32 s81, 0
    s_cselect_b64 s[2:3], -1, 0
    s_branch QK_next_s
QK_E_s:
    s_mov_b32 s47, 0
    s_branch Pw_24
P_23:
    buffer_load_dwordx2 v[184:185], v212, s[4:7], s71 offen offset:0 sc1
    buffer_load_dwordx4 v[176:179], v213, s[4:7], s71 offen offset:0 sc1
    buffer_load_dwordx4 v[180:183], v214, s[4:7], s71 offen offset:0 sc1
    buffer_load_dwordx2 v[196:197], v215, s[4:7], s71 offen offset:0 sc1
    buffer_load_dwordx4 v[188:191], v216, s[4:7], s71 offen offset:0 sc1
    buffer_load_dwordx4 v[192:195], v217, s[4:7], s71 offen offset:0 sc1
    buffer_load_dwordx2 v[208:209], v218, s[4:7], s71 offen offset:0 sc1
    buffer_load_dwordx4 v[200:203], v219, s[4:7], s71 offen offset:0 sc1
    buffer_load_dwordx4 v[204:207], v220, s[4:7], s71 offen offset:0 sc1
Pw_24:
    s_add_u32 s47, s47, 1
    s_cmp_gt_u32 s47, s46
    s_waitcnt vmcnt(0)
    v_max3_u32 v11, v184, v185, v176
    v_max3_u32 v11, v11, v177, v178
    v_max3_u32 v11, v11, v179, v180
    v_max3_u32 v11, v11, v181, v182
    v_max3_u32 v11, v11, v183, v196
    v_max3_u32 v11, v11, v197, v188
    v_max3_u32 v11, v11, v189, v190
    v_max3_u32 v11, v11, v191, v192
    v_max3_u32 v11, v11, v193, v194
    v_max3_u32 v11, v11, v195, v208
    v_max3_u32 v11, v11, v209, v200
    v_max3_u32 v11, v11, v201, v202
    v_max3_u32 v11, v11, v203, v204
    v_max3_u32 v11, v11, v205, v206
    v_max_u32 v11, v11, v207
    v_cmp_eq_u32 vcc, -1, v11
    s_cbranch_vccz Po_25
    s_cbranch_scc0 P_23
    s_mov_b32 s46, 0
Po_25:
    v_pk_add_f32 v[176:177], v[176:177], v[188:189]
    v_pk_add_f32 v[178:179], v[178:179], v[190:191]
    v_pk_add_f32 v[180:181], v[180:181], v[192:193]
    v_pk_add_f32 v[182:183], v[182:183], v[194:195]
    v_pk_add_f32 v[184:185], v[184:185], v[196:197]
    v_pk_add_f32 v[176:177], v[176:177], v[200:201]
    v_pk_add_f32 v[178:179], v[178:179], v[202:203]
    v_pk_add_f32 v[180:181], v[180:181], v[204:205]
    v_pk_add_f32 v[182:183], v[182:183], v[206:207]
    v_pk_add_f32 v[184:185], v[184:185], v[208:209]
    v_pk_mul_f32 v[176:177], v[176:177], s[88:89]
    v_pk_mul_f32 v[178:179], v[178:179], s[88:89]
    v_pk_mul_f32 v[180:181], v[180:181], s[88:89]
    v_pk_mul_f32 v[182:183], v[182:183], s[88:89]
    v_pk_mul_f32 v[184:185], v[184:185], s[88:89]
    v_mov_b32 v12, 0xceabfb8f
    v_cmp_le_i32 vcc, 0, v165
    s_nop 1
    v_cndmask_b32 v176, v12, v176, vcc
    v_cmp_le_i32 vcc, 1, v165
    s_nop 1
    v_cndmask_b32 v177, v12, v177, vcc
    v_cmp_le_i32 vcc, 2, v165
    s_nop 1
    v_cndmask_b32 v178, v12, v178, vcc
    v_cmp_le_i32 vcc, 3, v165
    s_nop 1
    v_cndmask_b32 v179, v12, v179, vcc
    v_cmp_le_i32 vcc, 16, v165
    s_nop 1
    v_cndmask_b32 v180, v12, v180, vcc
    v_cmp_le_i32 vcc, 17, v165
    s_nop 1
    v_cndmask_b32 v181, v12, v181, vcc
    v_cmp_le_i32 vcc, 18, v165
    s_nop 1
    v_cndmask_b32 v182, v12, v182, vcc
    v_cmp_le_i32 vcc, 19, v165
    s_nop 1
    v_cndmask_b32 v183, v12, v183, vcc
    v_max3_f32 v11, v176, v177, v178
    v_max3_f32 v11, v11, v179, v180
    v_max3_f32 v11, v11, v181, v182
    v_max3_f32 v11, v11, v183, v184
    v_max_f32 v11, v11, v185
    v_mov_b32 v13, v11
    s_nop 1
    v_permlane16_swap_b32 v11, v13
    v_max_f32 v11, v11, v13
    v_mov_b32 v13, v11
    s_nop 1
    v_permlane32_swap_b32 v11, v13
    v_max_f32 v11, v11, v13
    v_sub_f32 v176, v176, v11
    v_sub_f32 v177, v177, v11
    v_sub_f32 v178, v178, v11
    v_sub_f32 v179, v179, v11
    v_sub_f32 v180, v180, v11
    v_sub_f32 v181, v181, v11
    v_sub_f32 v182, v182, v11
    v_sub_f32 v183, v183, v11
    v_sub_f32 v184, v184, v11
    v_sub_f32 v185, v185, v11
    v_exp_f32 v176, v176
    v_exp_f32 v177, v177
    v_exp_f32 v178, v178
    v_exp_f32 v179, v179
    v_exp_f32 v180, v180
    v_exp_f32 v181, v181
    v_exp_f32 v182, v182
    v_exp_f32 v183, v183
    v_exp_f32 v184, v184
    v_exp_f32 v185, v185
    v_add_f32 v12, v176, v177
    v_add_f32 v12, v12, v178
    v_add_f32 v12, v12, v179
    v_add_f32 v12, v12, v180
    v_add_f32 v12, v12, v181
    v_add_f32 v12, v12, v182
    v_add_f32 v12, v12, v183
    v_add_f32 v12, v12, v184
    v_add_f32 v12, v12, v185
    v_mov_b32 v13, v12
    s_nop 1
    v_permlane16_swap_b32 v12, v13
    v_add_f32 v12, v12, v13
    v_mov_b32 v13, v12
    s_nop 1
    v_permlane32_swap_b32 v12, v13
    v_add_f32 v12, v12, v13
    v_rcp_f32 v12, v12
    s_nop 0
    v_mul_f32 v176, v176, v12
    v_mul_f32 v177, v177, v12
    v_mul_f32 v178, v178, v12
    v_mul_f32 v179, v179, v12
    v_mul_f32 v180, v180, v12
    v_mul_f32 v181, v181, v12
    v_mul_f32 v182, v182, v12
    v_mul_f32 v183, v183, v12
    v_mul_f32 v184, v184, v12
    v_mul_f32 v185, v185, v12
    v_cvt_pk_bf16_f32 v188, v176, v177
    v_cvt_pk_bf16_f32 v189, v178, v179
    v_cvt_pk_bf16_f32 v190, v180, v181
    v_cvt_pk_bf16_f32 v191, v182, v183
    v_cvt_pk_bf16_f32 v192, v184, v185
    v_min_u32 v188, -2, v188
    v_min_u32 v189, -2, v189
    v_min_u32 v190, -2, v190
    v_min_u32 v191, -2, v191
    v_min_u32 v192, -2, v192
    buffer_store_dwordx4 v[188:191], v168, s[4:7], s72 offen offset:0 sc1
    buffer_store_dword v192, v169, s[4:7], s72 offen offset:0 sc1
    buffer_store_dwordx4 v[244:247], v168, s[4:7], s73 offen offset:0 sc1
    buffer_store_dword v244, v169, s[4:7], s73 offen offset:0 sc1
QK_next_s:
    s_mul_i32 s66, s85, 81920
    s_add_u32 s66, s66, s60
    buffer_load_dwordx4 v[16:19], v6, s[4:7], s66 offen offset:0 sc1
    buffer_load_dwordx4 v[20:23], v7, s[4:7], s66 offen offset:0 sc1
    buffer_load_dwordx4 v[24:27], v8, s[4:7], s66 offen offset:0 sc1
    s_add_u32 s43, s43, 1
    s_add_u32 s84, s43, 3
    s_and_b32 s84, s84, 3
    s_add_u32 s85, s43, 4
    s_and_b32 s85, s85, 3
    s_add_u32 s86, s43, 5
    s_and_b32 s86, s86, 3
    s_add_u32 s87, s43, 6
    s_and_b32 s87, s87, 3
    s_mul_i32 s67, s84, s62
    s_add_u32 s67, s67, s61
    s_mul_i32 s68, s86, s62
    s_add_u32 s68, s68, s61
    s_mul_i32 s69, s84, 393216
    s_add_u32 s69, s69, s63
    s_mul_i32 s70, s86, 393216
    s_add_u32 s70, s70, s63
    s_mul_i32 s71, s84, 393216
    s_add_u32 s71, s71, s64
    s_mul_i32 s72, s84, 81920
    s_add_u32 s72, s72, s65
    s_mul_i32 s73, s85, 81920
    s_add_u32 s73, s73, s65
    s_mul_i32 s78, s84, 327680
    s_add_u32 s78, s78, s77
    s_mul_i32 s99, s85, 81920
    s_add_u32 s99, s99, s79
    s_mul_i32 s91, s87, 81920
    s_add_u32 s91, s91, s79
    v_mov_b32 v112, 0
    v_mov_b32 v113, 0
    v_mov_b32 v114, 0
    v_mov_b32 v115, 0
    v_mov_b32 v116, 0
    v_mov_b32 v117, 0
    v_mov_b32 v118, 0
    v_mov_b32 v119, 0
    s_cmp_le_u32 s43, 64
    s_cbranch_scc1 QK_loop_s
QK_end_s:
    s_endpgm
K_red:
    s_sub_u32 s45, s41, 12
    s_lshl_b32 s44, s40, 2
    s_add_u32 s44, s44, s42
    v_add_u32 v11, 0, v0
    v_min_u32 v11, 383, v11
    v_mul_u32_u24 v12, 5462, v11
    v_lshrrev_b32 v12, 16, v12
    v_mul_u32_u24 v13, 10752, v12
    v_lshl_add_u32 v13, v11, 7, v13
    s_mul_i32 s51, s45, 393216
    s_mul_i32 s52, s40, 1536
    s_add_u32 s51, s51, s52
    buffer_load_dword v248, v13, s[8:11], s51 offen
    v_lshlrev_b32 v13, 7, v11
    s_mul_i32 s51, s45, 49152
    s_mul_i32 s52, s40, 983040
    s_add_u32 s51, s51, s52
    buffer_load_dword v253, v13, s[12:15], s51 offen
    v_add_u32 v11, 256, v0
    v_min_u32 v11, 383, v11
    v_mul_u32_u24 v12, 5462, v11
    v_lshrrev_b32 v12, 16, v12
    v_mul_u32_u24 v13, 10752, v12
    v_lshl_add_u32 v13, v11, 7, v13
    s_mul_i32 s51, s45, 393216
    s_mul_i32 s52, s40, 1536
    s_add_u32 s51, s51, s52
    buffer_load_dword v249, v13, s[8:11], s51 offen
    v_lshlrev_b32 v13, 7, v11
    s_mul_i32 s51, s45, 49152
    s_mul_i32 s52, s40, 983040
    s_add_u32 s51, s51, s52
    buffer_load_dword v254, v13, s[12:15], s51 offen
    v_lshlrev_b32 v252, 7, v0
    s_mul_i32 s61, s44, 3840
    s_add_u32 s61, s61, 12058624
    s_lshl_b32 s63, s45, 14
    s_add_u32 s63, s63, 12582912
    s_lshl_b32 s51, s40, 10
    s_add_u32 s62, s63, s51
    s_getreg_b32 s51, hwreg(HW_REG_XCC_ID)
    s_lshr_b32 s51, s51, 2
    s_and_b32 s51, s51, 1
    s_xor_b32 s51, s51, 1
    s_lshl_b32 s51, s51, 13
    s_add_u32 s63, s63, s51
    s_lshl_b32 s51, s45, 9
    s_add_u32 s64, s60, s51
    s_lshl_b32 s51, s40, 1
    s_and_b32 s52, s42, 1
    s_add_u32 s51, s51, s52
    s_mul_i32 s65, s51, 5120
    s_add_u32 s65, s65, 16777216
    v_lshlrev_b32 v155, 2, v0
    v_add_u32 v157, 8192, v155
    v_mov_b32 v171, v157
    v_and_b32 v11, 127, v0
    v_lshlrev_b32 v156, 3, v11
    v_add_u32 v157, 4096, v156
    v_lshlrev_b32 v158, 2, v11
    v_bfe_u32 v12, v11, 4, 2
    v_bfe_u32 v13, v11, 2, 1
    v_lshl_add_u32 v12, v12, 1, v13
    s_movk_i32 s51, 1280
    v_mul_lo_u32 v12, v12, s51
    v_bfe_u32 v13, v11, 6, 1
    v_lshl_add_u32 v12, v13, 5, v12
    v_and_b32 v13, 3, v11
    v_lshl_add_u32 v12, v13, 3, v12
    v_bfe_u32 v13, v11, 3, 1
    v_lshl_add_u32 v12, v13, 2, v12
    s_lshl_b32 s51, s45, 6
    buffer_load_dword v14, v12, s[32:35], s51 offen
    s_add_u32 s51, s62, 0
    buffer_store_dword v244, v155, s[4:7], s51 offen offset:0 sc1
    buffer_store_dword v244, v171, s[4:7], s51 offen offset:0 sc1
    s_add_u32 s51, s62, 327680
    buffer_store_dword v244, v155, s[4:7], s51 offen offset:0 sc1
    buffer_store_dword v244, v171, s[4:7], s51 offen offset:0 sc1
    s_add_u32 s51, s64, 81920
    buffer_store_dword v244, v158, s[4:7], s51 offen offset:0 sc1
    s_add_u32 s51, s62, 655360
    buffer_store_dword v244, v155, s[4:7], s51 offen offset:0 sc1
    buffer_store_dword v244, v171, s[4:7], s51 offen offset:0 sc1
    s_add_u32 s51, s64, 163840
    buffer_store_dword v244, v158, s[4:7], s51 offen offset:0 sc1
    s_add_u32 s51, s62, 983040
    buffer_store_dword v244, v155, s[4:7], s51 offen offset:0 sc1
    buffer_store_dword v244, v171, s[4:7], s51 offen offset:0 sc1
    s_add_u32 s51, s64, 245760
    buffer_store_dword v244, v158, s[4:7], s51 offen offset:0 sc1
    v_lshrrev_b32 v12, 2, v1
    s_movk_i32 s51, 1280
    v_mul_lo_u32 v149, v12, s51
    v_and_b32 v12, 3, v1
    v_lshl_add_u32 v149, v12, 4, v149
    s_mul_i32 s51, s44, 245760
    s_lshl_b32 s52, s45, 6
    s_add_u32 s51, s51, s52
    s_add_u32 m0, s90, 24576
    s_add_u32 s50, s51, 0
    buffer_load_dwordx4 v149, s[12:15], s50 offen lds
    s_add_u32 m0, s90, 25600
    s_add_u32 s50, s51, 20480
    buffer_load_dwordx4 v149, s[12:15], s50 offen lds
    s_add_u32 m0, s90, 26624
    s_add_u32 s50, s51, 40960
    buffer_load_dwordx4 v149, s[12:15], s50 offen lds
    s_add_u32 m0, s90, 27648
    s_add_u32 s50, s51, 61440
    buffer_load_dwordx4 v149, s[12:15], s50 offen lds
    s_add_u32 m0, s90, 28672
    s_add_u32 s50, s51, 81920
    buffer_load_dwordx4 v149, s[12:15], s50 offen lds
    s_add_u32 m0, s90, 29696
    s_add_u32 s50, s51, 102400
    buffer_load_dwordx4 v149, s[12:15], s50 offen lds
    s_add_u32 m0, s90, 30720
    s_add_u32 s50, s51, 122880
    buffer_load_dwordx4 v149, s[12:15], s50 offen lds
    s_add_u32 m0, s90, 31744
    s_add_u32 s50, s51, 143360
    buffer_load_dwordx4 v149, s[12:15], s50 offen lds
    s_add_u32 m0, s90, 32768
    s_add_u32 s50, s51, 163840
    buffer_load_dwordx4 v149, s[12:15], s50 offen lds
    s_add_u32 m0, s90, 33792
    s_add_u32 s50, s51, 184320
    buffer_load_dwordx4 v149, s[12:15], s50 offen lds
    s_add_u32 m0, s90, 34816
    s_add_u32 s50, s51, 204800
    buffer_load_dwordx4 v149, s[12:15], s50 offen lds
    s_add_u32 m0, s90, 35840
    s_add_u32 s50, s51, 225280
    buffer_load_dwordx4 v149, s[12:15], s50 offen lds
    s_waitcnt vmcnt(23)
    v_min_u32 v14, -2, v14
    buffer_store_dword v14, v158, s[4:7], s64 offen offset:0 sc1
    v_lshrrev_b32 v12, 5, v1
    v_bfe_u32 v13, v1, 3, 2
    v_lshl_add_u32 v12, v12, 3, v13
    s_movk_i32 s51, 12288
    v_mul_lo_u32 v150, v12, s51
    v_lshlrev_b32 v12, 1, v3
    v_and_b32 v13, 7, v1
    v_xor_b32 v12, v12, v13
    v_lshl_add_u32 v150, v12, 4, v150
    v_lshrrev_b32 v12, 3, v2
    v_mul_u32_u24 v151, 3072, v12
    v_and_b32 v12, 7, v2
    v_lshl_add_u32 v151, v12, 7, v151
    v_and_b32 v12, 6, v2
    v_xor_b32 v12, v12, v3
    v_lshl_add_u32 v151, v12, 4, v151
    v_add_u32 v151, s90, v151
    v_xor_b32 v152, 64, v151
    s_mul_i32 s81, s44, 384
    s_add_u32 m0, s90, 0
    s_add_u32 s50, s81, 0
    buffer_load_dwordx4 v150, s[8:11], s50 offen lds
    s_add_u32 m0, s90, 1024
    s_add_u32 s50, s81, 128
    buffer_load_dwordx4 v150, s[8:11], s50 offen lds
    s_add_u32 m0, s90, 2048
    s_add_u32 s50, s81, 256
    buffer_load_dwordx4 v150, s[8:11], s50 offen lds
    s_add_u32 m0, s90, 3072
    s_add_u32 s50, s81, 196608
    buffer_load_dwordx4 v150, s[8:11], s50 offen lds
    s_add_u32 m0, s90, 4096
    s_add_u32 s50, s81, 196736
    buffer_load_dwordx4 v150, s[8:11], s50 offen lds
    s_add_u32 m0, s90, 5120
    s_add_u32 s50, s81, 196864
    buffer_load_dwordx4 v150, s[8:11], s50 offen lds
    s_add_u32 m0, s90, 6144
    s_add_u32 s50, s81, 49152
    buffer_load_dwordx4 v150, s[8:11], s50 offen lds
    s_add_u32 m0, s90, 7168
    s_add_u32 s50, s81, 49280
    buffer_load_dwordx4 v150, s[8:11], s50 offen lds
    s_add_u32 m0, s90, 8192
    s_add_u32 s50, s81, 49408
    buffer_load_dwordx4 v150, s[8:11], s50 offen lds
    s_add_u32 m0, s90, 9216
    s_add_u32 s50, s81, 245760
    buffer_load_dwordx4 v150, s[8:11], s50 offen lds
    s_add_u32 m0, s90, 10240
    s_add_u32 s50, s81, 245888
    buffer_load_dwordx4 v150, s[8:11], s50 offen lds
    s_add_u32 m0, s90, 11264
    s_add_u32 s50, s81, 246016
    buffer_load_dwordx4 v150, s[8:11], s50 offen lds
    s_add_u32 m0, s90, 12288
    s_add_u32 s50, s81, 393216
    buffer_load_dwordx4 v150, s[8:11], s50 offen lds
    s_add_u32 m0, s90, 13312
    s_add_u32 s50, s81, 393344
    buffer_load_dwordx4 v150, s[8:11], s50 offen lds
    s_add_u32 m0, s90, 14336
    s_add_u32 s50, s81, 393472
    buffer_load_dwordx4 v150, s[8:11], s50 offen lds
    s_add_u32 m0, s90, 15360
    s_add_u32 s50, s81, 589824
    buffer_load_dwordx4 v150, s[8:11], s50 offen lds
    s_add_u32 m0, s90, 16384
    s_add_u32 s50, s81, 589952
    buffer_load_dwordx4 v150, s[8:11], s50 offen lds
    s_add_u32 m0, s90, 17408
    s_add_u32 s50, s81, 590080
    buffer_load_dwordx4 v150, s[8:11], s50 offen lds
    s_add_u32 m0, s90, 18432
    s_add_u32 s50, s81, 442368
    buffer_load_dwordx4 v150, s[8:11], s50 offen lds
    s_add_u32 m0, s90, 19456
    s_add_u32 s50, s81, 442496
    buffer_load_dwordx4 v150, s[8:11], s50 offen lds
    s_add_u32 m0, s90, 20480
    s_add_u32 s50, s81, 442624
    buffer_load_dwordx4 v150, s[8:11], s50 offen lds
    s_add_u32 m0, s90, 21504
    s_add_u32 s50, s81, 638976
    buffer_load_dwordx4 v150, s[8:11], s50 offen lds
    s_add_u32 m0, s90, 22528
    s_add_u32 s50, s81, 639104
    buffer_load_dwordx4 v150, s[8:11], s50 offen lds
    s_add_u32 m0, s90, 23552
    s_add_u32 s50, s81, 639232
    buffer_load_dwordx4 v150, s[8:11], s50 offen lds
    s_waitcnt vmcnt(24)
    s_barrier
    s_getreg_b32 s51, hwreg(HW_REG_XCC_ID)
    s_and_b32 s51, s51, 7
    s_lshl_b32 s51, s51, 3
    s_lshl_b64 s[52:53], 4, s51
    v_mov_b32 v12, s52
    v_mov_b32 v13, s53
    v_mov_b32 v14, 0
    s_lshl_b32 s51, s40, 5
    s_cmp_lg_u32 s42, 3
    s_cbranch_scc1 RG_26
    s_mov_b64 exec, 1
    buffer_atomic_add_x2 v[12:13], v14, s[24:27], s51 offen sc1
    s_mov_b64 exec, -1
RG_26:
    ds_read_b64_tr_b16 v[196:197], v148 offset:24576
    ds_read_b64_tr_b16 v[198:199], v148 offset:24832
    ds_read_b64_tr_b16 v[200:201], v148 offset:24584
    ds_read_b64_tr_b16 v[202:203], v148 offset:24840
    ds_read_b64_tr_b16 v[204:205], v148 offset:26624
    ds_read_b64_tr_b16 v[206:207], v148 offset:26880
    ds_read_b64_tr_b16 v[208:209], v148 offset:26632
    ds_read_b64_tr_b16 v[210:211], v148 offset:26888
    ds_read_b64_tr_b16 v[212:213], v148 offset:28672
    ds_read_b64_tr_b16 v[214:215], v148 offset:28928
    ds_read_b64_tr_b16 v[216:217], v148 offset:28680
    ds_read_b64_tr_b16 v[218:219], v148 offset:28936
    ds_read_b64_tr_b16 v[220:221], v148 offset:30720
    ds_read_b64_tr_b16 v[222:223], v148 offset:30976
    ds_read_b64_tr_b16 v[224:225], v148 offset:30728
    ds_read_b64_tr_b16 v[226:227], v148 offset:30984
    ds_read_b64_tr_b16 v[228:229], v148 offset:32768
    ds_read_b64_tr_b16 v[230:231], v148 offset:33024
    ds_read_b64_tr_b16 v[232:233], v148 offset:32776
    ds_read_b64_tr_b16 v[234:235], v148 offset:33032
    ds_read_b64_tr_b16 v[236:237], v148 offset:34816
    ds_read_b64_tr_b16 v[238:239], v148 offset:35072
    ds_read_b64_tr_b16 v[240:241], v148 offset:34824
    ds_read_b64_tr_b16 v[242:243], v148 offset:35080
    s_waitcnt lgkmcnt(0)
    s_add_u32 m0, s90, 24576
    s_add_u32 s50, s81, 786432
    buffer_load_dwordx4 v150, s[8:11], s50 offen lds
    s_add_u32 m0, s90, 25600
    s_add_u32 s50, s81, 786560
    buffer_load_dwordx4 v150, s[8:11], s50 offen lds
    s_add_u32 m0, s90, 26624
    s_add_u32 s50, s81, 786688
    buffer_load_dwordx4 v150, s[8:11], s50 offen lds
    s_add_u32 m0, s90, 27648
    s_add_u32 s50, s81, 983040
    buffer_load_dwordx4 v150, s[8:11], s50 offen lds
    s_add_u32 m0, s90, 28672
    s_add_u32 s50, s81, 983168
    buffer_load_dwordx4 v150, s[8:11], s50 offen lds
    s_add_u32 m0, s90, 29696
    s_add_u32 s50, s81, 983296
    buffer_load_dwordx4 v150, s[8:11], s50 offen lds
    s_add_u32 m0, s90, 30720
    s_add_u32 s50, s81, 835584
    buffer_load_dwordx4 v150, s[8:11], s50 offen lds
    s_add_u32 m0, s90, 31744
    s_add_u32 s50, s81, 835712
    buffer_load_dwordx4 v150, s[8:11], s50 offen lds
    s_add_u32 m0, s90, 32768
    s_add_u32 s50, s81, 835840
    buffer_load_dwordx4 v150, s[8:11], s50 offen lds
    s_add_u32 m0, s90, 33792
    s_add_u32 s50, s81, 1032192
    buffer_load_dwordx4 v150, s[8:11], s50 offen lds
    s_add_u32 m0, s90, 34816
    s_add_u32 s50, s81, 1032320
    buffer_load_dwordx4 v150, s[8:11], s50 offen lds
    s_add_u32 m0, s90, 35840
    s_add_u32 s50, s81, 1032448
    buffer_load_dwordx4 v150, s[8:11], s50 offen lds
    s_mul_i32 s82, s42, 491520
    s_lshl_b32 s52, s45, 6
    s_add_u32 s82, s82, s52
    s_waitcnt vmcnt(30)
    ds_read_b128 v[32:35], v151 offset:0
    ds_read_b128 v[36:39], v152 offset:0
    ds_read_b128 v[40:43], v151 offset:1024
    ds_read_b128 v[44:47], v152 offset:1024
    ds_read_b128 v[48:51], v151 offset:2048
    ds_read_b128 v[52:55], v152 offset:2048
    s_waitcnt vmcnt(24)
    ds_read_b128 v[56:59], v151 offset:6144
    ds_read_b128 v[60:63], v152 offset:6144
    ds_read_b128 v[64:67], v151 offset:7168
    ds_read_b128 v[68:71], v152 offset:7168
    ds_read_b128 v[72:75], v151 offset:8192
    ds_read_b128 v[76:79], v152 offset:8192
    s_waitcnt lgkmcnt(6)
    v_mfma_f32_16x16x32_bf16 v[128:131], v[32:35], v[196:199], 0
    v_mfma_f32_16x16x32_bf16 v[132:135], v[32:35], v[200:203], 0
    s_add_u32 m0, s90, 0
    s_add_u32 s50, s81, 1179648
    buffer_load_dwordx4 v150, s[8:11], s50 offen lds
    s_add_u32 m0, s90, 1024
    s_add_u32 s50, s81, 1179776
    buffer_load_dwordx4 v150, s[8:11], s50 offen lds
    s_add_u32 m0, s90, 2048
    s_add_u32 s50, s81, 1179904
    buffer_load_dwordx4 v150, s[8:11], s50 offen lds
    s_add_u32 m0, s90, 3072
    s_add_u32 s50, s81, 1376256
    buffer_load_dwordx4 v150, s[8:11], s50 offen lds
    s_add_u32 m0, s90, 4096
    s_add_u32 s50, s81, 1376384
    buffer_load_dwordx4 v150, s[8:11], s50 offen lds
    s_add_u32 m0, s90, 5120
    s_add_u32 s50, s81, 1376512
    buffer_load_dwordx4 v150, s[8:11], s50 offen lds
    v_mfma_f32_16x16x32_bf16 v[128:131], v[36:39], v[204:207], v[128:131]
    v_mfma_f32_16x16x32_bf16 v[132:135], v[36:39], v[208:211], v[132:135]
    v_mfma_f32_16x16x32_bf16 v[128:131], v[40:43], v[212:215], v[128:131]
    v_mfma_f32_16x16x32_bf16 v[132:135], v[40:43], v[216:219], v[132:135]
    v_mfma_f32_16x16x32_bf16 v[128:131], v[44:47], v[220:223], v[128:131]
    v_mfma_f32_16x16x32_bf16 v[132:135], v[44:47], v[224:227], v[132:135]
    v_mfma_f32_16x16x32_bf16 v[128:131], v[48:51], v[228:231], v[128:131]
    v_mfma_f32_16x16x32_bf16 v[132:135], v[48:51], v[232:235], v[132:135]
    v_mfma_f32_16x16x32_bf16 v[128:131], v[52:55], v[236:239], v[128:131]
    v_mfma_f32_16x16x32_bf16 v[132:135], v[52:55], v[240:243], v[132:135]
    s_waitcnt vmcnt(24)
    ds_read_b128 v[32:35], v151 offset:12288
    ds_read_b128 v[36:39], v152 offset:12288
    ds_read_b128 v[40:43], v151 offset:13312
    ds_read_b128 v[44:47], v152 offset:13312
    ds_read_b128 v[48:51], v151 offset:14336
    ds_read_b128 v[52:55], v152 offset:14336
    s_waitcnt lgkmcnt(6)
    v_mfma_f32_16x16x32_bf16 v[136:139], v[56:59], v[196:199], 0
    v_mfma_f32_16x16x32_bf16 v[140:143], v[56:59], v[200:203], 0
    s_add_u32 m0, s90, 6144
    s_add_u32 s50, s81, 1228800
    buffer_load_dwordx4 v150, s[8:11], s50 offen lds
    s_add_u32 m0, s90, 7168
    s_add_u32 s50, s81, 1228928
    buffer_load_dwordx4 v150, s[8:11], s50 offen lds
    s_add_u32 m0, s90, 8192
    s_add_u32 s50, s81, 1229056
    buffer_load_dwordx4 v150, s[8:11], s50 offen lds
    s_add_u32 m0, s90, 9216
    s_add_u32 s50, s81, 1425408
    buffer_load_dwordx4 v150, s[8:11], s50 offen lds
    s_add_u32 m0, s90, 10240
    s_add_u32 s50, s81, 1425536
    buffer_load_dwordx4 v150, s[8:11], s50 offen lds
    s_add_u32 m0, s90, 11264
    s_add_u32 s50, s81, 1425664
    buffer_load_dwordx4 v150, s[8:11], s50 offen lds
    v_mfma_f32_16x16x32_bf16 v[136:139], v[60:63], v[204:207], v[136:139]
    v_mfma_f32_16x16x32_bf16 v[140:143], v[60:63], v[208:211], v[140:143]
    v_mfma_f32_16x16x32_bf16 v[136:139], v[64:67], v[212:215], v[136:139]
    v_mfma_f32_16x16x32_bf16 v[140:143], v[64:67], v[216:219], v[140:143]
    v_cvt_pk_bf16_f32 v128, v128, v129
    v_cvt_pk_bf16_f32 v129, v130, v131
    v_accvgpr_write_b32 a0, v128
    v_accvgpr_write_b32 a1, v129
    v_cvt_pk_bf16_f32 v132, v132, v133
    v_cvt_pk_bf16_f32 v133, v134, v135
    v_accvgpr_write_b32 a80, v132
    v_accvgpr_write_b32 a81, v133
    v_mfma_f32_16x16x32_bf16 v[136:139], v[68:71], v[220:223], v[136:139]
    v_mfma_f32_16x16x32_bf16 v[140:143], v[68:71], v[224:227], v[140:143]
    v_mfma_f32_16x16x32_bf16 v[136:139], v[72:75], v[228:231], v[136:139]
    v_mfma_f32_16x16x32_bf16 v[140:143], v[72:75], v[232:235], v[140:143]
    v_mfma_f32_16x16x32_bf16 v[136:139], v[76:79], v[236:239], v[136:139]
    v_mfma_f32_16x16x32_bf16 v[140:143], v[76:79], v[240:243], v[140:143]
    s_waitcnt vmcnt(24)
    ds_read_b128 v[56:59], v151 offset:18432
    ds_read_b128 v[60:63], v152 offset:18432
    ds_read_b128 v[64:67], v151 offset:19456
    ds_read_b128 v[68:71], v152 offset:19456
    ds_read_b128 v[72:75], v151 offset:20480
    ds_read_b128 v[76:79], v152 offset:20480
    s_waitcnt lgkmcnt(6)
    v_mfma_f32_16x16x32_bf16 v[128:131], v[32:35], v[196:199], 0
    v_mfma_f32_16x16x32_bf16 v[132:135], v[32:35], v[200:203], 0
    s_add_u32 m0, s90, 12288
    s_add_u32 s50, s81, 1572864
    buffer_load_dwordx4 v150, s[8:11], s50 offen lds
    s_add_u32 m0, s90, 13312
    s_add_u32 s50, s81, 1572992
    buffer_load_dwordx4 v150, s[8:11], s50 offen lds
    s_add_u32 m0, s90, 14336
    s_add_u32 s50, s81, 1573120
    buffer_load_dwordx4 v150, s[8:11], s50 offen lds
    s_add_u32 m0, s90, 15360
    s_add_u32 s50, s81, 1769472
    buffer_load_dwordx4 v150, s[8:11], s50 offen lds
    s_add_u32 m0, s90, 16384
    s_add_u32 s50, s81, 1769600
    buffer_load_dwordx4 v150, s[8:11], s50 offen lds
    s_add_u32 m0, s90, 17408
    s_add_u32 s50, s81, 1769728
    buffer_load_dwordx4 v150, s[8:11], s50 offen lds
    v_mfma_f32_16x16x32_bf16 v[128:131], v[36:39], v[204:207], v[128:131]
    v_mfma_f32_16x16x32_bf16 v[132:135], v[36:39], v[208:211], v[132:135]
    v_mfma_f32_16x16x32_bf16 v[128:131], v[40:43], v[212:215], v[128:131]
    v_mfma_f32_16x16x32_bf16 v[132:135], v[40:43], v[216:219], v[132:135]
    v_cvt_pk_bf16_f32 v136, v136, v137
    v_cvt_pk_bf16_f32 v137, v138, v139
    v_accvgpr_write_b32 a2, v136
    v_accvgpr_write_b32 a3, v137
    v_cvt_pk_bf16_f32 v140, v140, v141
    v_cvt_pk_bf16_f32 v141, v142, v143
    v_accvgpr_write_b32 a82, v140
    v_accvgpr_write_b32 a83, v141
    v_mfma_f32_16x16x32_bf16 v[128:131], v[44:47], v[220:223], v[128:131]
    v_mfma_f32_16x16x32_bf16 v[132:135], v[44:47], v[224:227], v[132:135]
    v_mfma_f32_16x16x32_bf16 v[128:131], v[48:51], v[228:231], v[128:131]
    v_mfma_f32_16x16x32_bf16 v[132:135], v[48:51], v[232:235], v[132:135]
    v_mfma_f32_16x16x32_bf16 v[128:131], v[52:55], v[236:239], v[128:131]
    v_mfma_f32_16x16x32_bf16 v[132:135], v[52:55], v[240:243], v[132:135]
    s_waitcnt vmcnt(24)
    ds_read_b128 v[32:35], v151 offset:24576
    ds_read_b128 v[36:39], v152 offset:24576
    ds_read_b128 v[40:43], v151 offset:25600
    ds_read_b128 v[44:47], v152 offset:25600
    ds_read_b128 v[48:51], v151 offset:26624
    ds_read_b128 v[52:55], v152 offset:26624
    s_waitcnt lgkmcnt(6)
    v_mfma_f32_16x16x32_bf16 v[136:139], v[56:59], v[196:199], 0
    v_mfma_f32_16x16x32_bf16 v[140:143], v[56:59], v[200:203], 0
    s_add_u32 m0, s90, 18432
    s_add_u32 s50, s81, 1622016
    buffer_load_dwordx4 v150, s[8:11], s50 offen lds
    s_add_u32 m0, s90, 19456
    s_add_u32 s50, s81, 1622144
    buffer_load_dwordx4 v150, s[8:11], s50 offen lds
    s_add_u32 m0, s90, 20480
    s_add_u32 s50, s81, 1622272
    buffer_load_dwordx4 v150, s[8:11], s50 offen lds
    s_add_u32 m0, s90, 21504
    s_add_u32 s50, s81, 1818624
    buffer_load_dwordx4 v150, s[8:11], s50 offen lds
    s_add_u32 m0, s90, 22528
    s_add_u32 s50, s81, 1818752
    buffer_load_dwordx4 v150, s[8:11], s50 offen lds
    s_add_u32 m0, s90, 23552
    s_add_u32 s50, s81, 1818880
    buffer_load_dwordx4 v150, s[8:11], s50 offen lds
    v_mfma_f32_16x16x32_bf16 v[136:139], v[60:63], v[204:207], v[136:139]
    v_mfma_f32_16x16x32_bf16 v[140:143], v[60:63], v[208:211], v[140:143]
    v_mfma_f32_16x16x32_bf16 v[136:139], v[64:67], v[212:215], v[136:139]
    v_mfma_f32_16x16x32_bf16 v[140:143], v[64:67], v[216:219], v[140:143]
    v_cvt_pk_bf16_f32 v128, v128, v129
    v_cvt_pk_bf16_f32 v129, v130, v131
    v_accvgpr_write_b32 a4, v128
    v_accvgpr_write_b32 a5, v129
    v_cvt_pk_bf16_f32 v132, v132, v133
    v_cvt_pk_bf16_f32 v133, v134, v135
    v_accvgpr_write_b32 a84, v132
    v_accvgpr_write_b32 a85, v133
    v_mfma_f32_16x16x32_bf16 v[136:139], v[68:71], v[220:223], v[136:139]
    v_mfma_f32_16x16x32_bf16 v[140:143], v[68:71], v[224:227], v[140:143]
    v_mfma_f32_16x16x32_bf16 v[136:139], v[72:75], v[228:231], v[136:139]
    v_mfma_f32_16x16x32_bf16 v[140:143], v[72:75], v[232:235], v[140:143]
    v_mfma_f32_16x16x32_bf16 v[136:139], v[76:79], v[236:239], v[136:139]
    v_mfma_f32_16x16x32_bf16 v[140:143], v[76:79], v[240:243], v[140:143]
    s_waitcnt vmcnt(24)
    ds_read_b128 v[56:59], v151 offset:30720
    ds_read_b128 v[60:63], v152 offset:30720
    ds_read_b128 v[64:67], v151 offset:31744
    ds_read_b128 v[68:71], v152 offset:31744
    ds_read_b128 v[72:75], v151 offset:32768
    ds_read_b128 v[76:79], v152 offset:32768
    s_waitcnt lgkmcnt(6)
    v_mfma_f32_16x16x32_bf16 v[128:131], v[32:35], v[196:199], 0
    v_mfma_f32_16x16x32_bf16 v[132:135], v[32:35], v[200:203], 0
    s_add_u32 m0, s90, 24576
    s_add_u32 s50, s81, 1966080
    buffer_load_dwordx4 v150, s[8:11], s50 offen lds
    s_add_u32 m0, s90, 25600
    s_add_u32 s50, s81, 1966208
    buffer_load_dwordx4 v150, s[8:11], s50 offen lds
    s_add_u32 m0, s90, 26624
    s_add_u32 s50, s81, 1966336
    buffer_load_dwordx4 v150, s[8:11], s50 offen lds
    s_add_u32 m0, s90, 27648
    s_add_u32 s50, s81, 2162688
    buffer_load_dwordx4 v150, s[8:11], s50 offen lds
    s_add_u32 m0, s90, 28672
    s_add_u32 s50, s81, 2162816
    buffer_load_dwordx4 v150, s[8:11], s50 offen lds
    s_add_u32 m0, s90, 29696
    s_add_u32 s50, s81, 2162944
    buffer_load_dwordx4 v150, s[8:11], s50 offen lds
    v_mfma_f32_16x16x32_bf16 v[128:131], v[36:39], v[204:207], v[128:131]
    v_mfma_f32_16x16x32_bf16 v[132:135], v[36:39], v[208:211], v[132:135]
    v_mfma_f32_16x16x32_bf16 v[128:131], v[40:43], v[212:215], v[128:131]
    v_mfma_f32_16x16x32_bf16 v[132:135], v[40:43], v[216:219], v[132:135]
    v_cvt_pk_bf16_f32 v136, v136, v137
    v_cvt_pk_bf16_f32 v137, v138, v139
    v_accvgpr_write_b32 a6, v136
    v_accvgpr_write_b32 a7, v137
    v_cvt_pk_bf16_f32 v140, v140, v141
    v_cvt_pk_bf16_f32 v141, v142, v143
    v_accvgpr_write_b32 a86, v140
    v_accvgpr_write_b32 a87, v141
    v_mfma_f32_16x16x32_bf16 v[128:131], v[44:47], v[220:223], v[128:131]
    v_mfma_f32_16x16x32_bf16 v[132:135], v[44:47], v[224:227], v[132:135]
    v_mfma_f32_16x16x32_bf16 v[128:131], v[48:51], v[228:231], v[128:131]
    v_mfma_f32_16x16x32_bf16 v[132:135], v[48:51], v[232:235], v[132:135]
    v_mfma_f32_16x16x32_bf16 v[128:131], v[52:55], v[236:239], v[128:131]
    v_mfma_f32_16x16x32_bf16 v[132:135], v[52:55], v[240:243], v[132:135]
    s_waitcnt vmcnt(24)
    ds_read_b128 v[32:35], v151 offset:0
    ds_read_b128 v[36:39], v152 offset:0
    ds_read_b128 v[40:43], v151 offset:1024
    ds_read_b128 v[44:47], v152 offset:1024
    ds_read_b128 v[48:51], v151 offset:2048
    ds_read_b128 v[52:55], v152 offset:2048
    s_waitcnt lgkmcnt(6)
    v_mfma_f32_16x16x32_bf16 v[136:139], v[56:59], v[196:199], 0
    v_mfma_f32_16x16x32_bf16 v[140:143], v[56:59], v[200:203], 0
    s_add_u32 m0, s90, 30720
    s_add_u32 s50, s81, 2015232
    buffer_load_dwordx4 v150, s[8:11], s50 offen lds
    s_add_u32 m0, s90, 31744
    s_add_u32 s50, s81, 2015360
    buffer_load_dwordx4 v150, s[8:11], s50 offen lds
    s_add_u32 m0, s90, 32768
    s_add_u32 s50, s81, 2015488
    buffer_load_dwordx4 v150, s[8:11], s50 offen lds
    s_add_u32 m0, s90, 33792
    s_add_u32 s50, s81, 2211840
    buffer_load_dwordx4 v150, s[8:11], s50 offen lds
    s_add_u32 m0, s90, 34816
    s_add_u32 s50, s81, 2211968
    buffer_load_dwordx4 v150, s[8:11], s50 offen lds
    s_add_u32 m0, s90, 35840
    s_add_u32 s50, s81, 2212096
    buffer_load_dwordx4 v150, s[8:11], s50 offen lds
    v_mfma_f32_16x16x32_bf16 v[136:139], v[60:63], v[204:207], v[136:139]
    v_mfma_f32_16x16x32_bf16 v[140:143], v[60:63], v[208:211], v[140:143]
    v_mfma_f32_16x16x32_bf16 v[136:139], v[64:67], v[212:215], v[136:139]
    v_mfma_f32_16x16x32_bf16 v[140:143], v[64:67], v[216:219], v[140:143]
    v_cvt_pk_bf16_f32 v128, v128, v129
    v_cvt_pk_bf16_f32 v129, v130, v131
    v_accvgpr_write_b32 a8, v128
    v_accvgpr_write_b32 a9, v129
    v_cvt_pk_bf16_f32 v132, v132, v133
    v_cvt_pk_bf16_f32 v133, v134, v135
    v_accvgpr_write_b32 a88, v132
    v_accvgpr_write_b32 a89, v133
    v_mfma_f32_16x16x32_bf16 v[136:139], v[68:71], v[220:223], v[136:139]
    v_mfma_f32_16x16x32_bf16 v[140:143], v[68:71], v[224:227], v[140:143]
    v_mfma_f32_16x16x32_bf16 v[136:139], v[72:75], v[228:231], v[136:139]
    v_mfma_f32_16x16x32_bf16 v[140:143], v[72:75], v[232:235], v[140:143]
    v_mfma_f32_16x16x32_bf16 v[136:139], v[76:79], v[236:239], v[136:139]
    v_mfma_f32_16x16x32_bf16 v[140:143], v[76:79], v[240:243], v[140:143]
    s_waitcnt vmcnt(24)
    ds_read_b128 v[56:59], v151 offset:6144
    ds_read_b128 v[60:63], v152 offset:6144
    ds_read_b128 v[64:67], v151 offset:7168
    ds_read_b128 v[68:71], v152 offset:7168
    ds_read_b128 v[72:75], v151 offset:8192
    ds_read_b128 v[76:79], v152 offset:8192
    s_waitcnt lgkmcnt(6)
    v_mfma_f32_16x16x32_bf16 v[128:131], v[32:35], v[196:199], 0
    v_mfma_f32_16x16x32_bf16 v[132:135], v[32:35], v[200:203], 0
    s_add_u32 m0, s90, 0
    s_add_u32 s50, s81, 2359296
    buffer_load_dwordx4 v150, s[8:11], s50 offen lds
    s_add_u32 m0, s90, 1024
    s_add_u32 s50, s81, 2359424
    buffer_load_dwordx4 v150, s[8:11], s50 offen lds
    s_add_u32 m0, s90, 2048
    s_add_u32 s50, s81, 2359552
    buffer_load_dwordx4 v150, s[8:11], s50 offen lds
    s_add_u32 m0, s90, 3072
    s_add_u32 s50, s81, 2555904
    buffer_load_dwordx4 v150, s[8:11], s50 offen lds
    s_add_u32 m0, s90, 4096
    s_add_u32 s50, s81, 2556032
    buffer_load_dwordx4 v150, s[8:11], s50 offen lds
    s_add_u32 m0, s90, 5120
    s_add_u32 s50, s81, 2556160
    buffer_load_dwordx4 v150, s[8:11], s50 offen lds
    v_mfma_f32_16x16x32_bf16 v[128:131], v[36:39], v[204:207], v[128:131]
    v_mfma_f32_16x16x32_bf16 v[132:135], v[36:39], v[208:211], v[132:135]
    v_mfma_f32_16x16x32_bf16 v[128:131], v[40:43], v[212:215], v[128:131]
    v_mfma_f32_16x16x32_bf16 v[132:135], v[40:43], v[216:219], v[132:135]
    v_cvt_pk_bf16_f32 v136, v136, v137
    v_cvt_pk_bf16_f32 v137, v138, v139
    v_accvgpr_write_b32 a10, v136
    v_accvgpr_write_b32 a11, v137
    v_cvt_pk_bf16_f32 v140, v140, v141
    v_cvt_pk_bf16_f32 v141, v142, v143
    v_accvgpr_write_b32 a90, v140
    v_accvgpr_write_b32 a91, v141
    v_mfma_f32_16x16x32_bf16 v[128:131], v[44:47], v[220:223], v[128:131]
    v_mfma_f32_16x16x32_bf16 v[132:135], v[44:47], v[224:227], v[132:135]
    v_mfma_f32_16x16x32_bf16 v[128:131], v[48:51], v[228:231], v[128:131]
    v_mfma_f32_16x16x32_bf16 v[132:135], v[48:51], v[232:235], v[132:135]
    v_mfma_f32_16x16x32_bf16 v[128:131], v[52:55], v[236:239], v[128:131]
    v_mfma_f32_16x16x32_bf16 v[132:135], v[52:55], v[240:243], v[132:135]
    s_waitcnt vmcnt(24)
    ds_read_b128 v[32:35], v151 offset:12288
    ds_read_b128 v[36:39], v152 offset:12288
    ds_read_b128 v[40:43], v151 offset:13312
    ds_read_b128 v[44:47], v152 offset:13312
    ds_read_b128 v[48:51], v151 offset:14336
    ds_read_b128 v[52:55], v152 offset:14336
    s_waitcnt lgkmcnt(6)
    v_mfma_f32_16x16x32_bf16 v[136:139], v[56:59], v[196:199], 0
    v_mfma_f32_16x16x32_bf16 v[140:143], v[56:59], v[200:203], 0
    s_add_u32 m0, s90, 6144
    s_add_u32 s50, s81, 2408448
    buffer_load_dwordx4 v150, s[8:11], s50 offen lds
    s_add_u32 m0, s90, 7168
    s_add_u32 s50, s81, 2408576
    buffer_load_dwordx4 v150, s[8:11], s50 offen lds
    s_add_u32 m0, s90, 8192
    s_add_u32 s50, s81, 2408704
    buffer_load_dwordx4 v150, s[8:11], s50 offen lds
    s_add_u32 m0, s90, 9216
    s_add_u32 s50, s81, 2605056
    buffer_load_dwordx4 v150, s[8:11], s50 offen lds
    s_add_u32 m0, s90, 10240
    s_add_u32 s50, s81, 2605184
    buffer_load_dwordx4 v150, s[8:11], s50 offen lds
    s_add_u32 m0, s90, 11264
    s_add_u32 s50, s81, 2605312
    buffer_load_dwordx4 v150, s[8:11], s50 offen lds
    v_mfma_f32_16x16x32_bf16 v[136:139], v[60:63], v[204:207], v[136:139]
    v_mfma_f32_16x16x32_bf16 v[140:143], v[60:63], v[208:211], v[140:143]
    v_mfma_f32_16x16x32_bf16 v[136:139], v[64:67], v[212:215], v[136:139]
    v_mfma_f32_16x16x32_bf16 v[140:143], v[64:67], v[216:219], v[140:143]
    v_cvt_pk_bf16_f32 v128, v128, v129
    v_cvt_pk_bf16_f32 v129, v130, v131
    v_accvgpr_write_b32 a12, v128
    v_accvgpr_write_b32 a13, v129
    v_cvt_pk_bf16_f32 v132, v132, v133
    v_cvt_pk_bf16_f32 v133, v134, v135
    v_accvgpr_write_b32 a92, v132
    v_accvgpr_write_b32 a93, v133
    v_mfma_f32_16x16x32_bf16 v[136:139], v[68:71], v[220:223], v[136:139]
    v_mfma_f32_16x16x32_bf16 v[140:143], v[68:71], v[224:227], v[140:143]
    v_mfma_f32_16x16x32_bf16 v[136:139], v[72:75], v[228:231], v[136:139]
    v_mfma_f32_16x16x32_bf16 v[140:143], v[72:75], v[232:235], v[140:143]
    v_mfma_f32_16x16x32_bf16 v[136:139], v[76:79], v[236:239], v[136:139]
    v_mfma_f32_16x16x32_bf16 v[140:143], v[76:79], v[240:243], v[140:143]
    s_waitcnt vmcnt(24)
    ds_read_b128 v[56:59], v151 offset:18432
    ds_read_b128 v[60:63], v152 offset:18432
    ds_read_b128 v[64:67], v151 offset:19456
    ds_read_b128 v[68:71], v152 offset:19456
    ds_read_b128 v[72:75], v151 offset:20480
    ds_read_b128 v[76:79], v152 offset:20480
    s_waitcnt lgkmcnt(6)
    v_mfma_f32_16x16x32_bf16 v[128:131], v[32:35], v[196:199], 0
    v_mfma_f32_16x16x32_bf16 v[132:135], v[32:35], v[200:203], 0
    s_add_u32 m0, s90, 12288
    s_add_u32 s50, s81, 2752512
    buffer_load_dwordx4 v150, s[8:11], s50 offen lds
    s_add_u32 m0, s90, 13312
    s_add_u32 s50, s81, 2752640
    buffer_load_dwordx4 v150, s[8:11], s50 offen lds
    s_add_u32 m0, s90, 14336
    s_add_u32 s50, s81, 2752768
    buffer_load_dwordx4 v150, s[8:11], s50 offen lds
    s_add_u32 m0, s90, 15360
    s_add_u32 s50, s81, 2949120
    buffer_load_dwordx4 v150, s[8:11], s50 offen lds
    s_add_u32 m0, s90, 16384
    s_add_u32 s50, s81, 2949248
    buffer_load_dwordx4 v150, s[8:11], s50 offen lds
    s_add_u32 m0, s90, 17408
    s_add_u32 s50, s81, 2949376
    buffer_load_dwordx4 v150, s[8:11], s50 offen lds
    v_mfma_f32_16x16x32_bf16 v[128:131], v[36:39], v[204:207], v[128:131]
    v_mfma_f32_16x16x32_bf16 v[132:135], v[36:39], v[208:211], v[132:135]
    v_mfma_f32_16x16x32_bf16 v[128:131], v[40:43], v[212:215], v[128:131]
    v_mfma_f32_16x16x32_bf16 v[132:135], v[40:43], v[216:219], v[132:135]
    v_cvt_pk_bf16_f32 v136, v136, v137
    v_cvt_pk_bf16_f32 v137, v138, v139
    v_accvgpr_write_b32 a14, v136
    v_accvgpr_write_b32 a15, v137
    v_cvt_pk_bf16_f32 v140, v140, v141
    v_cvt_pk_bf16_f32 v141, v142, v143
    v_accvgpr_write_b32 a94, v140
    v_accvgpr_write_b32 a95, v141
    v_mfma_f32_16x16x32_bf16 v[128:131], v[44:47], v[220:223], v[128:131]
    v_mfma_f32_16x16x32_bf16 v[132:135], v[44:47], v[224:227], v[132:135]
    v_mfma_f32_16x16x32_bf16 v[128:131], v[48:51], v[228:231], v[128:131]
    v_mfma_f32_16x16x32_bf16 v[132:135], v[48:51], v[232:235], v[132:135]
    v_mfma_f32_16x16x32_bf16 v[128:131], v[52:55], v[236:239], v[128:131]
    v_mfma_f32_16x16x32_bf16 v[132:135], v[52:55], v[240:243], v[132:135]
    s_waitcnt vmcnt(24)
    ds_read_b128 v[32:35], v151 offset:24576
    ds_read_b128 v[36:39], v152 offset:24576
    ds_read_b128 v[40:43], v151 offset:25600
    ds_read_b128 v[44:47], v152 offset:25600
    ds_read_b128 v[48:51], v151 offset:26624
    ds_read_b128 v[52:55], v152 offset:26624
    s_waitcnt lgkmcnt(6)
    v_mfma_f32_16x16x32_bf16 v[136:139], v[56:59], v[196:199], 0
    v_mfma_f32_16x16x32_bf16 v[140:143], v[56:59], v[200:203], 0
    s_add_u32 m0, s90, 18432
    s_add_u32 s50, s81, 2801664
    buffer_load_dwordx4 v150, s[8:11], s50 offen lds
    s_add_u32 m0, s90, 19456
    s_add_u32 s50, s81, 2801792
    buffer_load_dwordx4 v150, s[8:11], s50 offen lds
    s_add_u32 m0, s90, 20480
    s_add_u32 s50, s81, 2801920
    buffer_load_dwordx4 v150, s[8:11], s50 offen lds
    s_add_u32 m0, s90, 21504
    s_add_u32 s50, s81, 2998272
    buffer_load_dwordx4 v150, s[8:11], s50 offen lds
    s_add_u32 m0, s90, 22528
    s_add_u32 s50, s81, 2998400
    buffer_load_dwordx4 v150, s[8:11], s50 offen lds
    s_add_u32 m0, s90, 23552
    s_add_u32 s50, s81, 2998528
    buffer_load_dwordx4 v150, s[8:11], s50 offen lds
    v_mfma_f32_16x16x32_bf16 v[136:139], v[60:63], v[204:207], v[136:139]
    v_mfma_f32_16x16x32_bf16 v[140:143], v[60:63], v[208:211], v[140:143]
    v_mfma_f32_16x16x32_bf16 v[136:139], v[64:67], v[212:215], v[136:139]
    v_mfma_f32_16x16x32_bf16 v[140:143], v[64:67], v[216:219], v[140:143]
    v_cvt_pk_bf16_f32 v128, v128, v129
    v_cvt_pk_bf16_f32 v129, v130, v131
    v_accvgpr_write_b32 a16, v128
    v_accvgpr_write_b32 a17, v129
    v_cvt_pk_bf16_f32 v132, v132, v133
    v_cvt_pk_bf16_f32 v133, v134, v135
    v_accvgpr_write_b32 a96, v132
    v_accvgpr_write_b32 a97, v133
    v_mfma_f32_16x16x32_bf16 v[136:139], v[68:71], v[220:223], v[136:139]
    v_mfma_f32_16x16x32_bf16 v[140:143], v[68:71], v[224:227], v[140:143]
    v_mfma_f32_16x16x32_bf16 v[136:139], v[72:75], v[228:231], v[136:139]
    v_mfma_f32_16x16x32_bf16 v[140:143], v[72:75], v[232:235], v[140:143]
    v_mfma_f32_16x16x32_bf16 v[136:139], v[76:79], v[236:239], v[136:139]
    v_mfma_f32_16x16x32_bf16 v[140:143], v[76:79], v[240:243], v[140:143]
    s_waitcnt vmcnt(24)
    ds_read_b128 v[56:59], v151 offset:30720
    ds_read_b128 v[60:63], v152 offset:30720
    ds_read_b128 v[64:67], v151 offset:31744
    ds_read_b128 v[68:71], v152 offset:31744
    ds_read_b128 v[72:75], v151 offset:32768
    ds_read_b128 v[76:79], v152 offset:32768
    s_waitcnt lgkmcnt(6)
    v_mfma_f32_16x16x32_bf16 v[128:131], v[32:35], v[196:199], 0
    v_mfma_f32_16x16x32_bf16 v[132:135], v[32:35], v[200:203], 0
    s_add_u32 m0, s90, 24576
    s_add_u32 s50, s81, 3145728
    buffer_load_dwordx4 v150, s[8:11], s50 offen lds
    s_add_u32 m0, s90, 25600
    s_add_u32 s50, s81, 3145856
    buffer_load_dwordx4 v150, s[8:11], s50 offen lds
    s_add_u32 m0, s90, 26624
    s_add_u32 s50, s81, 3145984
    buffer_load_dwordx4 v150, s[8:11], s50 offen lds
    s_add_u32 m0, s90, 27648
    s_add_u32 s50, s81, 3342336
    buffer_load_dwordx4 v150, s[8:11], s50 offen lds
    s_add_u32 m0, s90, 28672
    s_add_u32 s50, s81, 3342464
    buffer_load_dwordx4 v150, s[8:11], s50 offen lds
    s_add_u32 m0, s90, 29696
    s_add_u32 s50, s81, 3342592
    buffer_load_dwordx4 v150, s[8:11], s50 offen lds
    v_mfma_f32_16x16x32_bf16 v[128:131], v[36:39], v[204:207], v[128:131]
    v_mfma_f32_16x16x32_bf16 v[132:135], v[36:39], v[208:211], v[132:135]
    v_mfma_f32_16x16x32_bf16 v[128:131], v[40:43], v[212:215], v[128:131]
    v_mfma_f32_16x16x32_bf16 v[132:135], v[40:43], v[216:219], v[132:135]
    v_cvt_pk_bf16_f32 v136, v136, v137
    v_cvt_pk_bf16_f32 v137, v138, v139
    v_accvgpr_write_b32 a18, v136
    v_accvgpr_write_b32 a19, v137
    v_cvt_pk_bf16_f32 v140, v140, v141
    v_cvt_pk_bf16_f32 v141, v142, v143
    v_accvgpr_write_b32 a98, v140
    v_accvgpr_write_b32 a99, v141
    v_mfma_f32_16x16x32_bf16 v[128:131], v[44:47], v[220:223], v[128:131]
    v_mfma_f32_16x16x32_bf16 v[132:135], v[44:47], v[224:227], v[132:135]
    v_mfma_f32_16x16x32_bf16 v[128:131], v[48:51], v[228:231], v[128:131]
    v_mfma_f32_16x16x32_bf16 v[132:135], v[48:51], v[232:235], v[132:135]
    v_mfma_f32_16x16x32_bf16 v[128:131], v[52:55], v[236:239], v[128:131]
    v_mfma_f32_16x16x32_bf16 v[132:135], v[52:55], v[240:243], v[132:135]
    s_waitcnt vmcnt(24)
    ds_read_b128 v[32:35], v151 offset:0
    ds_read_b128 v[36:39], v152 offset:0
    ds_read_b128 v[40:43], v151 offset:1024
    ds_read_b128 v[44:47], v152 offset:1024
    ds_read_b128 v[48:51], v151 offset:2048
    ds_read_b128 v[52:55], v152 offset:2048
    s_waitcnt lgkmcnt(6)
    v_mfma_f32_16x16x32_bf16 v[136:139], v[56:59], v[196:199], 0
    v_mfma_f32_16x16x32_bf16 v[140:143], v[56:59], v[200:203], 0
    s_add_u32 m0, s90, 30720
    s_add_u32 s50, s81, 3194880
    buffer_load_dwordx4 v150, s[8:11], s50 offen lds
    s_add_u32 m0, s90, 31744
    s_add_u32 s50, s81, 3195008
    buffer_load_dwordx4 v150, s[8:11], s50 offen lds
    s_add_u32 m0, s90, 32768
    s_add_u32 s50, s81, 3195136
    buffer_load_dwordx4 v150, s[8:11], s50 offen lds
    s_add_u32 m0, s90, 33792
    s_add_u32 s50, s81, 3391488
    buffer_load_dwordx4 v150, s[8:11], s50 offen lds
    s_add_u32 m0, s90, 34816
    s_add_u32 s50, s81, 3391616
    buffer_load_dwordx4 v150, s[8:11], s50 offen lds
    s_add_u32 m0, s90, 35840
    s_add_u32 s50, s81, 3391744
    buffer_load_dwordx4 v150, s[8:11], s50 offen lds
    v_mfma_f32_16x16x32_bf16 v[136:139], v[60:63], v[204:207], v[136:139]
    v_mfma_f32_16x16x32_bf16 v[140:143], v[60:63], v[208:211], v[140:143]
    v_mfma_f32_16x16x32_bf16 v[136:139], v[64:67], v[212:215], v[136:139]
    v_mfma_f32_16x16x32_bf16 v[140:143], v[64:67], v[216:219], v[140:143]
    v_cvt_pk_bf16_f32 v128, v128, v129
    v_cvt_pk_bf16_f32 v129, v130, v131
    v_accvgpr_write_b32 a20, v128
    v_accvgpr_write_b32 a21, v129
    v_cvt_pk_bf16_f32 v132, v132, v133
    v_cvt_pk_bf16_f32 v133, v134, v135
    v_accvgpr_write_b32 a100, v132
    v_accvgpr_write_b32 a101, v133
    v_mfma_f32_16x16x32_bf16 v[136:139], v[68:71], v[220:223], v[136:139]
    v_mfma_f32_16x16x32_bf16 v[140:143], v[68:71], v[224:227], v[140:143]
    v_mfma_f32_16x16x32_bf16 v[136:139], v[72:75], v[228:231], v[136:139]
    v_mfma_f32_16x16x32_bf16 v[140:143], v[72:75], v[232:235], v[140:143]
    v_mfma_f32_16x16x32_bf16 v[136:139], v[76:79], v[236:239], v[136:139]
    v_mfma_f32_16x16x32_bf16 v[140:143], v[76:79], v[240:243], v[140:143]
    s_waitcnt vmcnt(24)
    ds_read_b128 v[56:59], v151 offset:6144
    ds_read_b128 v[60:63], v152 offset:6144
    ds_read_b128 v[64:67], v151 offset:7168
    ds_read_b128 v[68:71], v152 offset:7168
    ds_read_b128 v[72:75], v151 offset:8192
    ds_read_b128 v[76:79], v152 offset:8192
    s_waitcnt lgkmcnt(6)
    v_mfma_f32_16x16x32_bf16 v[128:131], v[32:35], v[196:199], 0
    v_mfma_f32_16x16x32_bf16 v[132:135], v[32:35], v[200:203], 0
    s_add_u32 m0, s90, 0
    s_add_u32 s50, s81, 3538944
    buffer_load_dwordx4 v150, s[8:11], s50 offen lds
    s_add_u32 m0, s90, 1024
    s_add_u32 s50, s81, 3539072
    buffer_load_dwordx4 v150, s[8:11], s50 offen lds
    s_add_u32 m0, s90, 2048
    s_add_u32 s50, s81, 3539200
    buffer_load_dwordx4 v150, s[8:11], s50 offen lds
    s_add_u32 m0, s90, 3072
    s_add_u32 s50, s81, 3735552
    buffer_load_dwordx4 v150, s[8:11], s50 offen lds
    s_add_u32 m0, s90, 4096
    s_add_u32 s50, s81, 3735680
    buffer_load_dwordx4 v150, s[8:11], s50 offen lds
    s_add_u32 m0, s90, 5120
    s_add_u32 s50, s81, 3735808
    buffer_load_dwordx4 v150, s[8:11], s50 offen lds
    v_mfma_f32_16x16x32_bf16 v[128:131], v[36:39], v[204:207], v[128:131]
    v_mfma_f32_16x16x32_bf16 v[132:135], v[36:39], v[208:211], v[132:135]
    v_mfma_f32_16x16x32_bf16 v[128:131], v[40:43], v[212:215], v[128:131]
    v_mfma_f32_16x16x32_bf16 v[132:135], v[40:43], v[216:219], v[132:135]
    v_cvt_pk_bf16_f32 v136, v136, v137
    v_cvt_pk_bf16_f32 v137, v138, v139
    v_accvgpr_write_b32 a22, v136
    v_accvgpr_write_b32 a23, v137
    v_cvt_pk_bf16_f32 v140, v140, v141
    v_cvt_pk_bf16_f32 v141, v142, v143
    v_accvgpr_write_b32 a102, v140
    v_accvgpr_write_b32 a103, v141
    v_mfma_f32_16x16x32_bf16 v[128:131], v[44:47], v[220:223], v[128:131]
    v_mfma_f32_16x16x32_bf16 v[132:135], v[44:47], v[224:227], v[132:135]
    v_mfma_f32_16x16x32_bf16 v[128:131], v[48:51], v[228:231], v[128:131]
    v_mfma_f32_16x16x32_bf16 v[132:135], v[48:51], v[232:235], v[132:135]
    v_mfma_f32_16x16x32_bf16 v[128:131], v[52:55], v[236:239], v[128:131]
    v_mfma_f32_16x16x32_bf16 v[132:135], v[52:55], v[240:243], v[132:135]
    s_waitcnt vmcnt(24)
    ds_read_b128 v[32:35], v151 offset:12288
    ds_read_b128 v[36:39], v152 offset:12288
    ds_read_b128 v[40:43], v151 offset:13312
    ds_read_b128 v[44:47], v152 offset:13312
    ds_read_b128 v[48:51], v151 offset:14336
    ds_read_b128 v[52:55], v152 offset:14336
    s_waitcnt lgkmcnt(6)
    v_mfma_f32_16x16x32_bf16 v[136:139], v[56:59], v[196:199], 0
    v_mfma_f32_16x16x32_bf16 v[140:143], v[56:59], v[200:203], 0
    s_add_u32 m0, s90, 6144
    s_add_u32 s50, s81, 3588096
    buffer_load_dwordx4 v150, s[8:11], s50 offen lds
    s_add_u32 m0, s90, 7168
    s_add_u32 s50, s81, 3588224
    buffer_load_dwordx4 v150, s[8:11], s50 offen lds
    s_add_u32 m0, s90, 8192
    s_add_u32 s50, s81, 3588352
    buffer_load_dwordx4 v150, s[8:11], s50 offen lds
    s_add_u32 m0, s90, 9216
    s_add_u32 s50, s81, 3784704
    buffer_load_dwordx4 v150, s[8:11], s50 offen lds
    s_add_u32 m0, s90, 10240
    s_add_u32 s50, s81, 3784832
    buffer_load_dwordx4 v150, s[8:11], s50 offen lds
    s_add_u32 m0, s90, 11264
    s_add_u32 s50, s81, 3784960
    buffer_load_dwordx4 v150, s[8:11], s50 offen lds
    v_mfma_f32_16x16x32_bf16 v[136:139], v[60:63], v[204:207], v[136:139]
    v_mfma_f32_16x16x32_bf16 v[140:143], v[60:63], v[208:211], v[140:143]
    v_mfma_f32_16x16x32_bf16 v[136:139], v[64:67], v[212:215], v[136:139]
    v_mfma_f32_16x16x32_bf16 v[140:143], v[64:67], v[216:219], v[140:143]
    v_cvt_pk_bf16_f32 v128, v128, v129
    v_cvt_pk_bf16_f32 v129, v130, v131
    v_accvgpr_write_b32 a24, v128
    v_accvgpr_write_b32 a25, v129
    v_cvt_pk_bf16_f32 v132, v132, v133
    v_cvt_pk_bf16_f32 v133, v134, v135
    v_accvgpr_write_b32 a104, v132
    v_accvgpr_write_b32 a105, v133
    v_mfma_f32_16x16x32_bf16 v[136:139], v[68:71], v[220:223], v[136:139]
    v_mfma_f32_16x16x32_bf16 v[140:143], v[68:71], v[224:227], v[140:143]
    v_mfma_f32_16x16x32_bf16 v[136:139], v[72:75], v[228:231], v[136:139]
    v_mfma_f32_16x16x32_bf16 v[140:143], v[72:75], v[232:235], v[140:143]
    v_mfma_f32_16x16x32_bf16 v[136:139], v[76:79], v[236:239], v[136:139]
    v_mfma_f32_16x16x32_bf16 v[140:143], v[76:79], v[240:243], v[140:143]
    s_waitcnt vmcnt(24)
    ds_read_b128 v[56:59], v151 offset:18432
    ds_read_b128 v[60:63], v152 offset:18432
    ds_read_b128 v[64:67], v151 offset:19456
    ds_read_b128 v[68:71], v152 offset:19456
    ds_read_b128 v[72:75], v151 offset:20480
    ds_read_b128 v[76:79], v152 offset:20480
    s_waitcnt lgkmcnt(6)
    v_mfma_f32_16x16x32_bf16 v[128:131], v[32:35], v[196:199], 0
    v_mfma_f32_16x16x32_bf16 v[132:135], v[32:35], v[200:203], 0
    s_add_u32 m0, s90, 12288
    s_add_u32 s50, s81, 3932160
    buffer_load_dwordx4 v150, s[8:11], s50 offen lds
    s_add_u32 m0, s90, 13312
    s_add_u32 s50, s81, 3932288
    buffer_load_dwordx4 v150, s[8:11], s50 offen lds
    s_add_u32 m0, s90, 14336
    s_add_u32 s50, s81, 3932416
    buffer_load_dwordx4 v150, s[8:11], s50 offen lds
    s_add_u32 m0, s90, 15360
    s_add_u32 s50, s81, 4128768
    buffer_load_dwordx4 v150, s[8:11], s50 offen lds
    s_add_u32 m0, s90, 16384
    s_add_u32 s50, s81, 4128896
    buffer_load_dwordx4 v150, s[8:11], s50 offen lds
    s_add_u32 m0, s90, 17408
    s_add_u32 s50, s81, 4129024
    buffer_load_dwordx4 v150, s[8:11], s50 offen lds
    v_mfma_f32_16x16x32_bf16 v[128:131], v[36:39], v[204:207], v[128:131]
    v_mfma_f32_16x16x32_bf16 v[132:135], v[36:39], v[208:211], v[132:135]
    v_mfma_f32_16x16x32_bf16 v[128:131], v[40:43], v[212:215], v[128:131]
    v_mfma_f32_16x16x32_bf16 v[132:135], v[40:43], v[216:219], v[132:135]
    v_cvt_pk_bf16_f32 v136, v136, v137
    v_cvt_pk_bf16_f32 v137, v138, v139
    v_accvgpr_write_b32 a26, v136
    v_accvgpr_write_b32 a27, v137
    v_cvt_pk_bf16_f32 v140, v140, v141
    v_cvt_pk_bf16_f32 v141, v142, v143
    v_accvgpr_write_b32 a106, v140
    v_accvgpr_write_b32 a107, v141
    v_mfma_f32_16x16x32_bf16 v[128:131], v[44:47], v[220:223], v[128:131]
    v_mfma_f32_16x16x32_bf16 v[132:135], v[44:47], v[224:227], v[132:135]
    v_mfma_f32_16x16x32_bf16 v[128:131], v[48:51], v[228:231], v[128:131]
    v_mfma_f32_16x16x32_bf16 v[132:135], v[48:51], v[232:235], v[132:135]
    v_mfma_f32_16x16x32_bf16 v[128:131], v[52:55], v[236:239], v[128:131]
    v_mfma_f32_16x16x32_bf16 v[132:135], v[52:55], v[240:243], v[132:135]
    s_waitcnt vmcnt(24)
    ds_read_b128 v[32:35], v151 offset:24576
    ds_read_b128 v[36:39], v152 offset:24576
    ds_read_b128 v[40:43], v151 offset:25600
    ds_read_b128 v[44:47], v152 offset:25600
    ds_read_b128 v[48:51], v151 offset:26624
    ds_read_b128 v[52:55], v152 offset:26624
    s_waitcnt lgkmcnt(6)
    v_mfma_f32_16x16x32_bf16 v[136:139], v[56:59], v[196:199], 0
    v_mfma_f32_16x16x32_bf16 v[140:143], v[56:59], v[200:203], 0
    s_add_u32 m0, s90, 18432
    s_add_u32 s50, s81, 3981312
    buffer_load_dwordx4 v150, s[8:11], s50 offen lds
    s_add_u32 m0, s90, 19456
    s_add_u32 s50, s81, 3981440
    buffer_load_dwordx4 v150, s[8:11], s50 offen lds
    s_add_u32 m0, s90, 20480
    s_add_u32 s50, s81, 3981568
    buffer_load_dwordx4 v150, s[8:11], s50 offen lds
    s_add_u32 m0, s90, 21504
    s_add_u32 s50, s81, 4177920
    buffer_load_dwordx4 v150, s[8:11], s50 offen lds
    s_add_u32 m0, s90, 22528
    s_add_u32 s50, s81, 4178048
    buffer_load_dwordx4 v150, s[8:11], s50 offen lds
    s_add_u32 m0, s90, 23552
    s_add_u32 s50, s81, 4178176
    buffer_load_dwordx4 v150, s[8:11], s50 offen lds
    v_mfma_f32_16x16x32_bf16 v[136:139], v[60:63], v[204:207], v[136:139]
    v_mfma_f32_16x16x32_bf16 v[140:143], v[60:63], v[208:211], v[140:143]
    v_mfma_f32_16x16x32_bf16 v[136:139], v[64:67], v[212:215], v[136:139]
    v_mfma_f32_16x16x32_bf16 v[140:143], v[64:67], v[216:219], v[140:143]
    v_cvt_pk_bf16_f32 v128, v128, v129
    v_cvt_pk_bf16_f32 v129, v130, v131
    v_accvgpr_write_b32 a28, v128
    v_accvgpr_write_b32 a29, v129
    v_cvt_pk_bf16_f32 v132, v132, v133
    v_cvt_pk_bf16_f32 v133, v134, v135
    v_accvgpr_write_b32 a108, v132
    v_accvgpr_write_b32 a109, v133
    v_mfma_f32_16x16x32_bf16 v[136:139], v[68:71], v[220:223], v[136:139]
    v_mfma_f32_16x16x32_bf16 v[140:143], v[68:71], v[224:227], v[140:143]
    v_mfma_f32_16x16x32_bf16 v[136:139], v[72:75], v[228:231], v[136:139]
    v_mfma_f32_16x16x32_bf16 v[140:143], v[72:75], v[232:235], v[140:143]
    v_mfma_f32_16x16x32_bf16 v[136:139], v[76:79], v[236:239], v[136:139]
    v_mfma_f32_16x16x32_bf16 v[140:143], v[76:79], v[240:243], v[140:143]
    s_waitcnt vmcnt(24)
    ds_read_b128 v[56:59], v151 offset:30720
    ds_read_b128 v[60:63], v152 offset:30720
    ds_read_b128 v[64:67], v151 offset:31744
    ds_read_b128 v[68:71], v152 offset:31744
    ds_read_b128 v[72:75], v151 offset:32768
    ds_read_b128 v[76:79], v152 offset:32768
    s_waitcnt lgkmcnt(6)
    v_mfma_f32_16x16x32_bf16 v[128:131], v[32:35], v[196:199], 0
    v_mfma_f32_16x16x32_bf16 v[132:135], v[32:35], v[200:203], 0
    s_add_u32 m0, s90, 24576
    s_add_u32 s50, s81, 4325376
    buffer_load_dwordx4 v150, s[8:11], s50 offen lds
    s_add_u32 m0, s90, 25600
    s_add_u32 s50, s81, 4325504
    buffer_load_dwordx4 v150, s[8:11], s50 offen lds
    s_add_u32 m0, s90, 26624
    s_add_u32 s50, s81, 4325632
    buffer_load_dwordx4 v150, s[8:11], s50 offen lds
    s_add_u32 m0, s90, 27648
    s_add_u32 s50, s81, 4521984
    buffer_load_dwordx4 v150, s[8:11], s50 offen lds
    s_add_u32 m0, s90, 28672
    s_add_u32 s50, s81, 4522112
    buffer_load_dwordx4 v150, s[8:11], s50 offen lds
    s_add_u32 m0, s90, 29696
    s_add_u32 s50, s81, 4522240
    buffer_load_dwordx4 v150, s[8:11], s50 offen lds
    v_mfma_f32_16x16x32_bf16 v[128:131], v[36:39], v[204:207], v[128:131]
    v_mfma_f32_16x16x32_bf16 v[132:135], v[36:39], v[208:211], v[132:135]
    v_mfma_f32_16x16x32_bf16 v[128:131], v[40:43], v[212:215], v[128:131]
    v_mfma_f32_16x16x32_bf16 v[132:135], v[40:43], v[216:219], v[132:135]
    v_cvt_pk_bf16_f32 v136, v136, v137
    v_cvt_pk_bf16_f32 v137, v138, v139
    v_accvgpr_write_b32 a30, v136
    v_accvgpr_write_b32 a31, v137
    v_cvt_pk_bf16_f32 v140, v140, v141
    v_cvt_pk_bf16_f32 v141, v142, v143
    v_accvgpr_write_b32 a110, v140
    v_accvgpr_write_b32 a111, v141
    v_mfma_f32_16x16x32_bf16 v[128:131], v[44:47], v[220:223], v[128:131]
    v_mfma_f32_16x16x32_bf16 v[132:135], v[44:47], v[224:227], v[132:135]
    v_mfma_f32_16x16x32_bf16 v[128:131], v[48:51], v[228:231], v[128:131]
    v_mfma_f32_16x16x32_bf16 v[132:135], v[48:51], v[232:235], v[132:135]
    v_mfma_f32_16x16x32_bf16 v[128:131], v[52:55], v[236:239], v[128:131]
    v_mfma_f32_16x16x32_bf16 v[132:135], v[52:55], v[240:243], v[132:135]
    s_waitcnt vmcnt(24)
    ds_read_b128 v[32:35], v151 offset:0
    ds_read_b128 v[36:39], v152 offset:0
    ds_read_b128 v[40:43], v151 offset:1024
    ds_read_b128 v[44:47], v152 offset:1024
    ds_read_b128 v[48:51], v151 offset:2048
    ds_read_b128 v[52:55], v152 offset:2048
    s_waitcnt lgkmcnt(6)
    v_mfma_f32_16x16x32_bf16 v[136:139], v[56:59], v[196:199], 0
    v_mfma_f32_16x16x32_bf16 v[140:143], v[56:59], v[200:203], 0
    s_add_u32 m0, s90, 30720
    s_add_u32 s50, s81, 4374528
    buffer_load_dwordx4 v150, s[8:11], s50 offen lds
    s_add_u32 m0, s90, 31744
    s_add_u32 s50, s81, 4374656
    buffer_load_dwordx4 v150, s[8:11], s50 offen lds
    s_add_u32 m0, s90, 32768
    s_add_u32 s50, s81, 4374784
    buffer_load_dwordx4 v150, s[8:11], s50 offen lds
    s_add_u32 m0, s90, 33792
    s_add_u32 s50, s81, 4571136
    buffer_load_dwordx4 v150, s[8:11], s50 offen lds
    s_add_u32 m0, s90, 34816
    s_add_u32 s50, s81, 4571264
    buffer_load_dwordx4 v150, s[8:11], s50 offen lds
    s_add_u32 m0, s90, 35840
    s_add_u32 s50, s81, 4571392
    buffer_load_dwordx4 v150, s[8:11], s50 offen lds
    v_mfma_f32_16x16x32_bf16 v[136:139], v[60:63], v[204:207], v[136:139]
    v_mfma_f32_16x16x32_bf16 v[140:143], v[60:63], v[208:211], v[140:143]
    v_mfma_f32_16x16x32_bf16 v[136:139], v[64:67], v[212:215], v[136:139]
    v_mfma_f32_16x16x32_bf16 v[140:143], v[64:67], v[216:219], v[140:143]
    v_cvt_pk_bf16_f32 v128, v128, v129
    v_cvt_pk_bf16_f32 v129, v130, v131
    v_accvgpr_write_b32 a32, v128
    v_accvgpr_write_b32 a33, v129
    v_cvt_pk_bf16_f32 v132, v132, v133
    v_cvt_pk_bf16_f32 v133, v134, v135
    v_accvgpr_write_b32 a112, v132
    v_accvgpr_write_b32 a113, v133
    v_mfma_f32_16x16x32_bf16 v[136:139], v[68:71], v[220:223], v[136:139]
    v_mfma_f32_16x16x32_bf16 v[140:143], v[68:71], v[224:227], v[140:143]
    v_mfma_f32_16x16x32_bf16 v[136:139], v[72:75], v[228:231], v[136:139]
    v_mfma_f32_16x16x32_bf16 v[140:143], v[72:75], v[232:235], v[140:143]
    v_mfma_f32_16x16x32_bf16 v[136:139], v[76:79], v[236:239], v[136:139]
    v_mfma_f32_16x16x32_bf16 v[140:143], v[76:79], v[240:243], v[140:143]
    s_waitcnt vmcnt(24)
    ds_read_b128 v[56:59], v151 offset:6144
    ds_read_b128 v[60:63], v152 offset:6144
    ds_read_b128 v[64:67], v151 offset:7168
    ds_read_b128 v[68:71], v152 offset:7168
    ds_read_b128 v[72:75], v151 offset:8192
    ds_read_b128 v[76:79], v152 offset:8192
    s_waitcnt lgkmcnt(6)
    v_mfma_f32_16x16x32_bf16 v[128:131], v[32:35], v[196:199], 0
    v_mfma_f32_16x16x32_bf16 v[132:135], v[32:35], v[200:203], 0
    s_add_u32 m0, s90, 0
    s_add_u32 s50, s81, 4718592
    buffer_load_dwordx4 v150, s[8:11], s50 offen lds
    s_add_u32 m0, s90, 1024
    s_add_u32 s50, s81, 4718720
    buffer_load_dwordx4 v150, s[8:11], s50 offen lds
    s_add_u32 m0, s90, 2048
    s_add_u32 s50, s81, 4718848
    buffer_load_dwordx4 v150, s[8:11], s50 offen lds
    s_add_u32 m0, s90, 3072
    s_add_u32 s50, s81, 4915200
    buffer_load_dwordx4 v150, s[8:11], s50 offen lds
    s_add_u32 m0, s90, 4096
    s_add_u32 s50, s81, 4915328
    buffer_load_dwordx4 v150, s[8:11], s50 offen lds
    s_add_u32 m0, s90, 5120
    s_add_u32 s50, s81, 4915456
    buffer_load_dwordx4 v150, s[8:11], s50 offen lds
    v_mfma_f32_16x16x32_bf16 v[128:131], v[36:39], v[204:207], v[128:131]
    v_mfma_f32_16x16x32_bf16 v[132:135], v[36:39], v[208:211], v[132:135]
    v_mfma_f32_16x16x32_bf16 v[128:131], v[40:43], v[212:215], v[128:131]
    v_mfma_f32_16x16x32_bf16 v[132:135], v[40:43], v[216:219], v[132:135]
    v_cvt_pk_bf16_f32 v136, v136, v137
    v_cvt_pk_bf16_f32 v137, v138, v139
    v_accvgpr_write_b32 a34, v136
    v_accvgpr_write_b32 a35, v137
    v_cvt_pk_bf16_f32 v140, v140, v141
    v_cvt_pk_bf16_f32 v141, v142, v143
    v_accvgpr_write_b32 a114, v140
    v_accvgpr_write_b32 a115, v141
    v_mfma_f32_16x16x32_bf16 v[128:131], v[44:47], v[220:223], v[128:131]
    v_mfma_f32_16x16x32_bf16 v[132:135], v[44:47], v[224:227], v[132:135]
    v_mfma_f32_16x16x32_bf16 v[128:131], v[48:51], v[228:231], v[128:131]
    v_mfma_f32_16x16x32_bf16 v[132:135], v[48:51], v[232:235], v[132:135]
    v_mfma_f32_16x16x32_bf16 v[128:131], v[52:55], v[236:239], v[128:131]
    v_mfma_f32_16x16x32_bf16 v[132:135], v[52:55], v[240:243], v[132:135]
    s_waitcnt vmcnt(24)
    ds_read_b128 v[32:35], v151 offset:12288
    ds_read_b128 v[36:39], v152 offset:12288
    ds_read_b128 v[40:43], v151 offset:13312
    ds_read_b128 v[44:47], v152 offset:13312
    ds_read_b128 v[48:51], v151 offset:14336
    ds_read_b128 v[52:55], v152 offset:14336
    s_waitcnt lgkmcnt(6)
    v_mfma_f32_16x16x32_bf16 v[136:139], v[56:59], v[196:199], 0
    v_mfma_f32_16x16x32_bf16 v[140:143], v[56:59], v[200:203], 0
    s_add_u32 m0, s90, 6144
    s_add_u32 s50, s81, 4767744
    buffer_load_dwordx4 v150, s[8:11], s50 offen lds
    s_add_u32 m0, s90, 7168
    s_add_u32 s50, s81, 4767872
    buffer_load_dwordx4 v150, s[8:11], s50 offen lds
    s_add_u32 m0, s90, 8192
    s_add_u32 s50, s81, 4768000
    buffer_load_dwordx4 v150, s[8:11], s50 offen lds
    s_add_u32 m0, s90, 9216
    s_add_u32 s50, s81, 4964352
    buffer_load_dwordx4 v150, s[8:11], s50 offen lds
    s_add_u32 m0, s90, 10240
    s_add_u32 s50, s81, 4964480
    buffer_load_dwordx4 v150, s[8:11], s50 offen lds
    s_add_u32 m0, s90, 11264
    s_add_u32 s50, s81, 4964608
    buffer_load_dwordx4 v150, s[8:11], s50 offen lds
    v_mfma_f32_16x16x32_bf16 v[136:139], v[60:63], v[204:207], v[136:139]
    v_mfma_f32_16x16x32_bf16 v[140:143], v[60:63], v[208:211], v[140:143]
    v_mfma_f32_16x16x32_bf16 v[136:139], v[64:67], v[212:215], v[136:139]
    v_mfma_f32_16x16x32_bf16 v[140:143], v[64:67], v[216:219], v[140:143]
    v_cvt_pk_bf16_f32 v128, v128, v129
    v_cvt_pk_bf16_f32 v129, v130, v131
    v_accvgpr_write_b32 a36, v128
    v_accvgpr_write_b32 a37, v129
    v_cvt_pk_bf16_f32 v132, v132, v133
    v_cvt_pk_bf16_f32 v133, v134, v135
    v_accvgpr_write_b32 a116, v132
    v_accvgpr_write_b32 a117, v133
    v_mfma_f32_16x16x32_bf16 v[136:139], v[68:71], v[220:223], v[136:139]
    v_mfma_f32_16x16x32_bf16 v[140:143], v[68:71], v[224:227], v[140:143]
    v_mfma_f32_16x16x32_bf16 v[136:139], v[72:75], v[228:231], v[136:139]
    v_mfma_f32_16x16x32_bf16 v[140:143], v[72:75], v[232:235], v[140:143]
    v_mfma_f32_16x16x32_bf16 v[136:139], v[76:79], v[236:239], v[136:139]
    v_mfma_f32_16x16x32_bf16 v[140:143], v[76:79], v[240:243], v[140:143]
    s_waitcnt vmcnt(24)
    ds_read_b128 v[56:59], v151 offset:18432
    ds_read_b128 v[60:63], v152 offset:18432
    ds_read_b128 v[64:67], v151 offset:19456
    ds_read_b128 v[68:71], v152 offset:19456
    ds_read_b128 v[72:75], v151 offset:20480
    ds_read_b128 v[76:79], v152 offset:20480
    s_waitcnt lgkmcnt(6)
    v_mfma_f32_16x16x32_bf16 v[128:131], v[32:35], v[196:199], 0
    v_mfma_f32_16x16x32_bf16 v[132:135], v[32:35], v[200:203], 0
    s_add_u32 m0, s90, 12288
    s_add_u32 s50, s81, 5111808
    buffer_load_dwordx4 v150, s[8:11], s50 offen lds
    s_add_u32 m0, s90, 13312
    s_add_u32 s50, s81, 5111936
    buffer_load_dwordx4 v150, s[8:11], s50 offen lds
    s_add_u32 m0, s90, 14336
    s_add_u32 s50, s81, 5112064
    buffer_load_dwordx4 v150, s[8:11], s50 offen lds
    s_add_u32 m0, s90, 15360
    s_add_u32 s50, s81, 5308416
    buffer_load_dwordx4 v150, s[8:11], s50 offen lds
    s_add_u32 m0, s90, 16384
    s_add_u32 s50, s81, 5308544
    buffer_load_dwordx4 v150, s[8:11], s50 offen lds
    s_add_u32 m0, s90, 17408
    s_add_u32 s50, s81, 5308672
    buffer_load_dwordx4 v150, s[8:11], s50 offen lds
    v_mfma_f32_16x16x32_bf16 v[128:131], v[36:39], v[204:207], v[128:131]
    v_mfma_f32_16x16x32_bf16 v[132:135], v[36:39], v[208:211], v[132:135]
    v_mfma_f32_16x16x32_bf16 v[128:131], v[40:43], v[212:215], v[128:131]
    v_mfma_f32_16x16x32_bf16 v[132:135], v[40:43], v[216:219], v[132:135]
    v_cvt_pk_bf16_f32 v136, v136, v137
    v_cvt_pk_bf16_f32 v137, v138, v139
    v_accvgpr_write_b32 a38, v136
    v_accvgpr_write_b32 a39, v137
    v_cvt_pk_bf16_f32 v140, v140, v141
    v_cvt_pk_bf16_f32 v141, v142, v143
    v_accvgpr_write_b32 a118, v140
    v_accvgpr_write_b32 a119, v141
    v_mfma_f32_16x16x32_bf16 v[128:131], v[44:47], v[220:223], v[128:131]
    v_mfma_f32_16x16x32_bf16 v[132:135], v[44:47], v[224:227], v[132:135]
    v_mfma_f32_16x16x32_bf16 v[128:131], v[48:51], v[228:231], v[128:131]
    v_mfma_f32_16x16x32_bf16 v[132:135], v[48:51], v[232:235], v[132:135]
    v_mfma_f32_16x16x32_bf16 v[128:131], v[52:55], v[236:239], v[128:131]
    v_mfma_f32_16x16x32_bf16 v[132:135], v[52:55], v[240:243], v[132:135]
    s_waitcnt vmcnt(24)
    ds_read_b128 v[32:35], v151 offset:24576
    ds_read_b128 v[36:39], v152 offset:24576
    ds_read_b128 v[40:43], v151 offset:25600
    ds_read_b128 v[44:47], v152 offset:25600
    ds_read_b128 v[48:51], v151 offset:26624
    ds_read_b128 v[52:55], v152 offset:26624
    s_waitcnt lgkmcnt(6)
    v_mfma_f32_16x16x32_bf16 v[136:139], v[56:59], v[196:199], 0
    v_mfma_f32_16x16x32_bf16 v[140:143], v[56:59], v[200:203], 0
    s_add_u32 m0, s90, 18432
    s_add_u32 s50, s81, 5160960
    buffer_load_dwordx4 v150, s[8:11], s50 offen lds
    s_add_u32 m0, s90, 19456
    s_add_u32 s50, s81, 5161088
    buffer_load_dwordx4 v150, s[8:11], s50 offen lds
    s_add_u32 m0, s90, 20480
    s_add_u32 s50, s81, 5161216
    buffer_load_dwordx4 v150, s[8:11], s50 offen lds
    s_add_u32 m0, s90, 21504
    s_add_u32 s50, s81, 5357568
    buffer_load_dwordx4 v150, s[8:11], s50 offen lds
    s_add_u32 m0, s90, 22528
    s_add_u32 s50, s81, 5357696
    buffer_load_dwordx4 v150, s[8:11], s50 offen lds
    s_add_u32 m0, s90, 23552
    s_add_u32 s50, s81, 5357824
    buffer_load_dwordx4 v150, s[8:11], s50 offen lds
    v_mfma_f32_16x16x32_bf16 v[136:139], v[60:63], v[204:207], v[136:139]
    v_mfma_f32_16x16x32_bf16 v[140:143], v[60:63], v[208:211], v[140:143]
    v_mfma_f32_16x16x32_bf16 v[136:139], v[64:67], v[212:215], v[136:139]
    v_mfma_f32_16x16x32_bf16 v[140:143], v[64:67], v[216:219], v[140:143]
    v_cvt_pk_bf16_f32 v128, v128, v129
    v_cvt_pk_bf16_f32 v129, v130, v131
    v_accvgpr_write_b32 a40, v128
    v_accvgpr_write_b32 a41, v129
    v_cvt_pk_bf16_f32 v132, v132, v133
    v_cvt_pk_bf16_f32 v133, v134, v135
    v_accvgpr_write_b32 a120, v132
    v_accvgpr_write_b32 a121, v133
    v_mfma_f32_16x16x32_bf16 v[136:139], v[68:71], v[220:223], v[136:139]
    v_mfma_f32_16x16x32_bf16 v[140:143], v[68:71], v[224:227], v[140:143]
    v_mfma_f32_16x16x32_bf16 v[136:139], v[72:75], v[228:231], v[136:139]
    v_mfma_f32_16x16x32_bf16 v[140:143], v[72:75], v[232:235], v[140:143]
    v_mfma_f32_16x16x32_bf16 v[136:139], v[76:79], v[236:239], v[136:139]
    v_mfma_f32_16x16x32_bf16 v[140:143], v[76:79], v[240:243], v[140:143]
    s_waitcnt vmcnt(24)
    ds_read_b128 v[56:59], v151 offset:30720
    ds_read_b128 v[60:63], v152 offset:30720
    ds_read_b128 v[64:67], v151 offset:31744
    ds_read_b128 v[68:71], v152 offset:31744
    ds_read_b128 v[72:75], v151 offset:32768
    ds_read_b128 v[76:79], v152 offset:32768
    s_waitcnt lgkmcnt(6)
    v_mfma_f32_16x16x32_bf16 v[128:131], v[32:35], v[196:199], 0
    v_mfma_f32_16x16x32_bf16 v[132:135], v[32:35], v[200:203], 0
    s_add_u32 m0, s90, 24576
    s_add_u32 s50, s81, 5505024
    buffer_load_dwordx4 v150, s[8:11], s50 offen lds
    s_add_u32 m0, s90, 25600
    s_add_u32 s50, s81, 5505152
    buffer_load_dwordx4 v150, s[8:11], s50 offen lds
    s_add_u32 m0, s90, 26624
    s_add_u32 s50, s81, 5505280
    buffer_load_dwordx4 v150, s[8:11], s50 offen lds
    s_add_u32 m0, s90, 27648
    s_add_u32 s50, s81, 5701632
    buffer_load_dwordx4 v150, s[8:11], s50 offen lds
    s_add_u32 m0, s90, 28672
    s_add_u32 s50, s81, 5701760
    buffer_load_dwordx4 v150, s[8:11], s50 offen lds
    s_add_u32 m0, s90, 29696
    s_add_u32 s50, s81, 5701888
    buffer_load_dwordx4 v150, s[8:11], s50 offen lds
    v_mfma_f32_16x16x32_bf16 v[128:131], v[36:39], v[204:207], v[128:131]
    v_mfma_f32_16x16x32_bf16 v[132:135], v[36:39], v[208:211], v[132:135]
    v_mfma_f32_16x16x32_bf16 v[128:131], v[40:43], v[212:215], v[128:131]
    v_mfma_f32_16x16x32_bf16 v[132:135], v[40:43], v[216:219], v[132:135]
    v_cvt_pk_bf16_f32 v136, v136, v137
    v_cvt_pk_bf16_f32 v137, v138, v139
    v_accvgpr_write_b32 a42, v136
    v_accvgpr_write_b32 a43, v137
    v_cvt_pk_bf16_f32 v140, v140, v141
    v_cvt_pk_bf16_f32 v141, v142, v143
    v_accvgpr_write_b32 a122, v140
    v_accvgpr_write_b32 a123, v141
    v_mfma_f32_16x16x32_bf16 v[128:131], v[44:47], v[220:223], v[128:131]
    v_mfma_f32_16x16x32_bf16 v[132:135], v[44:47], v[224:227], v[132:135]
    v_mfma_f32_16x16x32_bf16 v[128:131], v[48:51], v[228:231], v[128:131]
    v_mfma_f32_16x16x32_bf16 v[132:135], v[48:51], v[232:235], v[132:135]
    v_mfma_f32_16x16x32_bf16 v[128:131], v[52:55], v[236:239], v[128:131]
    v_mfma_f32_16x16x32_bf16 v[132:135], v[52:55], v[240:243], v[132:135]
    s_waitcnt vmcnt(24)
    ds_read_b128 v[32:35], v151 offset:0
    ds_read_b128 v[36:39], v152 offset:0
    ds_read_b128 v[40:43], v151 offset:1024
    ds_read_b128 v[44:47], v152 offset:1024
    ds_read_b128 v[48:51], v151 offset:2048
    ds_read_b128 v[52:55], v152 offset:2048
    s_waitcnt lgkmcnt(6)
    v_mfma_f32_16x16x32_bf16 v[136:139], v[56:59], v[196:199], 0
    v_mfma_f32_16x16x32_bf16 v[140:143], v[56:59], v[200:203], 0
    s_add_u32 m0, s90, 30720
    s_add_u32 s50, s81, 5554176
    buffer_load_dwordx4 v150, s[8:11], s50 offen lds
    s_add_u32 m0, s90, 31744
    s_add_u32 s50, s81, 5554304
    buffer_load_dwordx4 v150, s[8:11], s50 offen lds
    s_add_u32 m0, s90, 32768
    s_add_u32 s50, s81, 5554432
    buffer_load_dwordx4 v150, s[8:11], s50 offen lds
    s_add_u32 m0, s90, 33792
    s_add_u32 s50, s81, 5750784
    buffer_load_dwordx4 v150, s[8:11], s50 offen lds
    s_add_u32 m0, s90, 34816
    s_add_u32 s50, s81, 5750912
    buffer_load_dwordx4 v150, s[8:11], s50 offen lds
    s_add_u32 m0, s90, 35840
    s_add_u32 s50, s81, 5751040
    buffer_load_dwordx4 v150, s[8:11], s50 offen lds
    v_mfma_f32_16x16x32_bf16 v[136:139], v[60:63], v[204:207], v[136:139]
    v_mfma_f32_16x16x32_bf16 v[140:143], v[60:63], v[208:211], v[140:143]
    v_mfma_f32_16x16x32_bf16 v[136:139], v[64:67], v[212:215], v[136:139]
    v_mfma_f32_16x16x32_bf16 v[140:143], v[64:67], v[216:219], v[140:143]
    v_cvt_pk_bf16_f32 v128, v128, v129
    v_cvt_pk_bf16_f32 v129, v130, v131
    v_accvgpr_write_b32 a44, v128
    v_accvgpr_write_b32 a45, v129
    v_cvt_pk_bf16_f32 v132, v132, v133
    v_cvt_pk_bf16_f32 v133, v134, v135
    v_accvgpr_write_b32 a124, v132
    v_accvgpr_write_b32 a125, v133
    v_mfma_f32_16x16x32_bf16 v[136:139], v[68:71], v[220:223], v[136:139]
    v_mfma_f32_16x16x32_bf16 v[140:143], v[68:71], v[224:227], v[140:143]
    v_mfma_f32_16x16x32_bf16 v[136:139], v[72:75], v[228:231], v[136:139]
    v_mfma_f32_16x16x32_bf16 v[140:143], v[72:75], v[232:235], v[140:143]
    v_mfma_f32_16x16x32_bf16 v[136:139], v[76:79], v[236:239], v[136:139]
    v_mfma_f32_16x16x32_bf16 v[140:143], v[76:79], v[240:243], v[140:143]
    s_waitcnt vmcnt(24)
    ds_read_b128 v[56:59], v151 offset:6144
    ds_read_b128 v[60:63], v152 offset:6144
    ds_read_b128 v[64:67], v151 offset:7168
    ds_read_b128 v[68:71], v152 offset:7168
    ds_read_b128 v[72:75], v151 offset:8192
    ds_read_b128 v[76:79], v152 offset:8192
    s_waitcnt lgkmcnt(6)
    v_mfma_f32_16x16x32_bf16 v[128:131], v[32:35], v[196:199], 0
    v_mfma_f32_16x16x32_bf16 v[132:135], v[32:35], v[200:203], 0
    s_add_u32 m0, s90, 0
    s_add_u32 s50, s81, 5898240
    buffer_load_dwordx4 v150, s[8:11], s50 offen lds
    s_add_u32 m0, s90, 1024
    s_add_u32 s50, s81, 5898368
    buffer_load_dwordx4 v150, s[8:11], s50 offen lds
    s_add_u32 m0, s90, 2048
    s_add_u32 s50, s81, 5898496
    buffer_load_dwordx4 v150, s[8:11], s50 offen lds
    s_add_u32 m0, s90, 3072
    s_add_u32 s50, s81, 6094848
    buffer_load_dwordx4 v150, s[8:11], s50 offen lds
    s_add_u32 m0, s90, 4096
    s_add_u32 s50, s81, 6094976
    buffer_load_dwordx4 v150, s[8:11], s50 offen lds
    s_add_u32 m0, s90, 5120
    s_add_u32 s50, s81, 6095104
    buffer_load_dwordx4 v150, s[8:11], s50 offen lds
    v_mfma_f32_16x16x32_bf16 v[128:131], v[36:39], v[204:207], v[128:131]
    v_mfma_f32_16x16x32_bf16 v[132:135], v[36:39], v[208:211], v[132:135]
    v_mfma_f32_16x16x32_bf16 v[128:131], v[40:43], v[212:215], v[128:131]
    v_mfma_f32_16x16x32_bf16 v[132:135], v[40:43], v[216:219], v[132:135]
    v_cvt_pk_bf16_f32 v136, v136, v137
    v_cvt_pk_bf16_f32 v137, v138, v139
    v_accvgpr_write_b32 a46, v136
    v_accvgpr_write_b32 a47, v137
    v_cvt_pk_bf16_f32 v140, v140, v141
    v_cvt_pk_bf16_f32 v141, v142, v143
    v_accvgpr_write_b32 a126, v140
    v_accvgpr_write_b32 a127, v141
    v_mfma_f32_16x16x32_bf16 v[128:131], v[44:47], v[220:223], v[128:131]
    v_mfma_f32_16x16x32_bf16 v[132:135], v[44:47], v[224:227], v[132:135]
    v_mfma_f32_16x16x32_bf16 v[128:131], v[48:51], v[228:231], v[128:131]
    v_mfma_f32_16x16x32_bf16 v[132:135], v[48:51], v[232:235], v[132:135]
    v_mfma_f32_16x16x32_bf16 v[128:131], v[52:55], v[236:239], v[128:131]
    v_mfma_f32_16x16x32_bf16 v[132:135], v[52:55], v[240:243], v[132:135]
    s_waitcnt vmcnt(24)
    ds_read_b128 v[32:35], v151 offset:12288
    ds_read_b128 v[36:39], v152 offset:12288
    ds_read_b128 v[40:43], v151 offset:13312
    ds_read_b128 v[44:47], v152 offset:13312
    ds_read_b128 v[48:51], v151 offset:14336
    ds_read_b128 v[52:55], v152 offset:14336
    s_waitcnt lgkmcnt(6)
    v_mfma_f32_16x16x32_bf16 v[136:139], v[56:59], v[196:199], 0
    v_mfma_f32_16x16x32_bf16 v[140:143], v[56:59], v[200:203], 0
    s_add_u32 m0, s90, 6144
    s_add_u32 s50, s81, 5947392
    buffer_load_dwordx4 v150, s[8:11], s50 offen lds
    s_add_u32 m0, s90, 7168
    s_add_u32 s50, s81, 5947520
    buffer_load_dwordx4 v150, s[8:11], s50 offen lds
    s_add_u32 m0, s90, 8192
    s_add_u32 s50, s81, 5947648
    buffer_load_dwordx4 v150, s[8:11], s50 offen lds
    s_add_u32 m0, s90, 9216
    s_add_u32 s50, s81, 6144000
    buffer_load_dwordx4 v150, s[8:11], s50 offen lds
    s_add_u32 m0, s90, 10240
    s_add_u32 s50, s81, 6144128
    buffer_load_dwordx4 v150, s[8:11], s50 offen lds
    s_add_u32 m0, s90, 11264
    s_add_u32 s50, s81, 6144256
    buffer_load_dwordx4 v150, s[8:11], s50 offen lds
    v_mfma_f32_16x16x32_bf16 v[136:139], v[60:63], v[204:207], v[136:139]
    v_mfma_f32_16x16x32_bf16 v[140:143], v[60:63], v[208:211], v[140:143]
    v_mfma_f32_16x16x32_bf16 v[136:139], v[64:67], v[212:215], v[136:139]
    v_mfma_f32_16x16x32_bf16 v[140:143], v[64:67], v[216:219], v[140:143]
    v_cvt_pk_bf16_f32 v128, v128, v129
    v_cvt_pk_bf16_f32 v129, v130, v131
    v_accvgpr_write_b32 a48, v128
    v_accvgpr_write_b32 a49, v129
    v_cvt_pk_bf16_f32 v132, v132, v133
    v_cvt_pk_bf16_f32 v133, v134, v135
    v_accvgpr_write_b32 a128, v132
    v_accvgpr_write_b32 a129, v133
    v_mfma_f32_16x16x32_bf16 v[136:139], v[68:71], v[220:223], v[136:139]
    v_mfma_f32_16x16x32_bf16 v[140:143], v[68:71], v[224:227], v[140:143]
    v_mfma_f32_16x16x32_bf16 v[136:139], v[72:75], v[228:231], v[136:139]
    v_mfma_f32_16x16x32_bf16 v[140:143], v[72:75], v[232:235], v[140:143]
    v_mfma_f32_16x16x32_bf16 v[136:139], v[76:79], v[236:239], v[136:139]
    v_mfma_f32_16x16x32_bf16 v[140:143], v[76:79], v[240:243], v[140:143]
    s_waitcnt vmcnt(24)
    ds_read_b128 v[56:59], v151 offset:18432
    ds_read_b128 v[60:63], v152 offset:18432
    ds_read_b128 v[64:67], v151 offset:19456
    ds_read_b128 v[68:71], v152 offset:19456
    ds_read_b128 v[72:75], v151 offset:20480
    ds_read_b128 v[76:79], v152 offset:20480
    s_waitcnt lgkmcnt(6)
    v_mfma_f32_16x16x32_bf16 v[128:131], v[32:35], v[196:199], 0
    v_mfma_f32_16x16x32_bf16 v[132:135], v[32:35], v[200:203], 0
    s_add_u32 m0, s90, 12288
    s_add_u32 s50, s81, 6291456
    buffer_load_dwordx4 v150, s[8:11], s50 offen lds
    s_add_u32 m0, s90, 13312
    s_add_u32 s50, s81, 6291584
    buffer_load_dwordx4 v150, s[8:11], s50 offen lds
    s_add_u32 m0, s90, 14336
    s_add_u32 s50, s81, 6291712
    buffer_load_dwordx4 v150, s[8:11], s50 offen lds
    s_add_u32 m0, s90, 15360
    s_add_u32 s50, s81, 6488064
    buffer_load_dwordx4 v150, s[8:11], s50 offen lds
    s_add_u32 m0, s90, 16384
    s_add_u32 s50, s81, 6488192
    buffer_load_dwordx4 v150, s[8:11], s50 offen lds
    s_add_u32 m0, s90, 17408
    s_add_u32 s50, s81, 6488320
    buffer_load_dwordx4 v150, s[8:11], s50 offen lds
    v_mfma_f32_16x16x32_bf16 v[128:131], v[36:39], v[204:207], v[128:131]
    v_mfma_f32_16x16x32_bf16 v[132:135], v[36:39], v[208:211], v[132:135]
    v_mfma_f32_16x16x32_bf16 v[128:131], v[40:43], v[212:215], v[128:131]
    v_mfma_f32_16x16x32_bf16 v[132:135], v[40:43], v[216:219], v[132:135]
    v_cvt_pk_bf16_f32 v136, v136, v137
    v_cvt_pk_bf16_f32 v137, v138, v139
    v_accvgpr_write_b32 a50, v136
    v_accvgpr_write_b32 a51, v137
    v_cvt_pk_bf16_f32 v140, v140, v141
    v_cvt_pk_bf16_f32 v141, v142, v143
    v_accvgpr_write_b32 a130, v140
    v_accvgpr_write_b32 a131, v141
    v_mfma_f32_16x16x32_bf16 v[128:131], v[44:47], v[220:223], v[128:131]
    v_mfma_f32_16x16x32_bf16 v[132:135], v[44:47], v[224:227], v[132:135]
    v_mfma_f32_16x16x32_bf16 v[128:131], v[48:51], v[228:231], v[128:131]
    v_mfma_f32_16x16x32_bf16 v[132:135], v[48:51], v[232:235], v[132:135]
    v_mfma_f32_16x16x32_bf16 v[128:131], v[52:55], v[236:239], v[128:131]
    v_mfma_f32_16x16x32_bf16 v[132:135], v[52:55], v[240:243], v[132:135]
    s_waitcnt vmcnt(24)
    ds_read_b128 v[32:35], v151 offset:24576
    ds_read_b128 v[36:39], v152 offset:24576
    ds_read_b128 v[40:43], v151 offset:25600
    ds_read_b128 v[44:47], v152 offset:25600
    ds_read_b128 v[48:51], v151 offset:26624
    ds_read_b128 v[52:55], v152 offset:26624
    s_waitcnt lgkmcnt(6)
    v_mfma_f32_16x16x32_bf16 v[136:139], v[56:59], v[196:199], 0
    v_mfma_f32_16x16x32_bf16 v[140:143], v[56:59], v[200:203], 0
    s_add_u32 m0, s90, 18432
    s_add_u32 s50, s81, 6340608
    buffer_load_dwordx4 v150, s[8:11], s50 offen lds
    s_add_u32 m0, s90, 19456
    s_add_u32 s50, s81, 6340736
    buffer_load_dwordx4 v150, s[8:11], s50 offen lds
    s_add_u32 m0, s90, 20480
    s_add_u32 s50, s81, 6340864
    buffer_load_dwordx4 v150, s[8:11], s50 offen lds
    s_add_u32 m0, s90, 21504
    s_add_u32 s50, s81, 6537216
    buffer_load_dwordx4 v150, s[8:11], s50 offen lds
    s_add_u32 m0, s90, 22528
    s_add_u32 s50, s81, 6537344
    buffer_load_dwordx4 v150, s[8:11], s50 offen lds
    s_add_u32 m0, s90, 23552
    s_add_u32 s50, s81, 6537472
    buffer_load_dwordx4 v150, s[8:11], s50 offen lds
    v_mfma_f32_16x16x32_bf16 v[136:139], v[60:63], v[204:207], v[136:139]
    v_mfma_f32_16x16x32_bf16 v[140:143], v[60:63], v[208:211], v[140:143]
    v_mfma_f32_16x16x32_bf16 v[136:139], v[64:67], v[212:215], v[136:139]
    v_mfma_f32_16x16x32_bf16 v[140:143], v[64:67], v[216:219], v[140:143]
    v_cvt_pk_bf16_f32 v128, v128, v129
    v_cvt_pk_bf16_f32 v129, v130, v131
    v_accvgpr_write_b32 a52, v128
    v_accvgpr_write_b32 a53, v129
    v_cvt_pk_bf16_f32 v132, v132, v133
    v_cvt_pk_bf16_f32 v133, v134, v135
    v_accvgpr_write_b32 a132, v132
    v_accvgpr_write_b32 a133, v133
    v_mfma_f32_16x16x32_bf16 v[136:139], v[68:71], v[220:223], v[136:139]
    v_mfma_f32_16x16x32_bf16 v[140:143], v[68:71], v[224:227], v[140:143]
    v_mfma_f32_16x16x32_bf16 v[136:139], v[72:75], v[228:231], v[136:139]
    v_mfma_f32_16x16x32_bf16 v[140:143], v[72:75], v[232:235], v[140:143]
    v_mfma_f32_16x16x32_bf16 v[136:139], v[76:79], v[236:239], v[136:139]
    v_mfma_f32_16x16x32_bf16 v[140:143], v[76:79], v[240:243], v[140:143]
    s_waitcnt vmcnt(24)
    ds_read_b128 v[56:59], v151 offset:30720
    ds_read_b128 v[60:63], v152 offset:30720
    ds_read_b128 v[64:67], v151 offset:31744
    ds_read_b128 v[68:71], v152 offset:31744
    ds_read_b128 v[72:75], v151 offset:32768
    ds_read_b128 v[76:79], v152 offset:32768
    s_waitcnt lgkmcnt(6)
    v_mfma_f32_16x16x32_bf16 v[128:131], v[32:35], v[196:199], 0
    v_mfma_f32_16x16x32_bf16 v[132:135], v[32:35], v[200:203], 0
    s_add_u32 m0, s90, 24576
    s_add_u32 s50, s81, 6684672
    buffer_load_dwordx4 v150, s[8:11], s50 offen lds
    s_add_u32 m0, s90, 25600
    s_add_u32 s50, s81, 6684800
    buffer_load_dwordx4 v150, s[8:11], s50 offen lds
    s_add_u32 m0, s90, 26624
    s_add_u32 s50, s81, 6684928
    buffer_load_dwordx4 v150, s[8:11], s50 offen lds
    s_add_u32 m0, s90, 27648
    s_add_u32 s50, s81, 6881280
    buffer_load_dwordx4 v150, s[8:11], s50 offen lds
    s_add_u32 m0, s90, 28672
    s_add_u32 s50, s81, 6881408
    buffer_load_dwordx4 v150, s[8:11], s50 offen lds
    s_add_u32 m0, s90, 29696
    s_add_u32 s50, s81, 6881536
    buffer_load_dwordx4 v150, s[8:11], s50 offen lds
    v_mfma_f32_16x16x32_bf16 v[128:131], v[36:39], v[204:207], v[128:131]
    v_mfma_f32_16x16x32_bf16 v[132:135], v[36:39], v[208:211], v[132:135]
    v_mfma_f32_16x16x32_bf16 v[128:131], v[40:43], v[212:215], v[128:131]
    v_mfma_f32_16x16x32_bf16 v[132:135], v[40:43], v[216:219], v[132:135]
    v_cvt_pk_bf16_f32 v136, v136, v137
    v_cvt_pk_bf16_f32 v137, v138, v139
    v_accvgpr_write_b32 a54, v136
    v_accvgpr_write_b32 a55, v137
    v_cvt_pk_bf16_f32 v140, v140, v141
    v_cvt_pk_bf16_f32 v141, v142, v143
    v_accvgpr_write_b32 a134, v140
    v_accvgpr_write_b32 a135, v141
    v_mfma_f32_16x16x32_bf16 v[128:131], v[44:47], v[220:223], v[128:131]
    v_mfma_f32_16x16x32_bf16 v[132:135], v[44:47], v[224:227], v[132:135]
    v_mfma_f32_16x16x32_bf16 v[128:131], v[48:51], v[228:231], v[128:131]
    v_mfma_f32_16x16x32_bf16 v[132:135], v[48:51], v[232:235], v[132:135]
    v_mfma_f32_16x16x32_bf16 v[128:131], v[52:55], v[236:239], v[128:131]
    v_mfma_f32_16x16x32_bf16 v[132:135], v[52:55], v[240:243], v[132:135]
    s_waitcnt vmcnt(24)
    ds_read_b128 v[32:35], v151 offset:0
    ds_read_b128 v[36:39], v152 offset:0
    ds_read_b128 v[40:43], v151 offset:1024
    ds_read_b128 v[44:47], v152 offset:1024
    ds_read_b128 v[48:51], v151 offset:2048
    ds_read_b128 v[52:55], v152 offset:2048
    s_waitcnt lgkmcnt(6)
    v_mfma_f32_16x16x32_bf16 v[136:139], v[56:59], v[196:199], 0
    v_mfma_f32_16x16x32_bf16 v[140:143], v[56:59], v[200:203], 0
    s_add_u32 m0, s90, 30720
    s_add_u32 s50, s81, 6733824
    buffer_load_dwordx4 v150, s[8:11], s50 offen lds
    s_add_u32 m0, s90, 31744
    s_add_u32 s50, s81, 6733952
    buffer_load_dwordx4 v150, s[8:11], s50 offen lds
    s_add_u32 m0, s90, 32768
    s_add_u32 s50, s81, 6734080
    buffer_load_dwordx4 v150, s[8:11], s50 offen lds
    s_add_u32 m0, s90, 33792
    s_add_u32 s50, s81, 6930432
    buffer_load_dwordx4 v150, s[8:11], s50 offen lds
    s_add_u32 m0, s90, 34816
    s_add_u32 s50, s81, 6930560
    buffer_load_dwordx4 v150, s[8:11], s50 offen lds
    s_add_u32 m0, s90, 35840
    s_add_u32 s50, s81, 6930688
    buffer_load_dwordx4 v150, s[8:11], s50 offen lds
    v_mfma_f32_16x16x32_bf16 v[136:139], v[60:63], v[204:207], v[136:139]
    v_mfma_f32_16x16x32_bf16 v[140:143], v[60:63], v[208:211], v[140:143]
    v_mfma_f32_16x16x32_bf16 v[136:139], v[64:67], v[212:215], v[136:139]
    v_mfma_f32_16x16x32_bf16 v[140:143], v[64:67], v[216:219], v[140:143]
    v_cvt_pk_bf16_f32 v128, v128, v129
    v_cvt_pk_bf16_f32 v129, v130, v131
    v_accvgpr_write_b32 a56, v128
    v_accvgpr_write_b32 a57, v129
    v_cvt_pk_bf16_f32 v132, v132, v133
    v_cvt_pk_bf16_f32 v133, v134, v135
    v_accvgpr_write_b32 a136, v132
    v_accvgpr_write_b32 a137, v133
    v_mfma_f32_16x16x32_bf16 v[136:139], v[68:71], v[220:223], v[136:139]
    v_mfma_f32_16x16x32_bf16 v[140:143], v[68:71], v[224:227], v[140:143]
    v_mfma_f32_16x16x32_bf16 v[136:139], v[72:75], v[228:231], v[136:139]
    v_mfma_f32_16x16x32_bf16 v[140:143], v[72:75], v[232:235], v[140:143]
    v_mfma_f32_16x16x32_bf16 v[136:139], v[76:79], v[236:239], v[136:139]
    v_mfma_f32_16x16x32_bf16 v[140:143], v[76:79], v[240:243], v[140:143]
    s_waitcnt vmcnt(24)
    ds_read_b128 v[56:59], v151 offset:6144
    ds_read_b128 v[60:63], v152 offset:6144
    ds_read_b128 v[64:67], v151 offset:7168
    ds_read_b128 v[68:71], v152 offset:7168
    ds_read_b128 v[72:75], v151 offset:8192
    ds_read_b128 v[76:79], v152 offset:8192
    s_waitcnt lgkmcnt(6)
    v_mfma_f32_16x16x32_bf16 v[128:131], v[32:35], v[196:199], 0
    v_mfma_f32_16x16x32_bf16 v[132:135], v[32:35], v[200:203], 0
    s_add_u32 m0, s90, 0
    s_add_u32 s50, s81, 7077888
    buffer_load_dwordx4 v150, s[8:11], s50 offen lds
    s_add_u32 m0, s90, 1024
    s_add_u32 s50, s81, 7078016
    buffer_load_dwordx4 v150, s[8:11], s50 offen lds
    s_add_u32 m0, s90, 2048
    s_add_u32 s50, s81, 7078144
    buffer_load_dwordx4 v150, s[8:11], s50 offen lds
    s_add_u32 m0, s90, 3072
    s_add_u32 s50, s81, 7274496
    buffer_load_dwordx4 v150, s[8:11], s50 offen lds
    s_add_u32 m0, s90, 4096
    s_add_u32 s50, s81, 7274624
    buffer_load_dwordx4 v150, s[8:11], s50 offen lds
    s_add_u32 m0, s90, 5120
    s_add_u32 s50, s81, 7274752
    buffer_load_dwordx4 v150, s[8:11], s50 offen lds
    v_mfma_f32_16x16x32_bf16 v[128:131], v[36:39], v[204:207], v[128:131]
    v_mfma_f32_16x16x32_bf16 v[132:135], v[36:39], v[208:211], v[132:135]
    v_mfma_f32_16x16x32_bf16 v[128:131], v[40:43], v[212:215], v[128:131]
    v_mfma_f32_16x16x32_bf16 v[132:135], v[40:43], v[216:219], v[132:135]
    v_cvt_pk_bf16_f32 v136, v136, v137
    v_cvt_pk_bf16_f32 v137, v138, v139
    v_accvgpr_write_b32 a58, v136
    v_accvgpr_write_b32 a59, v137
    v_cvt_pk_bf16_f32 v140, v140, v141
    v_cvt_pk_bf16_f32 v141, v142, v143
    v_accvgpr_write_b32 a138, v140
    v_accvgpr_write_b32 a139, v141
    v_mfma_f32_16x16x32_bf16 v[128:131], v[44:47], v[220:223], v[128:131]
    v_mfma_f32_16x16x32_bf16 v[132:135], v[44:47], v[224:227], v[132:135]
    v_mfma_f32_16x16x32_bf16 v[128:131], v[48:51], v[228:231], v[128:131]
    v_mfma_f32_16x16x32_bf16 v[132:135], v[48:51], v[232:235], v[132:135]
    v_mfma_f32_16x16x32_bf16 v[128:131], v[52:55], v[236:239], v[128:131]
    v_mfma_f32_16x16x32_bf16 v[132:135], v[52:55], v[240:243], v[132:135]
    s_waitcnt vmcnt(24)
    ds_read_b128 v[32:35], v151 offset:12288
    ds_read_b128 v[36:39], v152 offset:12288
    ds_read_b128 v[40:43], v151 offset:13312
    ds_read_b128 v[44:47], v152 offset:13312
    ds_read_b128 v[48:51], v151 offset:14336
    ds_read_b128 v[52:55], v152 offset:14336
    s_waitcnt lgkmcnt(6)
    v_mfma_f32_16x16x32_bf16 v[136:139], v[56:59], v[196:199], 0
    v_mfma_f32_16x16x32_bf16 v[140:143], v[56:59], v[200:203], 0
    s_add_u32 m0, s90, 6144
    s_add_u32 s50, s81, 7127040
    buffer_load_dwordx4 v150, s[8:11], s50 offen lds
    s_add_u32 m0, s90, 7168
    s_add_u32 s50, s81, 7127168
    buffer_load_dwordx4 v150, s[8:11], s50 offen lds
    s_add_u32 m0, s90, 8192
    s_add_u32 s50, s81, 7127296
    buffer_load_dwordx4 v150, s[8:11], s50 offen lds
    s_add_u32 m0, s90, 9216
    s_add_u32 s50, s81, 7323648
    buffer_load_dwordx4 v150, s[8:11], s50 offen lds
    s_add_u32 m0, s90, 10240
    s_add_u32 s50, s81, 7323776
    buffer_load_dwordx4 v150, s[8:11], s50 offen lds
    s_add_u32 m0, s90, 11264
    s_add_u32 s50, s81, 7323904
    buffer_load_dwordx4 v150, s[8:11], s50 offen lds
    v_mfma_f32_16x16x32_bf16 v[136:139], v[60:63], v[204:207], v[136:139]
    v_mfma_f32_16x16x32_bf16 v[140:143], v[60:63], v[208:211], v[140:143]
    v_mfma_f32_16x16x32_bf16 v[136:139], v[64:67], v[212:215], v[136:139]
    v_mfma_f32_16x16x32_bf16 v[140:143], v[64:67], v[216:219], v[140:143]
    v_cvt_pk_bf16_f32 v128, v128, v129
    v_cvt_pk_bf16_f32 v129, v130, v131
    v_accvgpr_write_b32 a60, v128
    v_accvgpr_write_b32 a61, v129
    v_cvt_pk_bf16_f32 v132, v132, v133
    v_cvt_pk_bf16_f32 v133, v134, v135
    v_accvgpr_write_b32 a140, v132
    v_accvgpr_write_b32 a141, v133
    v_mfma_f32_16x16x32_bf16 v[136:139], v[68:71], v[220:223], v[136:139]
    v_mfma_f32_16x16x32_bf16 v[140:143], v[68:71], v[224:227], v[140:143]
    v_mfma_f32_16x16x32_bf16 v[136:139], v[72:75], v[228:231], v[136:139]
    v_mfma_f32_16x16x32_bf16 v[140:143], v[72:75], v[232:235], v[140:143]
    v_mfma_f32_16x16x32_bf16 v[136:139], v[76:79], v[236:239], v[136:139]
    v_mfma_f32_16x16x32_bf16 v[140:143], v[76:79], v[240:243], v[140:143]
    s_waitcnt vmcnt(24)
    ds_read_b128 v[56:59], v151 offset:18432
    ds_read_b128 v[60:63], v152 offset:18432
    ds_read_b128 v[64:67], v151 offset:19456
    ds_read_b128 v[68:71], v152 offset:19456
    ds_read_b128 v[72:75], v151 offset:20480
    ds_read_b128 v[76:79], v152 offset:20480
    s_waitcnt lgkmcnt(6)
    v_mfma_f32_16x16x32_bf16 v[128:131], v[32:35], v[196:199], 0
    v_mfma_f32_16x16x32_bf16 v[132:135], v[32:35], v[200:203], 0
    s_add_u32 m0, s90, 12288
    s_add_u32 s50, s81, 7471104
    buffer_load_dwordx4 v150, s[8:11], s50 offen lds
    s_add_u32 m0, s90, 13312
    s_add_u32 s50, s81, 7471232
    buffer_load_dwordx4 v150, s[8:11], s50 offen lds
    s_add_u32 m0, s90, 14336
    s_add_u32 s50, s81, 7471360
    buffer_load_dwordx4 v150, s[8:11], s50 offen lds
    s_add_u32 m0, s90, 15360
    s_add_u32 s50, s81, 7667712
    buffer_load_dwordx4 v150, s[8:11], s50 offen lds
    s_add_u32 m0, s90, 16384
    s_add_u32 s50, s81, 7667840
    buffer_load_dwordx4 v150, s[8:11], s50 offen lds
    s_add_u32 m0, s90, 17408
    s_add_u32 s50, s81, 7667968
    buffer_load_dwordx4 v150, s[8:11], s50 offen lds
    v_mfma_f32_16x16x32_bf16 v[128:131], v[36:39], v[204:207], v[128:131]
    v_mfma_f32_16x16x32_bf16 v[132:135], v[36:39], v[208:211], v[132:135]
    v_mfma_f32_16x16x32_bf16 v[128:131], v[40:43], v[212:215], v[128:131]
    v_mfma_f32_16x16x32_bf16 v[132:135], v[40:43], v[216:219], v[132:135]
    v_cvt_pk_bf16_f32 v136, v136, v137
    v_cvt_pk_bf16_f32 v137, v138, v139
    v_accvgpr_write_b32 a62, v136
    v_accvgpr_write_b32 a63, v137
    v_cvt_pk_bf16_f32 v140, v140, v141
    v_cvt_pk_bf16_f32 v141, v142, v143
    v_accvgpr_write_b32 a142, v140
    v_accvgpr_write_b32 a143, v141
    v_mfma_f32_16x16x32_bf16 v[128:131], v[44:47], v[220:223], v[128:131]
    v_mfma_f32_16x16x32_bf16 v[132:135], v[44:47], v[224:227], v[132:135]
    v_mfma_f32_16x16x32_bf16 v[128:131], v[48:51], v[228:231], v[128:131]
    v_mfma_f32_16x16x32_bf16 v[132:135], v[48:51], v[232:235], v[132:135]
    v_mfma_f32_16x16x32_bf16 v[128:131], v[52:55], v[236:239], v[128:131]
    v_mfma_f32_16x16x32_bf16 v[132:135], v[52:55], v[240:243], v[132:135]
    s_waitcnt vmcnt(24)
    ds_read_b128 v[32:35], v151 offset:24576
    ds_read_b128 v[36:39], v152 offset:24576
    ds_read_b128 v[40:43], v151 offset:25600
    ds_read_b128 v[44:47], v152 offset:25600
    ds_read_b128 v[48:51], v151 offset:26624
    ds_read_b128 v[52:55], v152 offset:26624
    s_waitcnt lgkmcnt(6)
    v_mfma_f32_16x16x32_bf16 v[136:139], v[56:59], v[196:199], 0
    v_mfma_f32_16x16x32_bf16 v[140:143], v[56:59], v[200:203], 0
    s_add_u32 m0, s90, 18432
    s_add_u32 s50, s81, 7520256
    buffer_load_dwordx4 v150, s[8:11], s50 offen lds
    s_add_u32 m0, s90, 19456
    s_add_u32 s50, s81, 7520384
    buffer_load_dwordx4 v150, s[8:11], s50 offen lds
    s_add_u32 m0, s90, 20480
    s_add_u32 s50, s81, 7520512
    buffer_load_dwordx4 v150, s[8:11], s50 offen lds
    s_add_u32 m0, s90, 21504
    s_add_u32 s50, s81, 7716864
    buffer_load_dwordx4 v150, s[8:11], s50 offen lds
    s_add_u32 m0, s90, 22528
    s_add_u32 s50, s81, 7716992
    buffer_load_dwordx4 v150, s[8:11], s50 offen lds
    s_add_u32 m0, s90, 23552
    s_add_u32 s50, s81, 7717120
    buffer_load_dwordx4 v150, s[8:11], s50 offen lds
    v_mfma_f32_16x16x32_bf16 v[136:139], v[60:63], v[204:207], v[136:139]
    v_mfma_f32_16x16x32_bf16 v[140:143], v[60:63], v[208:211], v[140:143]
    v_mfma_f32_16x16x32_bf16 v[136:139], v[64:67], v[212:215], v[136:139]
    v_mfma_f32_16x16x32_bf16 v[140:143], v[64:67], v[216:219], v[140:143]
    v_cvt_pk_bf16_f32 v128, v128, v129
    v_cvt_pk_bf16_f32 v129, v130, v131
    v_accvgpr_write_b32 a64, v128
    v_accvgpr_write_b32 a65, v129
    v_cvt_pk_bf16_f32 v132, v132, v133
    v_cvt_pk_bf16_f32 v133, v134, v135
    v_accvgpr_write_b32 a144, v132
    v_accvgpr_write_b32 a145, v133
    v_mfma_f32_16x16x32_bf16 v[136:139], v[68:71], v[220:223], v[136:139]
    v_mfma_f32_16x16x32_bf16 v[140:143], v[68:71], v[224:227], v[140:143]
    v_mfma_f32_16x16x32_bf16 v[136:139], v[72:75], v[228:231], v[136:139]
    v_mfma_f32_16x16x32_bf16 v[140:143], v[72:75], v[232:235], v[140:143]
    v_mfma_f32_16x16x32_bf16 v[136:139], v[76:79], v[236:239], v[136:139]
    v_mfma_f32_16x16x32_bf16 v[140:143], v[76:79], v[240:243], v[140:143]
    s_waitcnt vmcnt(24)
    ds_read_b128 v[56:59], v151 offset:30720
    ds_read_b128 v[60:63], v152 offset:30720
    ds_read_b128 v[64:67], v151 offset:31744
    ds_read_b128 v[68:71], v152 offset:31744
    ds_read_b128 v[72:75], v151 offset:32768
    ds_read_b128 v[76:79], v152 offset:32768
    s_waitcnt lgkmcnt(6)
    v_mfma_f32_16x16x32_bf16 v[128:131], v[32:35], v[196:199], 0
    v_mfma_f32_16x16x32_bf16 v[132:135], v[32:35], v[200:203], 0
    s_add_u32 m0, s90, 24576
    s_add_u32 s50, s82, 0
    buffer_load_dwordx4 v149, s[16:19], s50 offen lds
    s_add_u32 m0, s90, 25600
    s_add_u32 s50, s82, 20480
    buffer_load_dwordx4 v149, s[16:19], s50 offen lds
    s_add_u32 m0, s90, 26624
    s_add_u32 s50, s82, 40960
    buffer_load_dwordx4 v149, s[16:19], s50 offen lds
    s_add_u32 m0, s90, 27648
    s_add_u32 s50, s82, 61440
    buffer_load_dwordx4 v149, s[16:19], s50 offen lds
    s_add_u32 m0, s90, 28672
    s_add_u32 s50, s82, 81920
    buffer_load_dwordx4 v149, s[16:19], s50 offen lds
    s_add_u32 m0, s90, 29696
    s_add_u32 s50, s82, 102400
    buffer_load_dwordx4 v149, s[16:19], s50 offen lds
    v_mfma_f32_16x16x32_bf16 v[128:131], v[36:39], v[204:207], v[128:131]
    v_mfma_f32_16x16x32_bf16 v[132:135], v[36:39], v[208:211], v[132:135]
    v_mfma_f32_16x16x32_bf16 v[128:131], v[40:43], v[212:215], v[128:131]
    v_mfma_f32_16x16x32_bf16 v[132:135], v[40:43], v[216:219], v[132:135]
    v_cvt_pk_bf16_f32 v136, v136, v137
    v_cvt_pk_bf16_f32 v137, v138, v139
    v_accvgpr_write_b32 a66, v136
    v_accvgpr_write_b32 a67, v137
    v_cvt_pk_bf16_f32 v140, v140, v141
    v_cvt_pk_bf16_f32 v141, v142, v143
    v_accvgpr_write_b32 a146, v140
    v_accvgpr_write_b32 a147, v141
    v_mfma_f32_16x16x32_bf16 v[128:131], v[44:47], v[220:223], v[128:131]
    v_mfma_f32_16x16x32_bf16 v[132:135], v[44:47], v[224:227], v[132:135]
    v_mfma_f32_16x16x32_bf16 v[128:131], v[48:51], v[228:231], v[128:131]
    v_mfma_f32_16x16x32_bf16 v[132:135], v[48:51], v[232:235], v[132:135]
    v_mfma_f32_16x16x32_bf16 v[128:131], v[52:55], v[236:239], v[128:131]
    v_mfma_f32_16x16x32_bf16 v[132:135], v[52:55], v[240:243], v[132:135]
    s_waitcnt vmcnt(24)
    ds_read_b128 v[32:35], v151 offset:0
    ds_read_b128 v[36:39], v152 offset:0
    ds_read_b128 v[40:43], v151 offset:1024
    ds_read_b128 v[44:47], v152 offset:1024
    ds_read_b128 v[48:51], v151 offset:2048
    ds_read_b128 v[52:55], v152 offset:2048
    s_waitcnt lgkmcnt(6)
    v_mfma_f32_16x16x32_bf16 v[136:139], v[56:59], v[196:199], 0
    v_mfma_f32_16x16x32_bf16 v[140:143], v[56:59], v[200:203], 0
    s_add_u32 m0, s90, 30720
    s_add_u32 s50, s82, 122880
    buffer_load_dwordx4 v149, s[16:19], s50 offen lds
    s_add_u32 m0, s90, 31744
    s_add_u32 s50, s82, 143360
    buffer_load_dwordx4 v149, s[16:19], s50 offen lds
    s_add_u32 m0, s90, 32768
    s_add_u32 s50, s82, 163840
    buffer_load_dwordx4 v149, s[16:19], s50 offen lds
    s_add_u32 m0, s90, 33792
    s_add_u32 s50, s82, 184320
    buffer_load_dwordx4 v149, s[16:19], s50 offen lds
    s_add_u32 m0, s90, 34816
    s_add_u32 s50, s82, 204800
    buffer_load_dwordx4 v149, s[16:19], s50 offen lds
    s_add_u32 m0, s90, 35840
    s_add_u32 s50, s82, 225280
    buffer_load_dwordx4 v149, s[16:19], s50 offen lds
    v_mfma_f32_16x16x32_bf16 v[136:139], v[60:63], v[204:207], v[136:139]
    v_mfma_f32_16x16x32_bf16 v[140:143], v[60:63], v[208:211], v[140:143]
    v_mfma_f32_16x16x32_bf16 v[136:139], v[64:67], v[212:215], v[136:139]
    v_mfma_f32_16x16x32_bf16 v[140:143], v[64:67], v[216:219], v[140:143]
    v_cvt_pk_bf16_f32 v128, v128, v129
    v_cvt_pk_bf16_f32 v129, v130, v131
    v_accvgpr_write_b32 a68, v128
    v_accvgpr_write_b32 a69, v129
    v_cvt_pk_bf16_f32 v132, v132, v133
    v_cvt_pk_bf16_f32 v133, v134, v135
    v_accvgpr_write_b32 a148, v132
    v_accvgpr_write_b32 a149, v133
    v_mfma_f32_16x16x32_bf16 v[136:139], v[68:71], v[220:223], v[136:139]
    v_mfma_f32_16x16x32_bf16 v[140:143], v[68:71], v[224:227], v[140:143]
    v_mfma_f32_16x16x32_bf16 v[136:139], v[72:75], v[228:231], v[136:139]
    v_mfma_f32_16x16x32_bf16 v[140:143], v[72:75], v[232:235], v[140:143]
    v_mfma_f32_16x16x32_bf16 v[136:139], v[76:79], v[236:239], v[136:139]
    v_mfma_f32_16x16x32_bf16 v[140:143], v[76:79], v[240:243], v[140:143]
    s_waitcnt vmcnt(24)
    ds_read_b128 v[56:59], v151 offset:6144
    ds_read_b128 v[60:63], v152 offset:6144
    ds_read_b128 v[64:67], v151 offset:7168
    ds_read_b128 v[68:71], v152 offset:7168
    ds_read_b128 v[72:75], v151 offset:8192
    ds_read_b128 v[76:79], v152 offset:8192
    s_waitcnt lgkmcnt(6)
    v_mfma_f32_16x16x32_bf16 v[128:131], v[32:35], v[196:199], 0
    v_mfma_f32_16x16x32_bf16 v[132:135], v[32:35], v[200:203], 0
    s_add_u32 m0, s90, 0
    s_add_u32 s50, s82, 245760
    buffer_load_dwordx4 v149, s[16:19], s50 offen lds
    s_add_u32 m0, s90, 1024
    s_add_u32 s50, s82, 266240
    buffer_load_dwordx4 v149, s[16:19], s50 offen lds
    s_add_u32 m0, s90, 2048
    s_add_u32 s50, s82, 286720
    buffer_load_dwordx4 v149, s[16:19], s50 offen lds
    s_add_u32 m0, s90, 3072
    s_add_u32 s50, s82, 307200
    buffer_load_dwordx4 v149, s[16:19], s50 offen lds
    s_add_u32 m0, s90, 4096
    s_add_u32 s50, s82, 327680
    buffer_load_dwordx4 v149, s[16:19], s50 offen lds
    s_add_u32 m0, s90, 5120
    s_add_u32 s50, s82, 348160
    buffer_load_dwordx4 v149, s[16:19], s50 offen lds
    v_mfma_f32_16x16x32_bf16 v[128:131], v[36:39], v[204:207], v[128:131]
    v_mfma_f32_16x16x32_bf16 v[132:135], v[36:39], v[208:211], v[132:135]
    v_mfma_f32_16x16x32_bf16 v[128:131], v[40:43], v[212:215], v[128:131]
    v_mfma_f32_16x16x32_bf16 v[132:135], v[40:43], v[216:219], v[132:135]
    v_cvt_pk_bf16_f32 v136, v136, v137
    v_cvt_pk_bf16_f32 v137, v138, v139
    v_accvgpr_write_b32 a70, v136
    v_accvgpr_write_b32 a71, v137
    v_cvt_pk_bf16_f32 v140, v140, v141
    v_cvt_pk_bf16_f32 v141, v142, v143
    v_accvgpr_write_b32 a150, v140
    v_accvgpr_write_b32 a151, v141
    v_mfma_f32_16x16x32_bf16 v[128:131], v[44:47], v[220:223], v[128:131]
    v_mfma_f32_16x16x32_bf16 v[132:135], v[44:47], v[224:227], v[132:135]
    v_mfma_f32_16x16x32_bf16 v[128:131], v[48:51], v[228:231], v[128:131]
    v_mfma_f32_16x16x32_bf16 v[132:135], v[48:51], v[232:235], v[132:135]
    v_mfma_f32_16x16x32_bf16 v[128:131], v[52:55], v[236:239], v[128:131]
    v_mfma_f32_16x16x32_bf16 v[132:135], v[52:55], v[240:243], v[132:135]
    s_waitcnt vmcnt(24)
    ds_read_b128 v[32:35], v151 offset:12288
    ds_read_b128 v[36:39], v152 offset:12288
    ds_read_b128 v[40:43], v151 offset:13312
    ds_read_b128 v[44:47], v152 offset:13312
    ds_read_b128 v[48:51], v151 offset:14336
    ds_read_b128 v[52:55], v152 offset:14336
    s_waitcnt lgkmcnt(6)
    v_mfma_f32_16x16x32_bf16 v[136:139], v[56:59], v[196:199], 0
    v_mfma_f32_16x16x32_bf16 v[140:143], v[56:59], v[200:203], 0
    s_add_u32 m0, s90, 6144
    s_add_u32 s50, s82, 368640
    buffer_load_dwordx4 v149, s[16:19], s50 offen lds
    s_add_u32 m0, s90, 7168
    s_add_u32 s50, s82, 389120
    buffer_load_dwordx4 v149, s[16:19], s50 offen lds
    s_add_u32 m0, s90, 8192
    s_add_u32 s50, s82, 409600
    buffer_load_dwordx4 v149, s[16:19], s50 offen lds
    s_add_u32 m0, s90, 9216
    s_add_u32 s50, s82, 430080
    buffer_load_dwordx4 v149, s[16:19], s50 offen lds
    s_add_u32 m0, s90, 10240
    s_add_u32 s50, s82, 450560
    buffer_load_dwordx4 v149, s[16:19], s50 offen lds
    s_add_u32 m0, s90, 11264
    s_add_u32 s50, s82, 471040
    buffer_load_dwordx4 v149, s[16:19], s50 offen lds
    v_mfma_f32_16x16x32_bf16 v[136:139], v[60:63], v[204:207], v[136:139]
    v_mfma_f32_16x16x32_bf16 v[140:143], v[60:63], v[208:211], v[140:143]
    v_mfma_f32_16x16x32_bf16 v[136:139], v[64:67], v[212:215], v[136:139]
    v_mfma_f32_16x16x32_bf16 v[140:143], v[64:67], v[216:219], v[140:143]
    v_cvt_pk_bf16_f32 v128, v128, v129
    v_cvt_pk_bf16_f32 v129, v130, v131
    v_accvgpr_write_b32 a72, v128
    v_accvgpr_write_b32 a73, v129
    v_cvt_pk_bf16_f32 v132, v132, v133
    v_cvt_pk_bf16_f32 v133, v134, v135
    v_accvgpr_write_b32 a152, v132
    v_accvgpr_write_b32 a153, v133
    v_mfma_f32_16x16x32_bf16 v[136:139], v[68:71], v[220:223], v[136:139]
    v_mfma_f32_16x16x32_bf16 v[140:143], v[68:71], v[224:227], v[140:143]
    v_mfma_f32_16x16x32_bf16 v[136:139], v[72:75], v[228:231], v[136:139]
    v_mfma_f32_16x16x32_bf16 v[140:143], v[72:75], v[232:235], v[140:143]
    v_mfma_f32_16x16x32_bf16 v[136:139], v[76:79], v[236:239], v[136:139]
    v_mfma_f32_16x16x32_bf16 v[140:143], v[76:79], v[240:243], v[140:143]
    s_waitcnt vmcnt(24)
    ds_read_b128 v[56:59], v151 offset:18432
    ds_read_b128 v[60:63], v152 offset:18432
    ds_read_b128 v[64:67], v151 offset:19456
    ds_read_b128 v[68:71], v152 offset:19456
    ds_read_b128 v[72:75], v151 offset:20480
    ds_read_b128 v[76:79], v152 offset:20480
    s_waitcnt lgkmcnt(6)
    v_mfma_f32_16x16x32_bf16 v[128:131], v[32:35], v[196:199], 0
    v_mfma_f32_16x16x32_bf16 v[132:135], v[32:35], v[200:203], 0
    v_mfma_f32_16x16x32_bf16 v[128:131], v[36:39], v[204:207], v[128:131]
    v_mfma_f32_16x16x32_bf16 v[132:135], v[36:39], v[208:211], v[132:135]
    v_mfma_f32_16x16x32_bf16 v[128:131], v[40:43], v[212:215], v[128:131]
    v_mfma_f32_16x16x32_bf16 v[132:135], v[40:43], v[216:219], v[132:135]
    v_cvt_pk_bf16_f32 v136, v136, v137
    v_cvt_pk_bf16_f32 v137, v138, v139
    v_accvgpr_write_b32 a74, v136
    v_accvgpr_write_b32 a75, v137
    v_cvt_pk_bf16_f32 v140, v140, v141
    v_cvt_pk_bf16_f32 v141, v142, v143
    v_accvgpr_write_b32 a154, v140
    v_accvgpr_write_b32 a155, v141
    v_mfma_f32_16x16x32_bf16 v[128:131], v[44:47], v[220:223], v[128:131]
    v_mfma_f32_16x16x32_bf16 v[132:135], v[44:47], v[224:227], v[132:135]
    v_mfma_f32_16x16x32_bf16 v[128:131], v[48:51], v[228:231], v[128:131]
    v_mfma_f32_16x16x32_bf16 v[132:135], v[48:51], v[232:235], v[132:135]
    v_mfma_f32_16x16x32_bf16 v[128:131], v[52:55], v[236:239], v[128:131]
    v_mfma_f32_16x16x32_bf16 v[132:135], v[52:55], v[240:243], v[132:135]
    s_waitcnt lgkmcnt(0)
    v_mfma_f32_16x16x32_bf16 v[136:139], v[56:59], v[196:199], 0
    v_mfma_f32_16x16x32_bf16 v[140:143], v[56:59], v[200:203], 0
    v_mfma_f32_16x16x32_bf16 v[136:139], v[60:63], v[204:207], v[136:139]
    v_mfma_f32_16x16x32_bf16 v[140:143], v[60:63], v[208:211], v[140:143]
    v_mfma_f32_16x16x32_bf16 v[136:139], v[64:67], v[212:215], v[136:139]
    v_mfma_f32_16x16x32_bf16 v[140:143], v[64:67], v[216:219], v[140:143]
    v_cvt_pk_bf16_f32 v128, v128, v129
    v_cvt_pk_bf16_f32 v129, v130, v131
    v_accvgpr_write_b32 a76, v128
    v_accvgpr_write_b32 a77, v129
    v_cvt_pk_bf16_f32 v132, v132, v133
    v_cvt_pk_bf16_f32 v133, v134, v135
    v_accvgpr_write_b32 a156, v132
    v_accvgpr_write_b32 a157, v133
    v_mfma_f32_16x16x32_bf16 v[136:139], v[68:71], v[220:223], v[136:139]
    v_mfma_f32_16x16x32_bf16 v[140:143], v[68:71], v[224:227], v[140:143]
    v_mfma_f32_16x16x32_bf16 v[136:139], v[72:75], v[228:231], v[136:139]
    v_mfma_f32_16x16x32_bf16 v[140:143], v[72:75], v[232:235], v[140:143]
    v_mfma_f32_16x16x32_bf16 v[136:139], v[76:79], v[236:239], v[136:139]
    v_mfma_f32_16x16x32_bf16 v[140:143], v[76:79], v[240:243], v[140:143]
    s_nop 6
    v_cvt_pk_bf16_f32 v136, v136, v137
    v_cvt_pk_bf16_f32 v137, v138, v139
    v_accvgpr_write_b32 a78, v136
    v_accvgpr_write_b32 a79, v137
    v_cvt_pk_bf16_f32 v140, v140, v141
    v_cvt_pk_bf16_f32 v141, v142, v143
    v_accvgpr_write_b32 a158, v140
    v_accvgpr_write_b32 a159, v141
    v_lshlrev_b32 v12, 8, v3
    v_sub_u32 v151, v148, v12
    s_waitcnt vmcnt(0)
    ds_read_b64_tr_b16 a[160:161], v151 offset:24576
    ds_read_b64_tr_b16 a[162:163], v151 offset:25600
    ds_read_b64_tr_b16 a[164:165], v151 offset:24584
    ds_read_b64_tr_b16 a[166:167], v151 offset:25608
    ds_read_b64_tr_b16 a[168:169], v151 offset:26624
    ds_read_b64_tr_b16 a[170:171], v151 offset:27648
    ds_read_b64_tr_b16 a[172:173], v151 offset:26632
    ds_read_b64_tr_b16 a[174:175], v151 offset:27656
    ds_read_b64_tr_b16 a[176:177], v151 offset:28672
    ds_read_b64_tr_b16 a[178:179], v151 offset:29696
    ds_read_b64_tr_b16 a[180:181], v151 offset:28680
    ds_read_b64_tr_b16 a[182:183], v151 offset:29704
    ds_read_b64_tr_b16 a[184:185], v151 offset:30720
    ds_read_b64_tr_b16 a[186:187], v151 offset:31744
    ds_read_b64_tr_b16 a[188:189], v151 offset:30728
    ds_read_b64_tr_b16 a[190:191], v151 offset:31752
    ds_read_b64_tr_b16 a[192:193], v151 offset:32768
    ds_read_b64_tr_b16 a[194:195], v151 offset:33792
    ds_read_b64_tr_b16 a[196:197], v151 offset:32776
    ds_read_b64_tr_b16 a[198:199], v151 offset:33800
    ds_read_b64_tr_b16 a[200:201], v151 offset:34816
    ds_read_b64_tr_b16 a[202:203], v151 offset:35840
    ds_read_b64_tr_b16 a[204:205], v151 offset:34824
    ds_read_b64_tr_b16 a[206:207], v151 offset:35848
    ds_read_b64_tr_b16 a[208:209], v151 offset:0
    ds_read_b64_tr_b16 a[210:211], v151 offset:1024
    ds_read_b64_tr_b16 a[212:213], v151 offset:8
    ds_read_b64_tr_b16 a[214:215], v151 offset:1032
    ds_read_b64_tr_b16 a[216:217], v151 offset:2048
    ds_read_b64_tr_b16 a[218:219], v151 offset:3072
    ds_read_b64_tr_b16 a[220:221], v151 offset:2056
    ds_read_b64_tr_b16 a[222:223], v151 offset:3080
    ds_read_b64_tr_b16 a[224:225], v151 offset:4096
    ds_read_b64_tr_b16 a[226:227], v151 offset:5120
    ds_read_b64_tr_b16 a[228:229], v151 offset:4104
    ds_read_b64_tr_b16 a[230:231], v151 offset:5128
    ds_read_b64_tr_b16 a[232:233], v151 offset:6144
    ds_read_b64_tr_b16 a[234:235], v151 offset:7168
    ds_read_b64_tr_b16 a[236:237], v151 offset:6152
    ds_read_b64_tr_b16 a[238:239], v151 offset:7176
    ds_read_b64_tr_b16 a[240:241], v151 offset:8192
    ds_read_b64_tr_b16 a[242:243], v151 offset:9216
    ds_read_b64_tr_b16 a[244:245], v151 offset:8200
    ds_read_b64_tr_b16 a[246:247], v151 offset:9224
    ds_read_b64_tr_b16 a[248:249], v151 offset:10240
    ds_read_b64_tr_b16 a[250:251], v151 offset:11264
    ds_read_b64_tr_b16 a[252:253], v151 offset:10248
    ds_read_b64_tr_b16 a[254:255], v151 offset:11272
    s_movk_i32 s51, 1280
    v_mul_lo_u32 v149, v2, s51
    v_lshl_add_u32 v149, v3, 4, v149
    v_lshlrev_b32 v11, 4, v3
    s_and_b32 s51, s42, 1
    s_lshl_b32 s51, s51, 3
    s_add_u32 s52, s52, s51
    buffer_load_dwordx2 v[174:175], v11, s[20:23], s52 offen
    v_mov_b32 v170, v149
    s_lshr_b32 s51, s42, 1
    s_mul_i32 s51, s51, 20480
    s_add_u32 s83, s51, s52
    s_mul_i32 s51, s40, 40960
    s_add_u32 s83, s83, s51
    v_add_u32 v150, 81920, v6
    v_add_u32 v151, 81920, v7
    v_add_u32 v152, 81920, v8
    s_lshl_b32 s51, s42, 11
    s_add_u32 s51, s51, 92160
    v_add_u32 v153, s51, v5
    v_bfe_u32 v12, v1, 3, 1
    v_mul_u32_u24 v154, 1152, v12
    v_lshl_add_u32 v154, v3, 8, v154
    v_and_b32 v13, 7, v1
    v_lshl_add_u32 v154, v13, 4, v154
    v_add_u32 v154, 92160, v154
    v_xor_b32 v171, 128, v154
    s_and_b32 s51, s42, 1
    s_lshl_b32 s52, s51, 13
    v_add_u32 v155, s52, v5
    v_lshlrev_b32 v158, 3, v1
    v_add_u32 v158, s52, v158
    v_lshrrev_b32 v14, 5, v1
    v_and_b32 v156, 31, v1
    v_lshlrev_b32 v156, 4, v156
    v_lshl_add_u32 v156, v14, 10, v156
    s_lshl_b32 s52, s51, 9
    v_add_u32 v156, s52, v156
    v_add_u32 v157, 4096, v156
    v_add_u32 v159, 4096, v5
    v_lshlrev_b32 v167, 3, v1
    v_cmp_gt_u32 vcc, 8, v2
    s_nop 1
    v_cndmask_b32 v164, 0, v244, vcc
    v_not_b32 v165, v164
    v_xor_b32 v166, 0xffff0000, v164
    s_lshl_b32 s51, s42, 12
    s_add_u32 s51, s51, 137216
    v_add_u32 v168, s51, v5
    s_lshl_b32 s51, s42, 10
    s_add_u32 s51, s51, 137216
    v_add_u32 v169, s51, v5
    s_mov_b32 s78, 100352
    s_mov_b32 s77, 124928
    s_mov_b32 s79, 112640
    s_mul_i32 s76, s40, 5242880
    s_lshl_b32 s51, s45, 12
    s_add_u32 s76, s76, s51
    s_and_b32 s52, s42, 1
    s_lshl_b32 s52, s52, 11
    s_add_u32 s76, s76, s52
    s_add_u32 s76, s76, 67108864
    s_mul_i32 s82, s40, 81920
    s_add_u32 s82, s82, s51
    s_lshl_b32 s52, s42, 10
    s_add_u32 s82, s82, s52
    s_add_u32 s82, s82, 67108864
    s_mul_i32 s81, s40, 98304
    s_mul_i32 s51, s42, 24576
    s_add_u32 s81, s81, s51
    s_add_u32 s81, s81, 4718592
    s_cmp_lt_u32 s42, 2
    s_cselect_b64 s[2:3], -1, 0
    s_add_u32 s84, s43, 3
    s_and_b32 s84, s84, 3
    s_add_u32 s85, s43, 4
    s_and_b32 s85, s85, 3
    s_add_u32 s86, s43, 5
    s_and_b32 s86, s86, 3
    s_add_u32 s87, s43, 6
    s_and_b32 s87, s87, 3
    s_mul_i32 s67, s84, 122880
    s_add_u32 s67, s67, s61
    s_mul_i32 s68, s84, 327680
    s_add_u32 s68, s68, s62
    s_mul_i32 s69, s86, 327680
    s_add_u32 s69, s69, s62
    s_mul_i32 s70, s84, 327680
    s_add_u32 s70, s70, s63
    s_mul_i32 s71, s85, 81920
    s_add_u32 s71, s71, s60
    s_mul_i32 s73, s87, 81920
    s_add_u32 s73, s73, s65
    s_sub_u32 s51, s43, s40
    s_sub_u32 s51, s51, 2
    s_and_b32 s80, s51, 7
    s_cmp_lt_u32 s51, 56
    s_cselect_b32 s80, s80, 8
    s_sub_u32 s51, s80, 1
    s_cmp_lt_u32 s51, 6
    s_cselect_b64 s[54:55], -1, 0
    s_and_b32 s51, s51, 7
    s_lshl_b32 s51, s51, 12
    s_add_u32 s99, s81, s51
    s_sub_u32 s51, s80, 4
    s_cmp_lt_u32 s51, 4
    s_cselect_b64 s[56:57], -1, 0
    s_cmp_eq_u32 s51, 0
    s_cselect_b64 s[58:59], -1, 0
    s_and_b32 s51, s51, 3
    s_mul_i32 s51, s51, 10485760
    s_add_u32 s44, s82, s51
    s_mul_i32 s51, s42, 3072
    s_add_u32 s72, s51, s78
    s_add_u32 s52, s51, s77
    v_add_u32 v161, s52, v167
    v_add_u32 v162, s79, v5
    v_add_u32 v163, s79, v167
    v_add_u32 v160, s72, v5
    s_waitcnt lgkmcnt(0)
    s_waitcnt vmcnt(0)
    s_barrier
    v_mov_b32 v13, 81920
    s_cmp_lg_u32 s42, 0
    s_cbranch_scc1 GWs_29
    s_mov_b32 s47, 0
GW_27:
    buffer_load_dword v12, v31, s[24:27], 0 offen sc1
    s_add_u32 s47, s47, 1
    s_waitcnt vmcnt(0)
    v_sad_u8 v11, v12, 0, 0
    s_nop 1
    v_add_u32_dpp v11, v11, v11 row_ror:8 row_mask:0xf bank_mask:0xf
    s_nop 1
    v_add_u32_dpp v11, v11, v11 row_ror:4 row_mask:0xf bank_mask:0xf
    s_nop 1
    v_add_u32_dpp v11, v11, v11 row_ror:2 row_mask:0xf bank_mask:0xf
    s_nop 1
    v_add_u32_dpp v11, v11, v11 row_ror:1 row_mask:0xf bank_mask:0xf
    v_mov_b32 v14, v11
    s_nop 1
    v_permlane16_swap_b32 v11, v14
    v_add_u32 v11, v11, v14
    v_mov_b32 v14, v11
    s_nop 1
    v_permlane32_swap_b32 v11, v14
    v_add_u32 v11, v11, v14
    v_cmp_ne_u32 vcc, 0x400, v11
    s_cmp_gt_u32 s47, s46
    s_cbranch_vccz GWo_28
    s_sleep 6
    s_cbranch_scc0 GW_27
    s_mov_b32 s46, 0
GWo_28:
    v_and_b32 v12, 0x7f7f7f7f, v12
    v_cmp_ne_u32 vcc, 0, v12
    s_nop 0
    s_cmp_eq_u64 vcc, 0
    s_cselect_b32 s48, 1, 0
    v_mov_b32 v12, s48
    ds_write_b32 v13, v12
    s_waitcnt lgkmcnt(0)
GWs_29:
    s_barrier
    ds_read_b32 v12, v13
    s_waitcnt lgkmcnt(0)
    v_readfirstlane_b32 s48, v12
    s_add_u32 m0, s75, 0
    s_add_u32 s49, s74, 0
    buffer_load_dwordx4 v5, s[4:7], s49 offen offset:0 lds
    buffer_load_dwordx4 v5, s[4:7], s49 offen offset:1024 lds
    buffer_load_dwordx4 v5, s[4:7], s49 offen offset:2048 lds
    buffer_load_dwordx4 v5, s[4:7], s49 offen offset:3072 lds
    s_add_u32 m0, s75, 4096
    s_add_u32 s49, s74, 4096
    buffer_load_dwordx4 v5, s[4:7], s49 offen offset:0 lds
    buffer_load_dwordx4 v5, s[4:7], s49 offen offset:1024 lds
    buffer_load_dwordx4 v5, s[4:7], s49 offen offset:2048 lds
    buffer_load_dwordx4 v5, s[4:7], s49 offen offset:3072 lds
    s_add_u32 m0, s75, 8192
    s_add_u32 s49, s74, 8192
    buffer_load_dwordx4 v5, s[4:7], s49 offen offset:0 lds
    buffer_load_dwordx4 v5, s[4:7], s49 offen offset:1024 lds
    s_add_u32 s74, s74, 40960
    s_mul_i32 s49, s42, 20480
    s_add_u32 s49, s49, 40960
    s_sub_u32 s75, s49, s75
    s_add_u32 m0, s75, 0
    s_add_u32 s49, s74, 0
    buffer_load_dwordx4 v5, s[4:7], s49 offen offset:0 lds
    buffer_load_dwordx4 v5, s[4:7], s49 offen offset:1024 lds
    buffer_load_dwordx4 v5, s[4:7], s49 offen offset:2048 lds
    buffer_load_dwordx4 v5, s[4:7], s49 offen offset:3072 lds
    s_add_u32 m0, s75, 4096
    s_add_u32 s49, s74, 4096
    buffer_load_dwordx4 v5, s[4:7], s49 offen offset:0 lds
    buffer_load_dwordx4 v5, s[4:7], s49 offen offset:1024 lds
    buffer_load_dwordx4 v5, s[4:7], s49 offen offset:2048 lds
    buffer_load_dwordx4 v5, s[4:7], s49 offen offset:3072 lds
    s_add_u32 m0, s75, 8192
    s_add_u32 s49, s74, 8192
    buffer_load_dwordx4 v5, s[4:7], s49 offen offset:0 lds
    buffer_load_dwordx4 v5, s[4:7], s49 offen offset:1024 lds
    s_add_u32 s74, s74, 40960
    s_mul_i32 s49, s42, 20480
    s_add_u32 s49, s49, 40960
    s_sub_u32 s75, s49, s75
    v_lshlrev_b32 v172, 16, v174
    v_and_b32 v173, 0xffff0000, v174
    v_lshlrev_b32 v174, 16, v175
    v_and_b32 v175, 0xffff0000, v175
    s_waitcnt vmcnt(10)
    s_barrier
    ds_read_b128 v[32:35], v10 offset:0
    ds_read_b128 v[36:39], v10 offset:1024
    ds_read_b128 v[40:43], v10 offset:2048
    ds_read_b128 v[44:47], v10 offset:3072
    ds_read_b128 v[48:51], v10 offset:4096
    ds_read_b128 v[52:55], v10 offset:5120
    ds_read_b128 v[56:59], v10 offset:6144
    ds_read_b128 v[60:63], v10 offset:7168
    ds_read_b128 v[64:67], v10 offset:8192
    s_waitcnt lgkmcnt(8)
    v_mfma_f32_16x16x32_bf16 v[112:115], v[32:35], a[0:3], 0
    v_mfma_f32_16x16x32_bf16 v[116:119], v[32:35], a[80:83], 0
    ds_read_b128 v[68:71], v10 offset:9216
    s_waitcnt lgkmcnt(8)
    v_mfma_f32_16x16x32_bf16 v[112:115], v[36:39], a[4:7], v[112:115]
    v_mfma_f32_16x16x32_bf16 v[116:119], v[36:39], a[84:87], v[116:119]
    ds_read_b128 v[32:35], v10 offset:10240
    s_waitcnt lgkmcnt(8)
    v_mfma_f32_16x16x32_bf16 v[112:115], v[40:43], a[8:11], v[112:115]
    v_mfma_f32_16x16x32_bf16 v[116:119], v[40:43], a[88:91], v[116:119]
    ds_read_b128 v[36:39], v10 offset:11264
    s_waitcnt lgkmcnt(8)
    v_mfma_f32_16x16x32_bf16 v[112:115], v[44:47], a[12:15], v[112:115]
    v_mfma_f32_16x16x32_bf16 v[116:119], v[44:47], a[92:95], v[116:119]
    ds_read_b128 v[40:43], v10 offset:12288
    s_waitcnt lgkmcnt(8)
    v_mfma_f32_16x16x32_bf16 v[112:115], v[48:51], a[16:19], v[112:115]
    v_mfma_f32_16x16x32_bf16 v[116:119], v[48:51], a[96:99], v[116:119]
    ds_read_b128 v[44:47], v10 offset:13312
    s_waitcnt lgkmcnt(8)
    v_mfma_f32_16x16x32_bf16 v[112:115], v[52:55], a[20:23], v[112:115]
    v_mfma_f32_16x16x32_bf16 v[116:119], v[52:55], a[100:103], v[116:119]
    ds_read_b128 v[48:51], v10 offset:14336
    s_waitcnt lgkmcnt(8)
    v_mfma_f32_16x16x32_bf16 v[112:115], v[56:59], a[24:27], v[112:115]
    v_mfma_f32_16x16x32_bf16 v[116:119], v[56:59], a[104:107], v[116:119]
    ds_read_b128 v[52:55], v10 offset:15360
    s_waitcnt lgkmcnt(8)
    v_mfma_f32_16x16x32_bf16 v[112:115], v[60:63], a[28:31], v[112:115]
    v_mfma_f32_16x16x32_bf16 v[116:119], v[60:63], a[108:111], v[116:119]
    ds_read_b128 v[56:59], v10 offset:16384
    s_waitcnt lgkmcnt(8)
    v_mfma_f32_16x16x32_bf16 v[112:115], v[64:67], a[32:35], v[112:115]
    v_mfma_f32_16x16x32_bf16 v[116:119], v[64:67], a[112:115], v[116:119]
    ds_read_b128 v[60:63], v10 offset:17408
    s_waitcnt lgkmcnt(8)
    v_mfma_f32_16x16x32_bf16 v[112:115], v[68:71], a[36:39], v[112:115]
    v_mfma_f32_16x16x32_bf16 v[116:119], v[68:71], a[116:119], v[116:119]
    ds_read_b128 v[64:67], v10 offset:18432
    s_waitcnt lgkmcnt(8)
    v_mfma_f32_16x16x32_bf16 v[112:115], v[32:35], a[40:43], v[112:115]
    v_mfma_f32_16x16x32_bf16 v[116:119], v[32:35], a[120:123], v[116:119]
    ds_read_b128 v[68:71], v10 offset:19456
    s_waitcnt lgkmcnt(8)
    v_mfma_f32_16x16x32_bf16 v[112:115], v[36:39], a[44:47], v[112:115]
    v_mfma_f32_16x16x32_bf16 v[116:119], v[36:39], a[124:127], v[116:119]
    ds_read_b128 v[32:35], v10 offset:20480
    s_waitcnt lgkmcnt(8)
    v_mfma_f32_16x16x32_bf16 v[112:115], v[40:43], a[48:51], v[112:115]
    v_mfma_f32_16x16x32_bf16 v[116:119], v[40:43], a[128:131], v[116:119]
    ds_read_b128 v[36:39], v10 offset:21504
    s_waitcnt lgkmcnt(8)
    v_mfma_f32_16x16x32_bf16 v[112:115], v[44:47], a[52:55], v[112:115]
    v_mfma_f32_16x16x32_bf16 v[116:119], v[44:47], a[132:135], v[116:119]
    ds_read_b128 v[40:43], v10 offset:22528
    s_waitcnt lgkmcnt(8)
    v_mfma_f32_16x16x32_bf16 v[112:115], v[48:51], a[56:59], v[112:115]
    v_mfma_f32_16x16x32_bf16 v[116:119], v[48:51], a[136:139], v[116:119]
    ds_read_b128 v[44:47], v10 offset:23552
    s_waitcnt lgkmcnt(8)
    v_mfma_f32_16x16x32_bf16 v[112:115], v[52:55], a[60:63], v[112:115]
    v_mfma_f32_16x16x32_bf16 v[116:119], v[52:55], a[140:143], v[116:119]
    ds_read_b128 v[48:51], v10 offset:24576
    s_waitcnt lgkmcnt(8)
    v_mfma_f32_16x16x32_bf16 v[112:115], v[56:59], a[64:67], v[112:115]
    v_mfma_f32_16x16x32_bf16 v[116:119], v[56:59], a[144:147], v[116:119]
    ds_read_b128 v[52:55], v10 offset:25600
    s_waitcnt lgkmcnt(8)
    v_mfma_f32_16x16x32_bf16 v[112:115], v[60:63], a[68:71], v[112:115]
    v_mfma_f32_16x16x32_bf16 v[116:119], v[60:63], a[148:151], v[116:119]
    ds_read_b128 v[56:59], v10 offset:26624
    s_waitcnt lgkmcnt(8)
    v_mfma_f32_16x16x32_bf16 v[112:115], v[64:67], a[72:75], v[112:115]
    v_mfma_f32_16x16x32_bf16 v[116:119], v[64:67], a[152:155], v[116:119]
    ds_read_b128 v[60:63], v10 offset:27648
    s_waitcnt lgkmcnt(8)
    v_mfma_f32_16x16x32_bf16 v[112:115], v[68:71], a[76:79], v[112:115]
    v_mfma_f32_16x16x32_bf16 v[116:119], v[68:71], a[156:159], v[116:119]
    ds_read_b128 v[64:67], v10 offset:28672
    s_waitcnt lgkmcnt(8)
    v_mfma_f32_16x16x32_bf16 v[120:123], v[32:35], a[0:3], 0
    v_mfma_f32_16x16x32_bf16 v[124:127], v[32:35], a[80:83], 0
    ds_read_b128 v[68:71], v10 offset:29696
    s_waitcnt lgkmcnt(8)
    v_mfma_f32_16x16x32_bf16 v[120:123], v[36:39], a[4:7], v[120:123]
    v_mfma_f32_16x16x32_bf16 v[124:127], v[36:39], a[84:87], v[124:127]
    ds_read_b128 v[32:35], v10 offset:30720
    s_waitcnt lgkmcnt(8)
    v_mfma_f32_16x16x32_bf16 v[120:123], v[40:43], a[8:11], v[120:123]
    v_mfma_f32_16x16x32_bf16 v[124:127], v[40:43], a[88:91], v[124:127]
    ds_read_b128 v[36:39], v10 offset:31744
    s_waitcnt lgkmcnt(8)
    v_mfma_f32_16x16x32_bf16 v[120:123], v[44:47], a[12:15], v[120:123]
    v_mfma_f32_16x16x32_bf16 v[124:127], v[44:47], a[92:95], v[124:127]
    ds_read_b128 v[40:43], v10 offset:32768
    s_waitcnt lgkmcnt(8)
    v_mfma_f32_16x16x32_bf16 v[120:123], v[48:51], a[16:19], v[120:123]
    v_mfma_f32_16x16x32_bf16 v[124:127], v[48:51], a[96:99], v[124:127]
    ds_read_b128 v[44:47], v10 offset:33792
    s_waitcnt lgkmcnt(8)
    v_mfma_f32_16x16x32_bf16 v[120:123], v[52:55], a[20:23], v[120:123]
    v_mfma_f32_16x16x32_bf16 v[124:127], v[52:55], a[100:103], v[124:127]
    ds_read_b128 v[48:51], v10 offset:34816
    s_waitcnt lgkmcnt(8)
    v_mfma_f32_16x16x32_bf16 v[120:123], v[56:59], a[24:27], v[120:123]
    v_mfma_f32_16x16x32_bf16 v[124:127], v[56:59], a[104:107], v[124:127]
    ds_read_b128 v[52:55], v10 offset:35840
    s_waitcnt lgkmcnt(8)
    v_mfma_f32_16x16x32_bf16 v[120:123], v[60:63], a[28:31], v[120:123]
    v_mfma_f32_16x16x32_bf16 v[124:127], v[60:63], a[108:111], v[124:127]
    ds_read_b128 v[56:59], v10 offset:36864
    s_waitcnt lgkmcnt(8)
    v_mfma_f32_16x16x32_bf16 v[120:123], v[64:67], a[32:35], v[120:123]
    v_mfma_f32_16x16x32_bf16 v[124:127], v[64:67], a[112:115], v[124:127]
    ds_read_b128 v[60:63], v10 offset:37888
    s_waitcnt lgkmcnt(8)
    v_mfma_f32_16x16x32_bf16 v[120:123], v[68:71], a[36:39], v[120:123]
    v_mfma_f32_16x16x32_bf16 v[124:127], v[68:71], a[116:119], v[124:127]
    ds_read_b128 v[64:67], v10 offset:38912
    s_waitcnt lgkmcnt(8)
    v_mfma_f32_16x16x32_bf16 v[120:123], v[32:35], a[40:43], v[120:123]
    v_mfma_f32_16x16x32_bf16 v[124:127], v[32:35], a[120:123], v[124:127]
    ds_read_b128 v[68:71], v10 offset:39936
    s_waitcnt lgkmcnt(8)
    v_mfma_f32_16x16x32_bf16 v[120:123], v[36:39], a[44:47], v[120:123]
    v_mfma_f32_16x16x32_bf16 v[124:127], v[36:39], a[124:127], v[124:127]
    s_waitcnt lgkmcnt(7)
    v_mfma_f32_16x16x32_bf16 v[120:123], v[40:43], a[48:51], v[120:123]
    v_mfma_f32_16x16x32_bf16 v[124:127], v[40:43], a[128:131], v[124:127]
    s_waitcnt lgkmcnt(6)
    v_mfma_f32_16x16x32_bf16 v[120:123], v[44:47], a[52:55], v[120:123]
    v_mfma_f32_16x16x32_bf16 v[124:127], v[44:47], a[132:135], v[124:127]
    s_waitcnt lgkmcnt(5)
    v_mfma_f32_16x16x32_bf16 v[120:123], v[48:51], a[56:59], v[120:123]
    v_mfma_f32_16x16x32_bf16 v[124:127], v[48:51], a[136:139], v[124:127]
    s_waitcnt lgkmcnt(4)
    v_mfma_f32_16x16x32_bf16 v[120:123], v[52:55], a[60:63], v[120:123]
    v_mfma_f32_16x16x32_bf16 v[124:127], v[52:55], a[140:143], v[124:127]
    s_waitcnt lgkmcnt(3)
    v_mfma_f32_16x16x32_bf16 v[120:123], v[56:59], a[64:67], v[120:123]
    v_mfma_f32_16x16x32_bf16 v[124:127], v[56:59], a[144:147], v[124:127]
    s_waitcnt lgkmcnt(2)
    v_mfma_f32_16x16x32_bf16 v[120:123], v[60:63], a[68:71], v[120:123]
    v_mfma_f32_16x16x32_bf16 v[124:127], v[60:63], a[148:151], v[124:127]
    s_waitcnt lgkmcnt(1)
    v_mfma_f32_16x16x32_bf16 v[120:123], v[64:67], a[72:75], v[120:123]
    v_mfma_f32_16x16x32_bf16 v[124:127], v[64:67], a[152:155], v[124:127]
    s_waitcnt lgkmcnt(0)
    v_mfma_f32_16x16x32_bf16 v[120:123], v[68:71], a[76:79], v[120:123]
    v_mfma_f32_16x16x32_bf16 v[124:127], v[68:71], a[156:159], v[124:127]
    v_cvt_pk_bf16_f32 v140, v112, v113
    v_cvt_pk_bf16_f32 v141, v114, v115
    v_cvt_pk_bf16_f32 v144, v116, v117
    v_cvt_pk_bf16_f32 v145, v118, v119
    s_nop 2
    v_cvt_pk_bf16_f32 v142, v120, v121
    v_cvt_pk_bf16_f32 v143, v122, v123
    v_cvt_pk_bf16_f32 v146, v124, v125
    v_cvt_pk_bf16_f32 v147, v126, v127
    ds_write_b128 v160, v[140:143] offset:0
    ds_write_b128 v160, v[144:147] offset:1024
    v_sub_u32 v11, v10, v5
    v_sub_u32 v11, 40960, v11
    v_add_u32 v10, v11, v5
    s_cmp_eq_u32 s48, 0
    s_cbranch_scc1 R_E0_s
    s_branch R_E0_f
R_E0_f:
    s_mov_b32 s64, s80
    s_mov_b32 s66, s71
    s_add_u32 s43, s43, 1
    s_mov_b32 s51, s79
    s_mov_b32 s79, s77
    s_mov_b32 s77, s78
    s_mov_b32 s78, s51
    s_add_u32 s84, s43, 3
    s_and_b32 s84, s84, 3
    s_add_u32 s85, s43, 4
    s_and_b32 s85, s85, 3
    s_add_u32 s86, s43, 5
    s_and_b32 s86, s86, 3
    s_add_u32 s87, s43, 6
    s_and_b32 s87, s87, 3
    s_mul_i32 s67, s84, 122880
    s_add_u32 s67, s67, s61
    s_mul_i32 s68, s84, 327680
    s_add_u32 s68, s68, s62
    s_mul_i32 s69, s86, 327680
    s_add_u32 s69, s69, s62
    s_mul_i32 s70, s84, 327680
    s_add_u32 s70, s70, s63
    s_mul_i32 s71, s85, 81920
    s_add_u32 s71, s71, s60
    s_mul_i32 s73, s87, 81920
    s_add_u32 s73, s73, s65
    s_sub_u32 s51, s43, s40
    s_sub_u32 s51, s51, 2
    s_and_b32 s80, s51, 7
    s_cmp_lt_u32 s51, 56
    s_cselect_b32 s80, s80, 8
    s_sub_u32 s51, s80, 1
    s_cmp_lt_u32 s51, 6
    s_cselect_b64 s[54:55], -1, 0
    s_and_b32 s51, s51, 7
    s_lshl_b32 s51, s51, 12
    s_add_u32 s99, s81, s51
    s_sub_u32 s51, s80, 4
    s_cmp_lt_u32 s51, 4
    s_cselect_b64 s[56:57], -1, 0
    s_cmp_eq_u32 s51, 0
    s_cselect_b64 s[58:59], -1, 0
    s_and_b32 s51, s51, 3
    s_mul_i32 s51, s51, 10485760
    s_add_u32 s44, s82, s51
    s_mul_i32 s51, s42, 3072
    s_add_u32 s72, s51, s78
    s_add_u32 s52, s51, s77
    v_add_u32 v161, s52, v167
    v_add_u32 v162, s79, v5
    v_add_u32 v163, s79, v167
    v_add_f32 v72, v72, v80
    v_cndmask_b32 v72, v72, 0, s[58:59]
    v_add_f32 v73, v73, v81
    v_cndmask_b32 v73, v73, 0, s[58:59]
    v_add_f32 v74, v74, v82
    v_cndmask_b32 v74, v74, 0, s[58:59]
    v_add_f32 v75, v75, v83
    v_cndmask_b32 v75, v75, 0, s[58:59]
    v_add_f32 v76, v76, v84
    v_cndmask_b32 v76, v76, 0, s[58:59]
    v_add_f32 v77, v77, v85
    v_cndmask_b32 v77, v77, 0, s[58:59]
    v_add_f32 v78, v78, v86
    v_cndmask_b32 v78, v78, 0, s[58:59]
    v_add_f32 v79, v79, v87
    v_cndmask_b32 v79, v79, 0, s[58:59]
    v_mov_b32 v16, -1
    v_mov_b32 v17, -1
    v_mov_b32 v18, -1
    v_mov_b32 v19, -1
    v_mov_b32 v20, -1
    v_mov_b32 v21, -1
    v_mov_b32 v22, -1
    v_mov_b32 v23, -1
    v_mov_b32 v24, -1
    v_mov_b32 v25, -1
    v_mov_b32 v26, -1
    v_mov_b32 v27, -1
    v_mov_b32 v196, -1
    v_mov_b32 v197, -1
    v_mov_b32 v198, -1
    v_mov_b32 v199, -1
    v_mov_b32 v200, -1
    v_mov_b32 v201, -1
    v_mov_b32 v202, -1
    v_mov_b32 v203, -1
    v_mov_b32 v204, -1
    v_mov_b32 v205, -1
    v_mov_b32 v206, -1
    v_mov_b32 v207, -1
    v_mov_b32 v108, -1
    v_mov_b32 v109, -1
    v_mov_b32 v110, -1
    v_mov_b32 v128, 0
    v_mov_b32 v129, 0
    v_mov_b32 v130, 0
    v_mov_b32 v131, 0
    v_mov_b32 v132, 0
    v_mov_b32 v133, 0
    v_mov_b32 v134, 0
    v_mov_b32 v135, 0
    v_add_u32 v160, s72, v5
    s_nop 0
    s_branch R_J_f
R_loop_f:
    s_mov_b32 s47, 0
D_30:
    v_max3_u32 v11, v16, v17, v18
    v_max3_u32 v11, v11, v19, v20
    v_max3_u32 v11, v11, v21, v22
    v_max3_u32 v11, v11, v23, v24
    v_max3_u32 v11, v11, v25, v26
    v_max_u32 v11, v11, v27
    v_cmp_eq_u32 vcc, -1, v11
    s_cbranch_vccz Do_31
    v_max3_u32 v11, v16, v17, v18
    v_max3_u32 v11, v11, v19, v20
    v_max3_u32 v11, v11, v21, v22
    v_max3_u32 v11, v11, v23, v24
    v_max3_u32 v11, v11, v25, v26
    v_max_u32 v11, v11, v27
    v_cmp_eq_u32 vcc, -1, v11
    s_cbranch_vccz Do_31
    v_max3_u32 v11, v16, v17, v18
    v_max3_u32 v11, v11, v19, v20
    v_max3_u32 v11, v11, v21, v22
    v_max3_u32 v11, v11, v23, v24
    v_max3_u32 v11, v11, v25, v26
    v_max_u32 v11, v11, v27
    v_cmp_eq_u32 vcc, -1, v11
    s_cbranch_vccz Do_31
    s_add_u32 s47, s47, 1
    s_cmp_gt_u32 s47, s46
    v_max3_u32 v12, v16, v17, v18
    v_max_u32 v12, v12, v19
    v_max3_u32 v13, v20, v21, v22
    v_max_u32 v13, v13, v23
    v_max3_u32 v14, v24, v25, v26
    v_max_u32 v14, v14, v27
    v_cmp_eq_u32 vcc, -1, v12
    v_cmp_eq_u32 s[92:93], -1, v13
    v_cmp_eq_u32 s[94:95], -1, v14
    s_mov_b64 exec, vcc
    buffer_load_dwordx4 v[16:19], v6, s[4:7], s66 offen offset:0 sc1
    s_mov_b64 exec, s[92:93]
    buffer_load_dwordx4 v[20:23], v7, s[4:7], s66 offen offset:0 sc1
    s_mov_b64 exec, s[94:95]
    buffer_load_dwordx4 v[24:27], v8, s[4:7], s66 offen offset:0 sc1
    s_mov_b64 exec, -1
    s_cbranch_scc0 D_30
    s_mov_b32 s46, 0
Do_31:
    ds_write_b128 v150, v[16:19]
    ds_write_b128 v151, v[20:23]
    ds_write_b128 v152, v[24:27]
    s_waitcnt lgkmcnt(0)
    s_barrier
    ds_read_b128 v[32:35], v9 offset:0
    ds_read_b128 v[36:39], v9 offset:1024
    ds_read_b128 v[40:43], v9 offset:2048
    ds_read_b128 v[44:47], v9 offset:3072
    ds_read_b128 v[48:51], v9 offset:4096
    ds_read_b128 v[52:55], v9 offset:5120
    ds_read_b128 v[56:59], v9 offset:6144
    ds_read_b128 v[60:63], v9 offset:7168
    ds_read_b128 v[64:67], v9 offset:8192
    ds_read_b128 v[68:71], v9 offset:9216
    s_waitcnt lgkmcnt(9)
    v_smfmac_f32_16x16x64_bf16 v[128:131], v[32:35], a[0:7], v30
    v_smfmac_f32_16x16x64_bf16 v[132:135], v[32:35], a[80:87], v30
    s_add_u32 m0, s75, 0
    s_add_u32 s49, s74, 0
    buffer_load_dwordx4 v5, s[4:7], s49 offen offset:0 lds
    s_waitcnt lgkmcnt(8)
    v_smfmac_f32_16x16x64_bf16 v[128:131], v[36:39], a[8:15], v30
    v_smfmac_f32_16x16x64_bf16 v[132:135], v[36:39], a[88:95], v30
    s_waitcnt lgkmcnt(7)
    v_smfmac_f32_16x16x64_bf16 v[128:131], v[40:43], a[16:23], v30
    v_smfmac_f32_16x16x64_bf16 v[132:135], v[40:43], a[96:103], v30
    s_waitcnt lgkmcnt(6)
    v_smfmac_f32_16x16x64_bf16 v[128:131], v[44:47], a[24:31], v30
    v_smfmac_f32_16x16x64_bf16 v[132:135], v[44:47], a[104:111], v30
    buffer_load_dwordx4 v5, s[4:7], s49 offen offset:1024 lds
    s_waitcnt lgkmcnt(5)
    v_smfmac_f32_16x16x64_bf16 v[128:131], v[48:51], a[32:39], v30
    v_smfmac_f32_16x16x64_bf16 v[132:135], v[48:51], a[112:119], v30
    s_waitcnt lgkmcnt(4)
    v_smfmac_f32_16x16x64_bf16 v[128:131], v[52:55], a[40:47], v30
    v_smfmac_f32_16x16x64_bf16 v[132:135], v[52:55], a[120:127], v30
    s_waitcnt lgkmcnt(3)
    v_smfmac_f32_16x16x64_bf16 v[128:131], v[56:59], a[48:55], v30
    v_smfmac_f32_16x16x64_bf16 v[132:135], v[56:59], a[128:135], v30
    buffer_load_dwordx4 v5, s[4:7], s49 offen offset:2048 lds
    s_waitcnt lgkmcnt(2)
    v_smfmac_f32_16x16x64_bf16 v[128:131], v[60:63], a[56:63], v30
    v_smfmac_f32_16x16x64_bf16 v[132:135], v[60:63], a[136:143], v30
    s_waitcnt lgkmcnt(1)
    v_smfmac_f32_16x16x64_bf16 v[128:131], v[64:67], a[64:71], v30
    v_smfmac_f32_16x16x64_bf16 v[132:135], v[64:67], a[144:151], v30
    s_waitcnt lgkmcnt(0)
    v_smfmac_f32_16x16x64_bf16 v[128:131], v[68:71], a[72:79], v30
    v_smfmac_f32_16x16x64_bf16 v[132:135], v[68:71], a[152:159], v30
    buffer_load_dwordx4 v5, s[4:7], s49 offen offset:3072 lds
    s_nop 5
    v_cvt_pk_bf16_f32 v136, v128, v129
    v_cvt_pk_bf16_f32 v137, v130, v131
    v_cvt_pk_bf16_f32 v138, v132, v133
    v_cvt_pk_bf16_f32 v139, v134, v135
    ds_write_b64 v161, v[136:137] offset:2048
    ds_write_b64 v161, v[138:139] offset:2560
    s_cmp_eq_u32 s43, 64
    s_cbranch_scc1 R_last
    ds_read_b128 v[32:35], v10 offset:0
    ds_read_b128 v[36:39], v10 offset:1024
    ds_read_b128 v[40:43], v10 offset:2048
    ds_read_b128 v[44:47], v10 offset:3072
    ds_read_b128 v[48:51], v10 offset:4096
    ds_read_b128 v[52:55], v10 offset:5120
    ds_read_b128 v[56:59], v10 offset:6144
    ds_read_b128 v[60:63], v10 offset:7168
    ds_read_b128 v[64:67], v10 offset:8192
    s_waitcnt lgkmcnt(8)
    v_mfma_f32_16x16x32_bf16 v[112:115], v[32:35], a[0:3], 0
    v_mfma_f32_16x16x32_bf16 v[116:119], v[32:35], a[80:83], 0
    s_mov_b64 exec, s[2:3]
    buffer_load_dwordx4 v[176:179], v5, s[4:7], s73 offen offset:0 sc1
    s_mov_b64 exec, -1
    ds_read_b128 v[68:71], v10 offset:9216
    s_waitcnt lgkmcnt(8)
    v_mfma_f32_16x16x32_bf16 v[112:115], v[36:39], a[4:7], v[112:115]
    v_mfma_f32_16x16x32_bf16 v[116:119], v[36:39], a[84:87], v[116:119]
    ds_read_b128 v[32:35], v10 offset:10240
    s_waitcnt lgkmcnt(8)
    v_mfma_f32_16x16x32_bf16 v[112:115], v[40:43], a[8:11], v[112:115]
    v_mfma_f32_16x16x32_bf16 v[116:119], v[40:43], a[88:91], v[116:119]
    s_mov_b64 exec, s[2:3]
    buffer_load_dwordx4 v[180:183], v5, s[4:7], s73 offen offset:1024 sc1
    s_mov_b64 exec, -1
    s_waitcnt lgkmcnt(7)
    v_mfma_f32_16x16x32_bf16 v[112:115], v[44:47], a[12:15], v[112:115]
    v_mfma_f32_16x16x32_bf16 v[116:119], v[44:47], a[92:95], v[116:119]
    s_add_u32 m0, s75, 4096
    s_add_u32 s49, s74, 4096
    buffer_load_dwordx4 v5, s[4:7], s49 offen offset:0 lds
    s_waitcnt lgkmcnt(6)
    v_mfma_f32_16x16x32_bf16 v[112:115], v[48:51], a[16:19], v[112:115]
    v_mfma_f32_16x16x32_bf16 v[116:119], v[48:51], a[96:99], v[116:119]
    s_mov_b64 exec, s[2:3]
    buffer_load_dwordx4 v[184:187], v5, s[4:7], s73 offen offset:2048 sc1
    s_mov_b64 exec, -1
    s_waitcnt lgkmcnt(5)
    v_mfma_f32_16x16x32_bf16 v[112:115], v[52:55], a[20:23], v[112:115]
    v_mfma_f32_16x16x32_bf16 v[116:119], v[52:55], a[100:103], v[116:119]
    s_waitcnt lgkmcnt(4)
    v_mfma_f32_16x16x32_bf16 v[112:115], v[56:59], a[24:27], v[112:115]
    v_mfma_f32_16x16x32_bf16 v[116:119], v[56:59], a[104:107], v[116:119]
    s_mov_b64 exec, s[2:3]
    buffer_load_dwordx4 v[188:191], v5, s[4:7], s73 offen offset:3072 sc1
    s_mov_b64 exec, -1
    s_waitcnt lgkmcnt(3)
    v_mfma_f32_16x16x32_bf16 v[112:115], v[60:63], a[28:31], v[112:115]
    v_mfma_f32_16x16x32_bf16 v[116:119], v[60:63], a[108:111], v[116:119]
    s_waitcnt lgkmcnt(2)
    v_mfma_f32_16x16x32_bf16 v[112:115], v[64:67], a[32:35], v[112:115]
    v_mfma_f32_16x16x32_bf16 v[116:119], v[64:67], a[112:115], v[116:119]
    s_mov_b64 exec, s[2:3]
    buffer_load_dwordx4 v[192:195], v159, s[4:7], s73 offen offset:0 sc1
    s_mov_b64 exec, -1
    buffer_load_dwordx4 v[196:199], v5, s[4:7], s67 offen offset:0 sc1
    buffer_load_dwordx4 v[200:203], v5, s[4:7], s67 offen offset:1280 sc1
    buffer_load_dwordx4 v[204:207], v5, s[4:7], s67 offen offset:2560 sc1
    buffer_load_dword v108, v31, s[4:7], s67 offen offset:1024 sc1
    buffer_load_dword v109, v31, s[4:7], s67 offen offset:2304 sc1
    buffer_load_dword v110, v31, s[4:7], s67 offen offset:3584 sc1
    s_waitcnt lgkmcnt(1)
    v_mfma_f32_16x16x32_bf16 v[112:115], v[68:71], a[36:39], v[112:115]
    v_mfma_f32_16x16x32_bf16 v[116:119], v[68:71], a[116:119], v[116:119]
    s_waitcnt lgkmcnt(0)
    v_mfma_f32_16x16x32_bf16 v[112:115], v[32:35], a[40:43], v[112:115]
    v_mfma_f32_16x16x32_bf16 v[116:119], v[32:35], a[120:123], v[116:119]
    s_mov_b32 s47, 0
D_33:
    s_waitcnt vmcnt(0)
    v_max3_u32 v11, v196, v197, v198
    v_max3_u32 v11, v11, v199, v200
    v_max3_u32 v11, v11, v201, v202
    v_max3_u32 v11, v11, v203, v204
    v_max3_u32 v11, v11, v205, v206
    v_max3_u32 v11, v11, v207, v108
    v_max3_u32 v11, v11, v109, v110
    v_cmp_eq_u32 vcc, -1, v11
    s_cbranch_vccz Do_34
    s_add_u32 s47, s47, 1
    s_cmp_gt_u32 s47, s46
    v_max3_u32 v12, v196, v197, v198
    v_max_u32 v12, v12, v199
    v_max3_u32 v13, v200, v201, v202
    v_max_u32 v13, v13, v203
    v_max3_u32 v14, v204, v205, v206
    v_max_u32 v14, v14, v207
    v_cmp_eq_u32 vcc, -1, v12
    v_cmp_eq_u32 s[92:93], -1, v13
    v_cmp_eq_u32 s[94:95], -1, v14
    v_cmp_eq_u32 s[100:101], -1, v108
    s_mov_b64 exec, vcc
    buffer_load_dwordx4 v[196:199], v5, s[4:7], s67 offen offset:0 sc1
    s_mov_b64 exec, s[92:93]
    buffer_load_dwordx4 v[200:203], v5, s[4:7], s67 offen offset:1280 sc1
    s_mov_b64 exec, s[94:95]
    buffer_load_dwordx4 v[204:207], v5, s[4:7], s67 offen offset:2560 sc1
    s_mov_b64 exec, s[100:101]
    buffer_load_dword v108, v31, s[4:7], s67 offen offset:1024 sc1
    s_mov_b64 exec, -1
    v_cmp_eq_u32 vcc, -1, v109
    v_cmp_eq_u32 s[92:93], -1, v110
    s_mov_b64 exec, vcc
    buffer_load_dword v109, v31, s[4:7], s67 offen offset:2304 sc1
    s_mov_b64 exec, s[92:93]
    buffer_load_dword v110, v31, s[4:7], s67 offen offset:3584 sc1
    s_mov_b64 exec, -1
    s_cbranch_scc0 D_33
    s_mov_b32 s46, 0
Do_34:
    v_pk_add_f32 v[32:33], v[196:197], v[200:201]
    v_pk_add_f32 v[34:35], v[198:199], v[202:203]
    v_add_f32 v44, v108, v109
    v_pk_add_f32 v[32:33], v[32:33], v[204:205]
    v_pk_add_f32 v[34:35], v[34:35], v[206:207]
    v_add_f32 v44, v44, v110
    v_max3_f32 v12, v32, v33, v34
    v_max3_f32 v12, v12, v35, v44
    s_nop 1
    v_max_f32_dpp v12, v12, v12 row_ror:8 row_mask:0xf bank_mask:0xf
    v_mov_b32 v11, v12
    s_nop 1
    v_permlane16_swap_b32 v12, v11
    v_max_f32 v12, v12, v11
    v_mov_b32 v11, v12
    s_nop 1
    v_permlane32_swap_b32 v12, v11
    v_max_f32 v12, v12, v11
    v_mul_f32 v12, 0xbdd53b95, v12
    v_pk_fma_f32 v[32:33], v[32:33], s[88:89], v[12:13] op_sel_hi:[1,1,0]
    v_pk_fma_f32 v[34:35], v[34:35], s[88:89], v[12:13] op_sel_hi:[1,1,0]
    v_fma_f32 v44, v44, s88, v12
    v_exp_f32 v32, v32
    v_exp_f32 v33, v33
    v_exp_f32 v34, v34
    v_exp_f32 v35, v35
    v_exp_f32 v44, v44
    v_cvt_pk_bf16_f32 v42, v32, v33
    v_cvt_pk_bf16_f32 v43, v34, v35
    v_cvt_pk_bf16_f32 v45, v44, v44
    v_and_b32 v36, v42, v164
    v_and_b32 v37, v43, v164
    v_and_b32 v38, v42, v165
    v_and_b32 v39, v43, v165
    v_and_b32 v40, v45, v166
    v_and_b32 v41, v45, v166
    v_mfma_f32_16x16x32_bf16 v[128:131], v[140:143], v[36:39], 0
    v_add_f32 v12, v32, v44
    v_add_f32 v33, v33, v34
    v_mfma_f32_16x16x32_bf16 v[132:135], v[144:147], v[36:39], 0
    v_add_f32 v12, v12, v35
    v_add_f32 v12, v12, v33
    v_mfma_f32_16x16x16_bf16 v[128:131], v[136:137], v[40:41], v[128:131]
    s_nop 0
    v_add_f32_dpp v12, v12, v12 row_ror:8 row_mask:0xf bank_mask:0xf
    v_mov_b32 v11, v12
    v_mfma_f32_16x16x16_bf16 v[132:135], v[138:139], v[40:41], v[132:135]
    s_nop 0
    v_permlane16_swap_b32 v12, v11
    v_add_f32 v12, v12, v11
    v_mov_b32 v11, v12
    s_nop 1
    v_permlane32_swap_b32 v12, v11
    v_add_f32 v12, v12, v11
    v_rcp_f32 v12, v12
    s_nop 0
    v_pk_mul_f32 v[128:129], v[128:129], v[12:13] op_sel_hi:[1,0]
    v_pk_mul_f32 v[130:131], v[130:131], v[12:13] op_sel_hi:[1,0]
    ds_write_b128 v153, v[128:131]
    v_pk_mul_f32 v[132:133], v[132:133], v[12:13] op_sel_hi:[1,0]
    v_pk_mul_f32 v[134:135], v[134:135], v[12:13] op_sel_hi:[1,0]
    ds_write_b128 v153, v[132:135] offset:1024
    s_waitcnt lgkmcnt(0)
    s_barrier
    s_cmp_lt_u32 s42, 2
    s_cbranch_scc1 R_E_f
    ds_read_b128 v[32:35], v154 offset:0
    ds_read_b128 v[36:39], v171 offset:0
    ds_read_b128 v[40:43], v154 offset:2048
    ds_read_b128 v[44:47], v171 offset:2048
    ds_read_b128 v[48:51], v154 offset:4096
    ds_read_b128 v[52:55], v171 offset:4096
    ds_read_b128 v[56:59], v154 offset:6144
    ds_read_b128 v[60:63], v171 offset:6144
    s_waitcnt lgkmcnt(6)
    v_pk_add_f32 v[32:33], v[32:33], v[36:37]
    v_pk_add_f32 v[34:35], v[34:35], v[38:39]
    s_waitcnt lgkmcnt(4)
    v_pk_add_f32 v[40:41], v[40:41], v[44:45]
    v_pk_add_f32 v[42:43], v[42:43], v[46:47]
    v_pk_add_f32 v[32:33], v[32:33], v[40:41]
    v_pk_add_f32 v[34:35], v[34:35], v[42:43]
    s_waitcnt lgkmcnt(2)
    v_pk_add_f32 v[48:49], v[48:49], v[52:53]
    v_pk_add_f32 v[50:51], v[50:51], v[54:55]
    v_pk_add_f32 v[32:33], v[32:33], v[48:49]
    v_pk_add_f32 v[34:35], v[34:35], v[50:51]
    s_waitcnt lgkmcnt(0)
    v_pk_add_f32 v[56:57], v[56:57], v[60:61]
    v_pk_add_f32 v[58:59], v[58:59], v[62:63]
    v_pk_add_f32 v[32:33], v[32:33], v[56:57]
    v_pk_add_f32 v[34:35], v[34:35], v[58:59]
    v_cvt_pk_bf16_f32 v88, v32, v33
    v_cvt_pk_bf16_f32 v89, v34, v35
    v_min_u32 v88, -2, v88
    v_min_u32 v89, -2, v89
    buffer_store_dwordx2 v[88:89], v158, s[4:7], s68 offen offset:0 sc1
    buffer_store_dwordx2 v[244:245], v158, s[4:7], s69 offen offset:0 sc1
    s_branch R_U2_f
R_E_f:
    s_cmp_lt_u32 s43, 2
    s_cbranch_scc1 R_U2_f
    ds_read_b128 v[32:35], v162 offset:0
    ds_read_b128 v[36:39], v162 offset:1024
    ds_read_b128 v[40:43], v162 offset:3072
    ds_read_b128 v[44:47], v162 offset:4096
    ds_read_b128 v[48:51], v162 offset:6144
    ds_read_b128 v[52:55], v162 offset:7168
    ds_read_b128 v[56:59], v162 offset:9216
    ds_read_b128 v[60:63], v162 offset:10240
    ds_read_b64 v[64:65], v163 offset:2048
    ds_read_b64 v[66:67], v163 offset:2560
    ds_read_b64 v[68:69], v163 offset:5120
    ds_read_b64 v[70:71], v163 offset:5632
    ds_read_b64 v[16:17], v163 offset:8192
    ds_read_b64 v[18:19], v163 offset:8704
    ds_read_b64 v[20:21], v163 offset:11264
    ds_read_b64 v[22:23], v163 offset:11776
    s_mov_b32 s47, 0
    s_branch Pw_37
P_36:
    buffer_load_dwordx4 v[176:179], v5, s[4:7], s73 offen offset:0 sc1
    buffer_load_dwordx4 v[180:183], v5, s[4:7], s73 offen offset:1024 sc1
    buffer_load_dwordx4 v[184:187], v5, s[4:7], s73 offen offset:2048 sc1
    buffer_load_dwordx4 v[188:191], v5, s[4:7], s73 offen offset:3072 sc1
    buffer_load_dwordx4 v[192:195], v159, s[4:7], s73 offen offset:0 sc1
Pw_37:
    s_add_u32 s47, s47, 1
    s_cmp_gt_u32 s47, s46
    s_waitcnt vmcnt(0)
    v_max3_u32 v11, v176, v177, v178
    v_max3_u32 v11, v11, v179, v180
    v_max3_u32 v11, v11, v181, v182
    v_max3_u32 v11, v11, v183, v184
    v_max3_u32 v11, v11, v185, v186
    v_max3_u32 v11, v11, v187, v188
    v_max3_u32 v11, v11, v189, v190
    v_max3_u32 v11, v11, v191, v192
    v_max3_u32 v11, v11, v193, v194
    v_max_u32 v11, v11, v195
    v_cmp_eq_u32 vcc, -1, v11
    s_cbranch_vccz Po_38
    s_cbranch_scc0 P_36
    s_mov_b32 s46, 0
Po_38:
    v_mov_b32 v88, v192
    v_mov_b32 v89, v192
    v_mov_b32 v90, v193
    v_mov_b32 v91, v193
    v_mov_b32 v92, v194
    v_mov_b32 v93, v194
    v_mov_b32 v94, v195
    v_mov_b32 v95, v195
    s_waitcnt lgkmcnt(0)
    v_mfma_f32_16x16x32_bf16 v[128:131], v[32:35], v[176:179], 0
    v_mfma_f32_16x16x32_bf16 v[132:135], v[36:39], v[176:179], 0
    v_mfma_f32_16x16x32_bf16 v[128:131], v[40:43], v[180:183], v[128:131]
    v_mfma_f32_16x16x32_bf16 v[132:135], v[44:47], v[180:183], v[132:135]
    v_mfma_f32_16x16x32_bf16 v[128:131], v[48:51], v[184:187], v[128:131]
    v_mfma_f32_16x16x32_bf16 v[132:135], v[52:55], v[184:187], v[132:135]
    v_mfma_f32_16x16x32_bf16 v[128:131], v[56:59], v[188:191], v[128:131]
    v_mfma_f32_16x16x32_bf16 v[132:135], v[60:63], v[188:191], v[132:135]
    v_mfma_f32_16x16x16_bf16 v[128:131], v[64:65], v[88:89], v[128:131]
    v_mfma_f32_16x16x16_bf16 v[132:135], v[66:67], v[88:89], v[132:135]
    v_mfma_f32_16x16x16_bf16 v[128:131], v[68:69], v[90:91], v[128:131]
    v_mfma_f32_16x16x16_bf16 v[132:135], v[70:71], v[90:91], v[132:135]
    v_mfma_f32_16x16x16_bf16 v[128:131], v[16:17], v[92:93], v[128:131]
    v_mfma_f32_16x16x16_bf16 v[132:135], v[18:19], v[92:93], v[132:135]
    v_mfma_f32_16x16x16_bf16 v[128:131], v[20:21], v[94:95], v[128:131]
    v_mfma_f32_16x16x16_bf16 v[132:135], v[22:23], v[94:95], v[132:135]
    s_nop 6
    buffer_store_dwordx4 v[128:131], v5, s[4:7], s76 offen offset:0 sc1
    buffer_store_dwordx4 v[132:135], v5, s[4:7], s76 offen offset:1024 sc1
    s_add_u32 s76, s76, 81920
R_U2_f:
    s_cmp_eq_u32 s80, 6
    s_cselect_b64 exec, -1, 0
    buffer_load_dwordx2 v[104:105], v170, s[28:31], s83 offen
    s_mov_b64 exec, -1
    ds_read_b128 v[32:35], v10 offset:11264
    ds_read_b128 v[36:39], v10 offset:12288
    ds_read_b128 v[40:43], v10 offset:13312
    ds_read_b128 v[44:47], v10 offset:14336
    ds_read_b128 v[48:51], v10 offset:15360
    ds_read_b128 v[52:55], v10 offset:16384
    ds_read_b128 v[56:59], v10 offset:17408
    ds_read_b128 v[60:63], v10 offset:18432
    ds_read_b128 v[64:67], v10 offset:19456
    s_waitcnt lgkmcnt(8)
    v_mfma_f32_16x16x32_bf16 v[112:115], v[32:35], a[44:47], v[112:115]
    v_mfma_f32_16x16x32_bf16 v[116:119], v[32:35], a[124:127], v[116:119]
    ds_read_b128 v[68:71], v10 offset:20480
    s_waitcnt lgkmcnt(8)
    v_mfma_f32_16x16x32_bf16 v[112:115], v[36:39], a[48:51], v[112:115]
    v_mfma_f32_16x16x32_bf16 v[116:119], v[36:39], a[128:131], v[116:119]
    ds_read_b128 v[32:35], v10 offset:21504
    s_waitcnt lgkmcnt(8)
    v_mfma_f32_16x16x32_bf16 v[112:115], v[40:43], a[52:55], v[112:115]
    v_mfma_f32_16x16x32_bf16 v[116:119], v[40:43], a[132:135], v[116:119]
    ds_read_b128 v[36:39], v10 offset:22528
    s_waitcnt lgkmcnt(8)
    v_mfma_f32_16x16x32_bf16 v[112:115], v[44:47], a[56:59], v[112:115]
    v_mfma_f32_16x16x32_bf16 v[116:119], v[44:47], a[136:139], v[116:119]
    ds_read_b128 v[40:43], v10 offset:23552
    s_waitcnt lgkmcnt(8)
    v_mfma_f32_16x16x32_bf16 v[112:115], v[48:51], a[60:63], v[112:115]
    v_mfma_f32_16x16x32_bf16 v[116:119], v[48:51], a[140:143], v[116:119]
    ds_read_b128 v[44:47], v10 offset:24576
    s_waitcnt lgkmcnt(8)
    v_mfma_f32_16x16x32_bf16 v[112:115], v[52:55], a[64:67], v[112:115]
    v_mfma_f32_16x16x32_bf16 v[116:119], v[52:55], a[144:147], v[116:119]
    buffer_load_dwordx4 v5, s[4:7], s49 offen offset:1024 lds
    ds_read_b128 v[48:51], v10 offset:25600
    s_waitcnt lgkmcnt(8)
    v_mfma_f32_16x16x32_bf16 v[112:115], v[56:59], a[68:71], v[112:115]
    v_mfma_f32_16x16x32_bf16 v[116:119], v[56:59], a[148:151], v[116:119]
    ds_read_b128 v[52:55], v10 offset:26624
    s_waitcnt lgkmcnt(8)
    v_mfma_f32_16x16x32_bf16 v[112:115], v[60:63], a[72:75], v[112:115]
    v_mfma_f32_16x16x32_bf16 v[116:119], v[60:63], a[152:155], v[116:119]
    ds_read_b128 v[56:59], v10 offset:27648
    s_waitcnt lgkmcnt(8)
    v_mfma_f32_16x16x32_bf16 v[112:115], v[64:67], a[76:79], v[112:115]
    v_mfma_f32_16x16x32_bf16 v[116:119], v[64:67], a[156:159], v[116:119]
    ds_read_b128 v[60:63], v10 offset:28672
    s_waitcnt lgkmcnt(8)
    v_mfma_f32_16x16x32_bf16 v[120:123], v[68:71], a[0:3], 0
    v_mfma_f32_16x16x32_bf16 v[124:127], v[68:71], a[80:83], 0
    buffer_load_dwordx4 v5, s[4:7], s49 offen offset:2048 lds
    ds_read_b128 v[64:67], v10 offset:29696
    s_waitcnt lgkmcnt(8)
    v_mfma_f32_16x16x32_bf16 v[120:123], v[32:35], a[4:7], v[120:123]
    v_mfma_f32_16x16x32_bf16 v[124:127], v[32:35], a[84:87], v[124:127]
    ds_read_b128 v[68:71], v10 offset:30720
    s_waitcnt lgkmcnt(8)
    v_mfma_f32_16x16x32_bf16 v[120:123], v[36:39], a[8:11], v[120:123]
    v_mfma_f32_16x16x32_bf16 v[124:127], v[36:39], a[88:91], v[124:127]
    ds_read_b128 v[32:35], v10 offset:31744
    s_waitcnt lgkmcnt(8)
    v_mfma_f32_16x16x32_bf16 v[120:123], v[40:43], a[12:15], v[120:123]
    v_mfma_f32_16x16x32_bf16 v[124:127], v[40:43], a[92:95], v[124:127]
    ds_read_b128 v[36:39], v10 offset:32768
    s_waitcnt lgkmcnt(8)
    v_mfma_f32_16x16x32_bf16 v[120:123], v[44:47], a[16:19], v[120:123]
    v_mfma_f32_16x16x32_bf16 v[124:127], v[44:47], a[96:99], v[124:127]
    buffer_load_dwordx4 v5, s[4:7], s49 offen offset:3072 lds
    ds_read_b128 v[40:43], v10 offset:33792
    s_waitcnt lgkmcnt(8)
    v_mfma_f32_16x16x32_bf16 v[120:123], v[48:51], a[20:23], v[120:123]
    v_mfma_f32_16x16x32_bf16 v[124:127], v[48:51], a[100:103], v[124:127]
    ds_read_b128 v[44:47], v10 offset:34816
    s_waitcnt lgkmcnt(8)
    v_mfma_f32_16x16x32_bf16 v[120:123], v[52:55], a[24:27], v[120:123]
    v_mfma_f32_16x16x32_bf16 v[124:127], v[52:55], a[104:107], v[124:127]
    ds_read_b128 v[48:51], v10 offset:35840
    s_waitcnt lgkmcnt(8)
    v_mfma_f32_16x16x32_bf16 v[120:123], v[56:59], a[28:31], v[120:123]
    v_mfma_f32_16x16x32_bf16 v[124:127], v[56:59], a[108:111], v[124:127]
    ds_read_b128 v[52:55], v10 offset:36864
    s_waitcnt lgkmcnt(8)
    v_mfma_f32_16x16x32_bf16 v[120:123], v[60:63], a[32:35], v[120:123]
    v_mfma_f32_16x16x32_bf16 v[124:127], v[60:63], a[112:115], v[124:127]
    s_add_u32 m0, s75, 8192
    s_add_u32 s49, s74, 8192
    buffer_load_dwordx4 v5, s[4:7], s49 offen offset:0 lds
    ds_read_b128 v[56:59], v10 offset:37888
    s_waitcnt lgkmcnt(8)
    v_mfma_f32_16x16x32_bf16 v[120:123], v[64:67], a[36:39], v[120:123]
    v_mfma_f32_16x16x32_bf16 v[124:127], v[64:67], a[116:119], v[124:127]
    ds_read_b128 v[60:63], v10 offset:38912
    s_waitcnt lgkmcnt(8)
    v_mfma_f32_16x16x32_bf16 v[120:123], v[68:71], a[40:43], v[120:123]
    v_mfma_f32_16x16x32_bf16 v[124:127], v[68:71], a[120:123], v[124:127]
    ds_read_b128 v[64:67], v10 offset:39936
    s_waitcnt lgkmcnt(8)
    v_mfma_f32_16x16x32_bf16 v[120:123], v[32:35], a[44:47], v[120:123]
    v_mfma_f32_16x16x32_bf16 v[124:127], v[32:35], a[124:127], v[124:127]
    s_waitcnt lgkmcnt(7)
    v_mfma_f32_16x16x32_bf16 v[120:123], v[36:39], a[48:51], v[120:123]
    v_mfma_f32_16x16x32_bf16 v[124:127], v[36:39], a[128:131], v[124:127]
    buffer_load_dwordx4 v5, s[4:7], s49 offen offset:1024 lds
    s_add_u32 s74, s74, 40960
    s_mul_i32 s49, s42, 20480
    s_add_u32 s49, s49, 40960
    s_sub_u32 s75, s49, s75
    s_waitcnt lgkmcnt(6)
    v_mfma_f32_16x16x32_bf16 v[120:123], v[40:43], a[52:55], v[120:123]
    v_mfma_f32_16x16x32_bf16 v[124:127], v[40:43], a[132:135], v[124:127]
    s_waitcnt lgkmcnt(5)
    v_mfma_f32_16x16x32_bf16 v[120:123], v[44:47], a[56:59], v[120:123]
    v_mfma_f32_16x16x32_bf16 v[124:127], v[44:47], a[136:139], v[124:127]
    s_waitcnt lgkmcnt(4)
    v_mfma_f32_16x16x32_bf16 v[120:123], v[48:51], a[60:63], v[120:123]
    v_mfma_f32_16x16x32_bf16 v[124:127], v[48:51], a[140:143], v[124:127]
    s_waitcnt lgkmcnt(3)
    v_mfma_f32_16x16x32_bf16 v[120:123], v[52:55], a[64:67], v[120:123]
    v_mfma_f32_16x16x32_bf16 v[124:127], v[52:55], a[144:147], v[124:127]
    s_waitcnt lgkmcnt(2)
    v_mfma_f32_16x16x32_bf16 v[120:123], v[56:59], a[68:71], v[120:123]
    v_mfma_f32_16x16x32_bf16 v[124:127], v[56:59], a[148:151], v[124:127]
    s_waitcnt lgkmcnt(1)
    v_mfma_f32_16x16x32_bf16 v[120:123], v[60:63], a[72:75], v[120:123]
    v_mfma_f32_16x16x32_bf16 v[124:127], v[60:63], a[152:155], v[124:127]
    s_waitcnt lgkmcnt(0)
    v_mfma_f32_16x16x32_bf16 v[120:123], v[64:67], a[76:79], v[120:123]
    v_mfma_f32_16x16x32_bf16 v[124:127], v[64:67], a[156:159], v[124:127]
    s_mov_b32 s64, s80
    s_mov_b32 s66, s71
    s_add_u32 s43, s43, 1
    s_mov_b32 s51, s79
    s_mov_b32 s79, s77
    s_mov_b32 s77, s78
    s_mov_b32 s78, s51
    s_add_u32 s84, s43, 3
    s_and_b32 s84, s84, 3
    s_add_u32 s85, s43, 4
    s_and_b32 s85, s85, 3
    s_add_u32 s86, s43, 5
    s_and_b32 s86, s86, 3
    s_add_u32 s87, s43, 6
    s_and_b32 s87, s87, 3
    s_mul_i32 s67, s84, 122880
    s_add_u32 s67, s67, s61
    s_mul_i32 s68, s84, 327680
    s_add_u32 s68, s68, s62
    s_mul_i32 s69, s86, 327680
    s_add_u32 s69, s69, s62
    s_mul_i32 s70, s84, 327680
    s_add_u32 s70, s70, s63
    s_mul_i32 s71, s85, 81920
    s_add_u32 s71, s71, s60
    s_mul_i32 s73, s87, 81920
    s_add_u32 s73, s73, s65
    s_sub_u32 s51, s43, s40
    s_sub_u32 s51, s51, 2
    s_and_b32 s80, s51, 7
    s_cmp_lt_u32 s51, 56
    s_cselect_b32 s80, s80, 8
    s_sub_u32 s51, s80, 1
    s_cmp_lt_u32 s51, 6
    s_cselect_b64 s[54:55], -1, 0
    s_and_b32 s51, s51, 7
    s_lshl_b32 s51, s51, 12
    s_add_u32 s99, s81, s51
    s_sub_u32 s51, s80, 4
    s_cmp_lt_u32 s51, 4
    s_cselect_b64 s[56:57], -1, 0
    s_cmp_eq_u32 s51, 0
    s_cselect_b64 s[58:59], -1, 0
    s_and_b32 s51, s51, 3
    s_mul_i32 s51, s51, 10485760
    s_add_u32 s44, s82, s51
    s_mul_i32 s51, s42, 3072
    s_add_u32 s72, s51, s78
    s_add_u32 s52, s51, s77
    v_add_u32 v161, s52, v167
    v_add_u32 v162, s79, v5
    v_add_u32 v163, s79, v167
    v_add_f32 v72, v72, v80
    v_cndmask_b32 v72, v72, 0, s[58:59]
    v_add_f32 v73, v73, v81
    v_cndmask_b32 v73, v73, 0, s[58:59]
    v_add_f32 v74, v74, v82
    v_cndmask_b32 v74, v74, 0, s[58:59]
    v_add_f32 v75, v75, v83
    v_cndmask_b32 v75, v75, 0, s[58:59]
    v_add_f32 v76, v76, v84
    v_cndmask_b32 v76, v76, 0, s[58:59]
    v_add_f32 v77, v77, v85
    v_cndmask_b32 v77, v77, 0, s[58:59]
    v_add_f32 v78, v78, v86
    v_cndmask_b32 v78, v78, 0, s[58:59]
    v_add_f32 v79, v79, v87
    v_cndmask_b32 v79, v79, 0, s[58:59]
    v_mov_b32 v16, -1
    v_mov_b32 v17, -1
    v_mov_b32 v18, -1
    v_mov_b32 v19, -1
    v_mov_b32 v20, -1
    v_mov_b32 v21, -1
    v_mov_b32 v22, -1
    v_mov_b32 v23, -1
    v_mov_b32 v24, -1
    v_mov_b32 v25, -1
    v_mov_b32 v26, -1
    v_mov_b32 v27, -1
    v_mov_b32 v196, -1
    v_mov_b32 v197, -1
    v_mov_b32 v198, -1
    v_mov_b32 v199, -1
    v_mov_b32 v200, -1
    v_mov_b32 v201, -1
    v_mov_b32 v202, -1
    v_mov_b32 v203, -1
    v_mov_b32 v204, -1
    v_mov_b32 v205, -1
    v_mov_b32 v206, -1
    v_mov_b32 v207, -1
    v_mov_b32 v108, -1
    v_mov_b32 v109, -1
    v_mov_b32 v110, -1
    v_mov_b32 v128, 0
    v_mov_b32 v129, 0
    v_mov_b32 v130, 0
    v_mov_b32 v131, 0
    v_mov_b32 v132, 0
    v_mov_b32 v133, 0
    v_mov_b32 v134, 0
    v_mov_b32 v135, 0
    v_cvt_pk_bf16_f32 v140, v112, v113
    v_cvt_pk_bf16_f32 v141, v114, v115
    v_cvt_pk_bf16_f32 v144, v116, v117
    v_cvt_pk_bf16_f32 v145, v118, v119
    v_cvt_pk_bf16_f32 v142, v120, v121
    v_cvt_pk_bf16_f32 v143, v122, v123
    v_cvt_pk_bf16_f32 v146, v124, v125
    v_cvt_pk_bf16_f32 v147, v126, v127
    ds_write_b128 v160, v[140:143] offset:0
    ds_write_b128 v160, v[144:147] offset:1024
    v_sub_u32 v11, v10, v5
    v_sub_u32 v11, 40960, v11
    v_add_u32 v10, v11, v5
    v_add_u32 v160, s72, v5
    s_and_b32 s51, s64, 7
    s_cmp_eq_u32 s51, 0
    s_cbranch_scc1 R_B_f
    s_cmp_ge_u32 s64, 4
    s_cbranch_scc1 PH_39
    s_cmp_ge_u32 s64, 2
    s_cbranch_scc1 PH_40
    v_swap_b32 v226, v228
    v_swap_b32 v227, v229
    v_swap_b32 v234, v236
    v_swap_b32 v235, v237
    v_mfma_f32_16x16x32_bf16 v[208:211], a[160:163], v[224:227], 0
    v_mfma_f32_16x16x32_bf16 v[212:215], a[164:167], v[224:227], 0
    v_mfma_f32_16x16x32_bf16 v[216:219], a[160:163], v[228:231], 0
    v_mfma_f32_16x16x32_bf16 v[220:223], a[164:167], v[228:231], 0
    v_mfma_f32_16x16x32_bf16 v[208:211], a[168:171], v[232:235], v[208:211]
    v_mfma_f32_16x16x32_bf16 v[212:215], a[172:175], v[232:235], v[212:215]
    v_mfma_f32_16x16x32_bf16 v[216:219], a[168:171], v[236:239], v[216:219]
    v_mfma_f32_16x16x32_bf16 v[220:223], a[172:175], v[236:239], v[220:223]
    s_nop 6
    s_branch R_B_f
PH_40:
    s_cmp_ge_u32 s64, 3
    s_cbranch_scc1 PH_41
    v_swap_b32 v226, v228
    v_swap_b32 v227, v229
    v_swap_b32 v234, v236
    v_swap_b32 v235, v237
    v_mfma_f32_16x16x32_bf16 v[208:211], a[176:179], v[224:227], v[208:211]
    v_mfma_f32_16x16x32_bf16 v[212:215], a[180:183], v[224:227], v[212:215]
    v_mfma_f32_16x16x32_bf16 v[216:219], a[176:179], v[228:231], v[216:219]
    v_mfma_f32_16x16x32_bf16 v[220:223], a[180:183], v[228:231], v[220:223]
    v_mfma_f32_16x16x32_bf16 v[208:211], a[184:187], v[232:235], v[208:211]
    v_mfma_f32_16x16x32_bf16 v[212:215], a[188:191], v[232:235], v[212:215]
    v_mfma_f32_16x16x32_bf16 v[216:219], a[184:187], v[236:239], v[216:219]
    v_mfma_f32_16x16x32_bf16 v[220:223], a[188:191], v[236:239], v[220:223]
    s_nop 6
    s_branch R_B_f
PH_41:
    v_swap_b32 v226, v228
    v_swap_b32 v227, v229
    v_swap_b32 v234, v236
    v_swap_b32 v235, v237
    v_mfma_f32_16x16x32_bf16 v[208:211], a[192:195], v[224:227], v[208:211]
    v_mfma_f32_16x16x32_bf16 v[212:215], a[196:199], v[224:227], v[212:215]
    v_mfma_f32_16x16x32_bf16 v[216:219], a[192:195], v[228:231], v[216:219]
    v_mfma_f32_16x16x32_bf16 v[220:223], a[196:199], v[228:231], v[220:223]
    v_mfma_f32_16x16x32_bf16 v[208:211], a[200:203], v[232:235], v[208:211]
    v_mfma_f32_16x16x32_bf16 v[212:215], a[204:207], v[232:235], v[212:215]
    v_mfma_f32_16x16x32_bf16 v[216:219], a[200:203], v[236:239], v[216:219]
    v_mfma_f32_16x16x32_bf16 v[220:223], a[204:207], v[236:239], v[220:223]
    s_nop 6
    s_branch R_B_f
PH_39:
    s_cmp_ge_u32 s64, 6
    s_cbranch_scc1 PH_42
    s_cmp_ge_u32 s64, 5
    s_cbranch_scc1 PH_43
    v_swap_b32 v226, v228
    v_swap_b32 v227, v229
    v_swap_b32 v234, v236
    v_swap_b32 v235, v237
    v_mfma_f32_16x16x32_bf16 v[208:211], a[208:211], v[224:227], v[208:211]
    v_mfma_f32_16x16x32_bf16 v[212:215], a[212:215], v[224:227], v[212:215]
    v_mfma_f32_16x16x32_bf16 v[216:219], a[208:211], v[228:231], v[216:219]
    v_mfma_f32_16x16x32_bf16 v[220:223], a[212:215], v[228:231], v[220:223]
    v_mfma_f32_16x16x32_bf16 v[208:211], a[216:219], v[232:235], v[208:211]
    v_mfma_f32_16x16x32_bf16 v[212:215], a[220:223], v[232:235], v[212:215]
    v_mfma_f32_16x16x32_bf16 v[216:219], a[216:219], v[236:239], v[216:219]
    v_mfma_f32_16x16x32_bf16 v[220:223], a[220:223], v[236:239], v[220:223]
    s_nop 6
    s_branch R_B_f
PH_43:
    v_swap_b32 v226, v228
    v_swap_b32 v227, v229
    v_swap_b32 v234, v236
    v_swap_b32 v235, v237
    v_mfma_f32_16x16x32_bf16 v[208:211], a[224:227], v[224:227], v[208:211]
    v_mfma_f32_16x16x32_bf16 v[212:215], a[228:231], v[224:227], v[212:215]
    v_mfma_f32_16x16x32_bf16 v[216:219], a[224:227], v[228:231], v[216:219]
    v_mfma_f32_16x16x32_bf16 v[220:223], a[228:231], v[228:231], v[220:223]
    v_mfma_f32_16x16x32_bf16 v[208:211], a[232:235], v[232:235], v[208:211]
    v_mfma_f32_16x16x32_bf16 v[212:215], a[236:239], v[232:235], v[212:215]
    v_mfma_f32_16x16x32_bf16 v[216:219], a[232:235], v[236:239], v[216:219]
    v_mfma_f32_16x16x32_bf16 v[220:223], a[236:239], v[236:239], v[220:223]
    s_nop 6
    s_branch R_B_f
PH_42:
    s_cmp_ge_u32 s64, 7
    s_cbranch_scc1 PH_44
    v_swap_b32 v226, v228
    v_swap_b32 v227, v229
    v_swap_b32 v234, v236
    v_swap_b32 v235, v237
    v_mfma_f32_16x16x32_bf16 v[208:211], a[240:243], v[224:227], v[208:211]
    v_mfma_f32_16x16x32_bf16 v[212:215], a[244:247], v[224:227], v[212:215]
    v_mfma_f32_16x16x32_bf16 v[216:219], a[240:243], v[228:231], v[216:219]
    v_mfma_f32_16x16x32_bf16 v[220:223], a[244:247], v[228:231], v[220:223]
    v_mfma_f32_16x16x32_bf16 v[208:211], a[248:251], v[232:235], v[208:211]
    v_mfma_f32_16x16x32_bf16 v[212:215], a[252:255], v[232:235], v[212:215]
    v_mfma_f32_16x16x32_bf16 v[216:219], a[248:251], v[236:239], v[216:219]
    v_mfma_f32_16x16x32_bf16 v[220:223], a[252:255], v[236:239], v[220:223]
    s_nop 4
    ds_write_b128 v168, v[208:211] offset:0
    ds_write_b128 v168, v[212:215] offset:1024
    ds_write_b128 v168, v[216:219] offset:2048
    ds_write_b128 v168, v[220:223] offset:3072
    s_branch R_B_f
PH_44:
    ds_read_b128 v[32:35], v169 offset:0
    ds_read_b128 v[36:39], v169 offset:4096
    ds_read_b128 v[40:43], v169 offset:8192
    ds_read_b128 v[44:47], v169 offset:12288
    v_pk_add_f32 v[72:73], v[72:73], v[76:77]
    v_pk_add_f32 v[74:75], v[74:75], v[78:79]
    s_waitcnt lgkmcnt(0)
    v_pk_add_f32 v[32:33], v[32:33], v[40:41]
    v_pk_add_f32 v[34:35], v[34:35], v[42:43]
    v_pk_add_f32 v[36:37], v[36:37], v[44:45]
    v_pk_add_f32 v[38:39], v[38:39], v[46:47]
    v_pk_add_f32 v[32:33], v[32:33], v[36:37]
    v_pk_add_f32 v[34:35], v[34:35], v[38:39]
    v_cvt_pk_bf16_f32 v11, v32, v33
    v_lshlrev_b32 v32, 16, v11
    v_and_b32 v33, 0xffff0000, v11
    v_pk_add_f32 v[32:33], v[32:33], v[172:173]
    v_cvt_pk_bf16_f32 v11, v32, v33
    v_lshlrev_b32 v32, 16, v11
    v_and_b32 v33, 0xffff0000, v11
    v_mul_f32 v11, 0xbfb8aa3b, v32
    v_mul_f32 v12, 0xbfb8aa3b, v33
    v_exp_f32 v11, v11
    v_exp_f32 v12, v12
    v_add_f32 v11, 1.0, v11
    v_add_f32 v12, 1.0, v12
    v_rcp_f32 v11, v11
    v_rcp_f32 v12, v12
    v_mul_f32 v32, v32, v11
    v_mul_f32 v33, v33, v12
    v_cvt_pk_bf16_f32 v11, v32, v33
    v_lshlrev_b32 v32, 16, v11
    v_and_b32 v33, 0xffff0000, v11
    v_cvt_pk_bf16_f32 v11, v72, v73
    v_lshlrev_b32 v72, 16, v11
    v_and_b32 v73, 0xffff0000, v11
    v_pk_mul_f32 v[72:73], v[72:73], v[32:33]
    v_cvt_pk_bf16_f32 v11, v72, v73
    v_lshlrev_b32 v72, 16, v11
    v_and_b32 v73, 0xffff0000, v11
    v_lshlrev_b32 v11, 16, v104
    v_and_b32 v12, 0xffff0000, v104
    v_add_f32 v72, v72, v11
    v_add_f32 v73, v73, v12
    v_cvt_pk_bf16_f32 v106, v72, v73
    v_cvt_pk_bf16_f32 v11, v34, v35
    v_lshlrev_b32 v34, 16, v11
    v_and_b32 v35, 0xffff0000, v11
    v_pk_add_f32 v[34:35], v[34:35], v[174:175]
    v_cvt_pk_bf16_f32 v11, v34, v35
    v_lshlrev_b32 v34, 16, v11
    v_and_b32 v35, 0xffff0000, v11
    v_mul_f32 v11, 0xbfb8aa3b, v34
    v_mul_f32 v12, 0xbfb8aa3b, v35
    v_exp_f32 v11, v11
    v_exp_f32 v12, v12
    v_add_f32 v11, 1.0, v11
    v_add_f32 v12, 1.0, v12
    v_rcp_f32 v11, v11
    v_rcp_f32 v12, v12
    v_mul_f32 v34, v34, v11
    v_mul_f32 v35, v35, v12
    v_cvt_pk_bf16_f32 v11, v34, v35
    v_lshlrev_b32 v34, 16, v11
    v_and_b32 v35, 0xffff0000, v11
    v_cvt_pk_bf16_f32 v11, v74, v75
    v_lshlrev_b32 v74, 16, v11
    v_and_b32 v75, 0xffff0000, v11
    v_pk_mul_f32 v[74:75], v[74:75], v[34:35]
    v_cvt_pk_bf16_f32 v11, v74, v75
    v_lshlrev_b32 v74, 16, v11
    v_and_b32 v75, 0xffff0000, v11
    v_lshlrev_b32 v11, 16, v105
    v_and_b32 v12, 0xffff0000, v105
    v_add_f32 v74, v74, v11
    v_add_f32 v75, v75, v12
    v_cvt_pk_bf16_f32 v107, v74, v75
    buffer_store_dwordx2 v[106:107], v170, s[36:39], s83 offen
    s_add_u32 s83, s83, 327680
    s_add_u32 s82, s82, 655360
    s_add_u32 s81, s81, 786432
R_B_f:
R_J_f:
    s_waitcnt vmcnt(0)
    buffer_load_dwordx4 v[16:19], v6, s[4:7], s66 offen offset:0 sc1
    buffer_load_dwordx4 v[20:23], v7, s[4:7], s66 offen offset:0 sc1
    buffer_load_dwordx4 v[24:27], v8, s[4:7], s66 offen offset:0 sc1
    s_mov_b64 exec, s[54:55]
    buffer_load_dwordx4 v[224:227], v5, s[4:7], s99 offen offset:0
    buffer_load_dwordx4 v[228:231], v5, s[4:7], s99 offen offset:1024
    buffer_load_dwordx4 v[232:235], v5, s[4:7], s99 offen offset:2048
    buffer_load_dwordx4 v[236:239], v5, s[4:7], s99 offen offset:3072
    s_mov_b64 exec, s[56:57]
    buffer_load_dwordx4 v[80:83], v5, s[4:7], s44 offen
    s_add_u32 s44, s44, 5242880
    buffer_load_dwordx4 v[84:87], v5, s[4:7], s44 offen
    s_mov_b64 exec, -1
    s_branch R_loop_f
R_E0_s:
    s_mov_b32 s64, s80
    s_mov_b32 s66, s71
    s_add_u32 s43, s43, 1
    s_mov_b32 s51, s79
    s_mov_b32 s79, s77
    s_mov_b32 s77, s78
    s_mov_b32 s78, s51
    s_add_u32 s84, s43, 3
    s_and_b32 s84, s84, 3
    s_add_u32 s85, s43, 4
    s_and_b32 s85, s85, 3
    s_add_u32 s86, s43, 5
    s_and_b32 s86, s86, 3
    s_add_u32 s87, s43, 6
    s_and_b32 s87, s87, 3
    s_mul_i32 s67, s84, 122880
    s_add_u32 s67, s67, s61
    s_mul_i32 s68, s84, 327680
    s_add_u32 s68, s68, s62
    s_mul_i32 s69, s86, 327680
    s_add_u32 s69, s69, s62
    s_mul_i32 s70, s84, 327680
    s_add_u32 s70, s70, s63
    s_mul_i32 s71, s85, 81920
    s_add_u32 s71, s71, s60
    s_mul_i32 s73, s87, 81920
    s_add_u32 s73, s73, s65
    s_sub_u32 s51, s43, s40
    s_sub_u32 s51, s51, 2
    s_and_b32 s80, s51, 7
    s_cmp_lt_u32 s51, 56
    s_cselect_b32 s80, s80, 8
    s_sub_u32 s51, s80, 1
    s_cmp_lt_u32 s51, 6
    s_cselect_b64 s[54:55], -1, 0
    s_and_b32 s51, s51, 7
    s_lshl_b32 s51, s51, 12
    s_add_u32 s99, s81, s51
    s_sub_u32 s51, s80, 4
    s_cmp_lt_u32 s51, 4
    s_cselect_b64 s[56:57], -1, 0
    s_cmp_eq_u32 s51, 0
    s_cselect_b64 s[58:59], -1, 0
    s_and_b32 s51, s51, 3
    s_mul_i32 s51, s51, 10485760
    s_add_u32 s44, s82, s51
    s_mul_i32 s51, s42, 3072
    s_add_u32 s72, s51, s78
    s_add_u32 s52, s51, s77
    v_add_u32 v161, s52, v167
    v_add_u32 v162, s79, v5
    v_add_u32 v163, s79, v167
    v_add_f32 v72, v72, v80
    v_cndmask_b32 v72, v72, 0, s[58:59]
    v_add_f32 v73, v73, v81
    v_cndmask_b32 v73, v73, 0, s[58:59]
    v_add_f32 v74, v74, v82
    v_cndmask_b32 v74, v74, 0, s[58:59]
    v_add_f32 v75, v75, v83
    v_cndmask_b32 v75, v75, 0, s[58:59]
    v_add_f32 v76, v76, v84
    v_cndmask_b32 v76, v76, 0, s[58:59]
    v_add_f32 v77, v77, v85
    v_cndmask_b32 v77, v77, 0, s[58:59]
    v_add_f32 v78, v78, v86
    v_cndmask_b32 v78, v78, 0, s[58:59]
    v_add_f32 v79, v79, v87
    v_cndmask_b32 v79, v79, 0, s[58:59]
    v_mov_b32 v16, -1
    v_mov_b32 v17, -1
    v_mov_b32 v18, -1
    v_mov_b32 v19, -1
    v_mov_b32 v20, -1
    v_mov_b32 v21, -1
    v_mov_b32 v22, -1
    v_mov_b32 v23, -1
    v_mov_b32 v24, -1
    v_mov_b32 v25, -1
    v_mov_b32 v26, -1
    v_mov_b32 v27, -1
    v_mov_b32 v196, -1
    v_mov_b32 v197, -1
    v_mov_b32 v198, -1
    v_mov_b32 v199, -1
    v_mov_b32 v200, -1
    v_mov_b32 v201, -1
    v_mov_b32 v202, -1
    v_mov_b32 v203, -1
    v_mov_b32 v204, -1
    v_mov_b32 v205, -1
    v_mov_b32 v206, -1
    v_mov_b32 v207, -1
    v_mov_b32 v108, -1
    v_mov_b32 v109, -1
    v_mov_b32 v110, -1
    v_mov_b32 v128, 0
    v_mov_b32 v129, 0
    v_mov_b32 v130, 0
    v_mov_b32 v131, 0
    v_mov_b32 v132, 0
    v_mov_b32 v133, 0
    v_mov_b32 v134, 0
    v_mov_b32 v135, 0
    v_add_u32 v160, s72, v5
    s_nop 0
    s_branch R_J_s
R_loop_s:
    s_mov_b32 s47, 0
D_45:
    v_max3_u32 v11, v16, v17, v18
    v_max3_u32 v11, v11, v19, v20
    v_max3_u32 v11, v11, v21, v22
    v_max3_u32 v11, v11, v23, v24
    v_max3_u32 v11, v11, v25, v26
    v_max_u32 v11, v11, v27
    v_cmp_eq_u32 vcc, -1, v11
    s_cbranch_vccz Do_46
    v_max3_u32 v11, v16, v17, v18
    v_max3_u32 v11, v11, v19, v20
    v_max3_u32 v11, v11, v21, v22
    v_max3_u32 v11, v11, v23, v24
    v_max3_u32 v11, v11, v25, v26
    v_max_u32 v11, v11, v27
    v_cmp_eq_u32 vcc, -1, v11
    s_cbranch_vccz Do_46
    v_max3_u32 v11, v16, v17, v18
    v_max3_u32 v11, v11, v19, v20
    v_max3_u32 v11, v11, v21, v22
    v_max3_u32 v11, v11, v23, v24
    v_max3_u32 v11, v11, v25, v26
    v_max_u32 v11, v11, v27
    v_cmp_eq_u32 vcc, -1, v11
    s_cbranch_vccz Do_46
    s_add_u32 s47, s47, 1
    s_cmp_gt_u32 s47, s46
    v_max3_u32 v12, v16, v17, v18
    v_max_u32 v12, v12, v19
    v_max3_u32 v13, v20, v21, v22
    v_max_u32 v13, v13, v23
    v_max3_u32 v14, v24, v25, v26
    v_max_u32 v14, v14, v27
    v_cmp_eq_u32 vcc, -1, v12
    v_cmp_eq_u32 s[92:93], -1, v13
    v_cmp_eq_u32 s[94:95], -1, v14
    s_mov_b64 exec, vcc
    buffer_load_dwordx4 v[16:19], v6, s[4:7], s66 offen offset:0 sc1
    s_mov_b64 exec, s[92:93]
    buffer_load_dwordx4 v[20:23], v7, s[4:7], s66 offen offset:0 sc1
    s_mov_b64 exec, s[94:95]
    buffer_load_dwordx4 v[24:27], v8, s[4:7], s66 offen offset:0 sc1
    s_mov_b64 exec, -1
    s_cbranch_scc0 D_45
    s_mov_b32 s46, 0
Do_46:
    ds_write_b128 v150, v[16:19]
    ds_write_b128 v151, v[20:23]
    ds_write_b128 v152, v[24:27]
    s_waitcnt lgkmcnt(0)
    s_barrier
    ds_read_b128 v[32:35], v9 offset:0
    ds_read_b128 v[36:39], v9 offset:1024
    ds_read_b128 v[40:43], v9 offset:2048
    ds_read_b128 v[44:47], v9 offset:3072
    ds_read_b128 v[48:51], v9 offset:4096
    ds_read_b128 v[52:55], v9 offset:5120
    ds_read_b128 v[56:59], v9 offset:6144
    ds_read_b128 v[60:63], v9 offset:7168
    ds_read_b128 v[64:67], v9 offset:8192
    ds_read_b128 v[68:71], v9 offset:9216
    s_waitcnt lgkmcnt(9)
    v_smfmac_f32_16x16x64_bf16 v[128:131], v[32:35], a[0:7], v30
    v_smfmac_f32_16x16x64_bf16 v[132:135], v[32:35], a[80:87], v30
    s_add_u32 m0, s75, 0
    s_add_u32 s49, s74, 0
    buffer_load_dwordx4 v5, s[4:7], s49 offen offset:0 lds
    s_waitcnt lgkmcnt(8)
    v_smfmac_f32_16x16x64_bf16 v[128:131], v[36:39], a[8:15], v30
    v_smfmac_f32_16x16x64_bf16 v[132:135], v[36:39], a[88:95], v30
    s_waitcnt lgkmcnt(7)
    v_smfmac_f32_16x16x64_bf16 v[128:131], v[40:43], a[16:23], v30
    v_smfmac_f32_16x16x64_bf16 v[132:135], v[40:43], a[96:103], v30
    s_waitcnt lgkmcnt(6)
    v_smfmac_f32_16x16x64_bf16 v[128:131], v[44:47], a[24:31], v30
    v_smfmac_f32_16x16x64_bf16 v[132:135], v[44:47], a[104:111], v30
    buffer_load_dwordx4 v5, s[4:7], s49 offen offset:1024 lds
    s_waitcnt lgkmcnt(5)
    v_smfmac_f32_16x16x64_bf16 v[128:131], v[48:51], a[32:39], v30
    v_smfmac_f32_16x16x64_bf16 v[132:135], v[48:51], a[112:119], v30
    s_waitcnt lgkmcnt(4)
    v_smfmac_f32_16x16x64_bf16 v[128:131], v[52:55], a[40:47], v30
    v_smfmac_f32_16x16x64_bf16 v[132:135], v[52:55], a[120:127], v30
    s_waitcnt lgkmcnt(3)
    v_smfmac_f32_16x16x64_bf16 v[128:131], v[56:59], a[48:55], v30
    v_smfmac_f32_16x16x64_bf16 v[132:135], v[56:59], a[128:135], v30
    buffer_load_dwordx4 v5, s[4:7], s49 offen offset:2048 lds
    s_waitcnt lgkmcnt(2)
    v_smfmac_f32_16x16x64_bf16 v[128:131], v[60:63], a[56:63], v30
    v_smfmac_f32_16x16x64_bf16 v[132:135], v[60:63], a[136:143], v30
    s_waitcnt lgkmcnt(1)
    v_smfmac_f32_16x16x64_bf16 v[128:131], v[64:67], a[64:71], v30
    v_smfmac_f32_16x16x64_bf16 v[132:135], v[64:67], a[144:151], v30
    s_waitcnt lgkmcnt(0)
    v_smfmac_f32_16x16x64_bf16 v[128:131], v[68:71], a[72:79], v30
    v_smfmac_f32_16x16x64_bf16 v[132:135], v[68:71], a[152:159], v30
    buffer_load_dwordx4 v5, s[4:7], s49 offen offset:3072 lds
    s_nop 5
    v_cvt_pk_bf16_f32 v136, v128, v129
    v_cvt_pk_bf16_f32 v137, v130, v131
    v_cvt_pk_bf16_f32 v138, v132, v133
    v_cvt_pk_bf16_f32 v139, v134, v135
    ds_write_b64 v161, v[136:137] offset:2048
    ds_write_b64 v161, v[138:139] offset:2560
    s_cmp_eq_u32 s43, 64
    s_cbranch_scc1 R_last
    ds_read_b128 v[32:35], v10 offset:0
    ds_read_b128 v[36:39], v10 offset:1024
    ds_read_b128 v[40:43], v10 offset:2048
    ds_read_b128 v[44:47], v10 offset:3072
    ds_read_b128 v[48:51], v10 offset:4096
    ds_read_b128 v[52:55], v10 offset:5120
    ds_read_b128 v[56:59], v10 offset:6144
    ds_read_b128 v[60:63], v10 offset:7168
    ds_read_b128 v[64:67], v10 offset:8192
    s_waitcnt lgkmcnt(8)
    v_mfma_f32_16x16x32_bf16 v[112:115], v[32:35], a[0:3], 0
    v_mfma_f32_16x16x32_bf16 v[116:119], v[32:35], a[80:83], 0
    s_mov_b64 exec, s[2:3]
    buffer_load_dwordx4 v[176:179], v5, s[4:7], s73 offen offset:0 sc1
    s_mov_b64 exec, -1
    ds_read_b128 v[68:71], v10 offset:9216
    s_waitcnt lgkmcnt(8)
    v_mfma_f32_16x16x32_bf16 v[112:115], v[36:39], a[4:7], v[112:115]
    v_mfma_f32_16x16x32_bf16 v[116:119], v[36:39], a[84:87], v[116:119]
    ds_read_b128 v[32:35], v10 offset:10240
    s_waitcnt lgkmcnt(8)
    v_mfma_f32_16x16x32_bf16 v[112:115], v[40:43], a[8:11], v[112:115]
    v_mfma_f32_16x16x32_bf16 v[116:119], v[40:43], a[88:91], v[116:119]
    s_mov_b64 exec, s[2:3]
    buffer_load_dwordx4 v[180:183], v5, s[4:7], s73 offen offset:1024 sc1
    s_mov_b64 exec, -1
    s_waitcnt lgkmcnt(7)
    v_mfma_f32_16x16x32_bf16 v[112:115], v[44:47], a[12:15], v[112:115]
    v_mfma_f32_16x16x32_bf16 v[116:119], v[44:47], a[92:95], v[116:119]
    s_add_u32 m0, s75, 4096
    s_add_u32 s49, s74, 4096
    buffer_load_dwordx4 v5, s[4:7], s49 offen offset:0 lds
    s_waitcnt lgkmcnt(6)
    v_mfma_f32_16x16x32_bf16 v[112:115], v[48:51], a[16:19], v[112:115]
    v_mfma_f32_16x16x32_bf16 v[116:119], v[48:51], a[96:99], v[116:119]
    s_mov_b64 exec, s[2:3]
    buffer_load_dwordx4 v[184:187], v5, s[4:7], s73 offen offset:2048 sc1
    s_mov_b64 exec, -1
    s_waitcnt lgkmcnt(5)
    v_mfma_f32_16x16x32_bf16 v[112:115], v[52:55], a[20:23], v[112:115]
    v_mfma_f32_16x16x32_bf16 v[116:119], v[52:55], a[100:103], v[116:119]
    s_waitcnt lgkmcnt(4)
    v_mfma_f32_16x16x32_bf16 v[112:115], v[56:59], a[24:27], v[112:115]
    v_mfma_f32_16x16x32_bf16 v[116:119], v[56:59], a[104:107], v[116:119]
    s_mov_b64 exec, s[2:3]
    buffer_load_dwordx4 v[188:191], v5, s[4:7], s73 offen offset:3072 sc1
    s_mov_b64 exec, -1
    s_waitcnt lgkmcnt(3)
    v_mfma_f32_16x16x32_bf16 v[112:115], v[60:63], a[28:31], v[112:115]
    v_mfma_f32_16x16x32_bf16 v[116:119], v[60:63], a[108:111], v[116:119]
    s_waitcnt lgkmcnt(2)
    v_mfma_f32_16x16x32_bf16 v[112:115], v[64:67], a[32:35], v[112:115]
    v_mfma_f32_16x16x32_bf16 v[116:119], v[64:67], a[112:115], v[116:119]
    s_mov_b64 exec, s[2:3]
    buffer_load_dwordx4 v[192:195], v159, s[4:7], s73 offen offset:0 sc1
    s_mov_b64 exec, -1
    buffer_load_dwordx4 v[196:199], v5, s[4:7], s67 offen offset:0 sc1
    buffer_load_dwordx4 v[200:203], v5, s[4:7], s67 offen offset:1280 sc1
    buffer_load_dwordx4 v[204:207], v5, s[4:7], s67 offen offset:2560 sc1
    buffer_load_dword v108, v31, s[4:7], s67 offen offset:1024 sc1
    buffer_load_dword v109, v31, s[4:7], s67 offen offset:2304 sc1
    buffer_load_dword v110, v31, s[4:7], s67 offen offset:3584 sc1
    s_waitcnt lgkmcnt(1)
    v_mfma_f32_16x16x32_bf16 v[112:115], v[68:71], a[36:39], v[112:115]
    v_mfma_f32_16x16x32_bf16 v[116:119], v[68:71], a[116:119], v[116:119]
    s_waitcnt lgkmcnt(0)
    v_mfma_f32_16x16x32_bf16 v[112:115], v[32:35], a[40:43], v[112:115]
    v_mfma_f32_16x16x32_bf16 v[116:119], v[32:35], a[120:123], v[116:119]
    s_mov_b32 s47, 0
D_48:
    s_waitcnt vmcnt(0)
    v_max3_u32 v11, v196, v197, v198
    v_max3_u32 v11, v11, v199, v200
    v_max3_u32 v11, v11, v201, v202
    v_max3_u32 v11, v11, v203, v204
    v_max3_u32 v11, v11, v205, v206
    v_max3_u32 v11, v11, v207, v108
    v_max3_u32 v11, v11, v109, v110
    v_cmp_eq_u32 vcc, -1, v11
    s_cbranch_vccz Do_49
    s_add_u32 s47, s47, 1
    s_cmp_gt_u32 s47, s46
    v_max3_u32 v12, v196, v197, v198
    v_max_u32 v12, v12, v199
    v_max3_u32 v13, v200, v201, v202
    v_max_u32 v13, v13, v203
    v_max3_u32 v14, v204, v205, v206
    v_max_u32 v14, v14, v207
    v_cmp_eq_u32 vcc, -1, v12
    v_cmp_eq_u32 s[92:93], -1, v13
    v_cmp_eq_u32 s[94:95], -1, v14
    v_cmp_eq_u32 s[100:101], -1, v108
    s_mov_b64 exec, vcc
    buffer_load_dwordx4 v[196:199], v5, s[4:7], s67 offen offset:0 sc1
    s_mov_b64 exec, s[92:93]
    buffer_load_dwordx4 v[200:203], v5, s[4:7], s67 offen offset:1280 sc1
    s_mov_b64 exec, s[94:95]
    buffer_load_dwordx4 v[204:207], v5, s[4:7], s67 offen offset:2560 sc1
    s_mov_b64 exec, s[100:101]
    buffer_load_dword v108, v31, s[4:7], s67 offen offset:1024 sc1
    s_mov_b64 exec, -1
    v_cmp_eq_u32 vcc, -1, v109
    v_cmp_eq_u32 s[92:93], -1, v110
    s_mov_b64 exec, vcc
    buffer_load_dword v109, v31, s[4:7], s67 offen offset:2304 sc1
    s_mov_b64 exec, s[92:93]
    buffer_load_dword v110, v31, s[4:7], s67 offen offset:3584 sc1
    s_mov_b64 exec, -1
    s_cbranch_scc0 D_48
    s_mov_b32 s46, 0
Do_49:
    v_pk_add_f32 v[32:33], v[196:197], v[200:201]
    v_pk_add_f32 v[34:35], v[198:199], v[202:203]
    v_add_f32 v44, v108, v109
    v_pk_add_f32 v[32:33], v[32:33], v[204:205]
    v_pk_add_f32 v[34:35], v[34:35], v[206:207]
    v_add_f32 v44, v44, v110
    v_max3_f32 v12, v32, v33, v34
    v_max3_f32 v12, v12, v35, v44
    s_nop 1
    v_max_f32_dpp v12, v12, v12 row_ror:8 row_mask:0xf bank_mask:0xf
    v_mov_b32 v11, v12
    s_nop 1
    v_permlane16_swap_b32 v12, v11
    v_max_f32 v12, v12, v11
    v_mov_b32 v11, v12
    s_nop 1
    v_permlane32_swap_b32 v12, v11
    v_max_f32 v12, v12, v11
    v_mul_f32 v12, 0xbdd53b95, v12
    v_pk_fma_f32 v[32:33], v[32:33], s[88:89], v[12:13] op_sel_hi:[1,1,0]
    v_pk_fma_f32 v[34:35], v[34:35], s[88:89], v[12:13] op_sel_hi:[1,1,0]
    v_fma_f32 v44, v44, s88, v12
    v_exp_f32 v32, v32
    v_exp_f32 v33, v33
    v_exp_f32 v34, v34
    v_exp_f32 v35, v35
    v_exp_f32 v44, v44
    v_cvt_pk_bf16_f32 v42, v32, v33
    v_cvt_pk_bf16_f32 v43, v34, v35
    v_cvt_pk_bf16_f32 v45, v44, v44
    v_and_b32 v36, v42, v164
    v_and_b32 v37, v43, v164
    v_and_b32 v38, v42, v165
    v_and_b32 v39, v43, v165
    v_and_b32 v40, v45, v166
    v_and_b32 v41, v45, v166
    v_mfma_f32_16x16x32_bf16 v[128:131], v[140:143], v[36:39], 0
    v_add_f32 v12, v32, v44
    v_add_f32 v33, v33, v34
    v_mfma_f32_16x16x32_bf16 v[132:135], v[144:147], v[36:39], 0
    v_add_f32 v12, v12, v35
    v_add_f32 v12, v12, v33
    v_mfma_f32_16x16x16_bf16 v[128:131], v[136:137], v[40:41], v[128:131]
    s_nop 0
    v_add_f32_dpp v12, v12, v12 row_ror:8 row_mask:0xf bank_mask:0xf
    v_mov_b32 v11, v12
    v_mfma_f32_16x16x16_bf16 v[132:135], v[138:139], v[40:41], v[132:135]
    s_nop 0
    v_permlane16_swap_b32 v12, v11
    v_add_f32 v12, v12, v11
    v_mov_b32 v11, v12
    s_nop 1
    v_permlane32_swap_b32 v12, v11
    v_add_f32 v12, v12, v11
    v_rcp_f32 v12, v12
    s_nop 0
    v_pk_mul_f32 v[128:129], v[128:129], v[12:13] op_sel_hi:[1,0]
    v_pk_mul_f32 v[130:131], v[130:131], v[12:13] op_sel_hi:[1,0]
    ds_write_b128 v153, v[128:131]
    v_pk_mul_f32 v[132:133], v[132:133], v[12:13] op_sel_hi:[1,0]
    v_pk_mul_f32 v[134:135], v[134:135], v[12:13] op_sel_hi:[1,0]
    ds_write_b128 v153, v[132:135] offset:1024
    s_waitcnt lgkmcnt(0)
    s_barrier
    s_cmp_lt_u32 s42, 2
    s_cbranch_scc1 R_E_s
    ds_read_b128 v[32:35], v154 offset:0
    ds_read_b128 v[36:39], v171 offset:0
    ds_read_b128 v[40:43], v154 offset:2048
    ds_read_b128 v[44:47], v171 offset:2048
    ds_read_b128 v[48:51], v154 offset:4096
    ds_read_b128 v[52:55], v171 offset:4096
    ds_read_b128 v[56:59], v154 offset:6144
    ds_read_b128 v[60:63], v171 offset:6144
    s_waitcnt lgkmcnt(6)
    v_pk_add_f32 v[32:33], v[32:33], v[36:37]
    v_pk_add_f32 v[34:35], v[34:35], v[38:39]
    s_waitcnt lgkmcnt(4)
    v_pk_add_f32 v[40:41], v[40:41], v[44:45]
    v_pk_add_f32 v[42:43], v[42:43], v[46:47]
    v_pk_add_f32 v[32:33], v[32:33], v[40:41]
    v_pk_add_f32 v[34:35], v[34:35], v[42:43]
    s_waitcnt lgkmcnt(2)
    v_pk_add_f32 v[48:49], v[48:49], v[52:53]
    v_pk_add_f32 v[50:51], v[50:51], v[54:55]
    v_pk_add_f32 v[32:33], v[32:33], v[48:49]
    v_pk_add_f32 v[34:35], v[34:35], v[50:51]
    s_waitcnt lgkmcnt(0)
    v_pk_add_f32 v[56:57], v[56:57], v[60:61]
    v_pk_add_f32 v[58:59], v[58:59], v[62:63]
    v_pk_add_f32 v[32:33], v[32:33], v[56:57]
    v_pk_add_f32 v[34:35], v[34:35], v[58:59]
    v_cvt_pk_bf16_f32 v88, v32, v33
    v_cvt_pk_bf16_f32 v89, v34, v35
    v_min_u32 v88, -2, v88
    v_min_u32 v89, -2, v89
    buffer_store_dwordx2 v[88:89], v158, s[4:7], s68 offen offset:0 sc1
    buffer_store_dwordx2 v[244:245], v158, s[4:7], s69 offen offset:0 sc1
    s_branch R_U2_s
R_E_s:
    s_cmp_lt_u32 s43, 2
    s_cbranch_scc1 R_U2_s
    ds_read_b128 v[32:35], v162 offset:0
    ds_read_b128 v[36:39], v162 offset:1024
    ds_read_b128 v[40:43], v162 offset:3072
    ds_read_b128 v[44:47], v162 offset:4096
    ds_read_b128 v[48:51], v162 offset:6144
    ds_read_b128 v[52:55], v162 offset:7168
    ds_read_b128 v[56:59], v162 offset:9216
    ds_read_b128 v[60:63], v162 offset:10240
    ds_read_b64 v[64:65], v163 offset:2048
    ds_read_b64 v[66:67], v163 offset:2560
    ds_read_b64 v[68:69], v163 offset:5120
    ds_read_b64 v[70:71], v163 offset:5632
    ds_read_b64 v[16:17], v163 offset:8192
    ds_read_b64 v[18:19], v163 offset:8704
    ds_read_b64 v[20:21], v163 offset:11264
    ds_read_b64 v[22:23], v163 offset:11776
    s_mov_b32 s47, 0
    s_branch Pw_52
P_51:
    buffer_load_dwordx4 v[176:179], v5, s[4:7], s73 offen offset:0 sc1
    buffer_load_dwordx4 v[180:183], v5, s[4:7], s73 offen offset:1024 sc1
    buffer_load_dwordx4 v[184:187], v5, s[4:7], s73 offen offset:2048 sc1
    buffer_load_dwordx4 v[188:191], v5, s[4:7], s73 offen offset:3072 sc1
    buffer_load_dwordx4 v[192:195], v159, s[4:7], s73 offen offset:0 sc1
Pw_52:
    s_add_u32 s47, s47, 1
    s_cmp_gt_u32 s47, s46
    s_waitcnt vmcnt(0)
    v_max3_u32 v11, v176, v177, v178
    v_max3_u32 v11, v11, v179, v180
    v_max3_u32 v11, v11, v181, v182
    v_max3_u32 v11, v11, v183, v184
    v_max3_u32 v11, v11, v185, v186
    v_max3_u32 v11, v11, v187, v188
    v_max3_u32 v11, v11, v189, v190
    v_max3_u32 v11, v11, v191, v192
    v_max3_u32 v11, v11, v193, v194
    v_max_u32 v11, v11, v195
    v_cmp_eq_u32 vcc, -1, v11
    s_cbranch_vccz Po_53
    s_cbranch_scc0 P_51
    s_mov_b32 s46, 0
Po_53:
    v_mov_b32 v88, v192
    v_mov_b32 v89, v192
    v_mov_b32 v90, v193
    v_mov_b32 v91, v193
    v_mov_b32 v92, v194
    v_mov_b32 v93, v194
    v_mov_b32 v94, v195
    v_mov_b32 v95, v195
    s_waitcnt lgkmcnt(0)
    v_mfma_f32_16x16x32_bf16 v[128:131], v[32:35], v[176:179], 0
    v_mfma_f32_16x16x32_bf16 v[132:135], v[36:39], v[176:179], 0
    v_mfma_f32_16x16x32_bf16 v[128:131], v[40:43], v[180:183], v[128:131]
    v_mfma_f32_16x16x32_bf16 v[132:135], v[44:47], v[180:183], v[132:135]
    v_mfma_f32_16x16x32_bf16 v[128:131], v[48:51], v[184:187], v[128:131]
    v_mfma_f32_16x16x32_bf16 v[132:135], v[52:55], v[184:187], v[132:135]
    v_mfma_f32_16x16x32_bf16 v[128:131], v[56:59], v[188:191], v[128:131]
    v_mfma_f32_16x16x32_bf16 v[132:135], v[60:63], v[188:191], v[132:135]
    v_mfma_f32_16x16x16_bf16 v[128:131], v[64:65], v[88:89], v[128:131]
    v_mfma_f32_16x16x16_bf16 v[132:135], v[66:67], v[88:89], v[132:135]
    v_mfma_f32_16x16x16_bf16 v[128:131], v[68:69], v[90:91], v[128:131]
    v_mfma_f32_16x16x16_bf16 v[132:135], v[70:71], v[90:91], v[132:135]
    v_mfma_f32_16x16x16_bf16 v[128:131], v[16:17], v[92:93], v[128:131]
    v_mfma_f32_16x16x16_bf16 v[132:135], v[18:19], v[92:93], v[132:135]
    v_mfma_f32_16x16x16_bf16 v[128:131], v[20:21], v[94:95], v[128:131]
    v_mfma_f32_16x16x16_bf16 v[132:135], v[22:23], v[94:95], v[132:135]
    s_nop 6
    buffer_store_dwordx4 v[128:131], v5, s[4:7], s76 offen offset:0 sc1
    buffer_store_dwordx4 v[132:135], v5, s[4:7], s76 offen offset:1024 sc1
    s_add_u32 s76, s76, 81920
R_U2_s:
    s_cmp_eq_u32 s80, 6
    s_cselect_b64 exec, -1, 0
    buffer_load_dwordx2 v[104:105], v170, s[28:31], s83 offen
    s_mov_b64 exec, -1
    ds_read_b128 v[32:35], v10 offset:11264
    ds_read_b128 v[36:39], v10 offset:12288
    ds_read_b128 v[40:43], v10 offset:13312
    ds_read_b128 v[44:47], v10 offset:14336
    ds_read_b128 v[48:51], v10 offset:15360
    ds_read_b128 v[52:55], v10 offset:16384
    ds_read_b128 v[56:59], v10 offset:17408
    ds_read_b128 v[60:63], v10 offset:18432
    ds_read_b128 v[64:67], v10 offset:19456
    s_waitcnt lgkmcnt(8)
    v_mfma_f32_16x16x32_bf16 v[112:115], v[32:35], a[44:47], v[112:115]
    v_mfma_f32_16x16x32_bf16 v[116:119], v[32:35], a[124:127], v[116:119]
    ds_read_b128 v[68:71], v10 offset:20480
    s_waitcnt lgkmcnt(8)
    v_mfma_f32_16x16x32_bf16 v[112:115], v[36:39], a[48:51], v[112:115]
    v_mfma_f32_16x16x32_bf16 v[116:119], v[36:39], a[128:131], v[116:119]
    ds_read_b128 v[32:35], v10 offset:21504
    s_waitcnt lgkmcnt(8)
    v_mfma_f32_16x16x32_bf16 v[112:115], v[40:43], a[52:55], v[112:115]
    v_mfma_f32_16x16x32_bf16 v[116:119], v[40:43], a[132:135], v[116:119]
    ds_read_b128 v[36:39], v10 offset:22528
    s_waitcnt lgkmcnt(8)
    v_mfma_f32_16x16x32_bf16 v[112:115], v[44:47], a[56:59], v[112:115]
    v_mfma_f32_16x16x32_bf16 v[116:119], v[44:47], a[136:139], v[116:119]
    ds_read_b128 v[40:43], v10 offset:23552
    s_waitcnt lgkmcnt(8)
    v_mfma_f32_16x16x32_bf16 v[112:115], v[48:51], a[60:63], v[112:115]
    v_mfma_f32_16x16x32_bf16 v[116:119], v[48:51], a[140:143], v[116:119]
    ds_read_b128 v[44:47], v10 offset:24576
    s_waitcnt lgkmcnt(8)
    v_mfma_f32_16x16x32_bf16 v[112:115], v[52:55], a[64:67], v[112:115]
    v_mfma_f32_16x16x32_bf16 v[116:119], v[52:55], a[144:147], v[116:119]
    buffer_load_dwordx4 v5, s[4:7], s49 offen offset:1024 lds
    ds_read_b128 v[48:51], v10 offset:25600
    s_waitcnt lgkmcnt(8)
    v_mfma_f32_16x16x32_bf16 v[112:115], v[56:59], a[68:71], v[112:115]
    v_mfma_f32_16x16x32_bf16 v[116:119], v[56:59], a[148:151], v[116:119]
    ds_read_b128 v[52:55], v10 offset:26624
    s_waitcnt lgkmcnt(8)
    v_mfma_f32_16x16x32_bf16 v[112:115], v[60:63], a[72:75], v[112:115]
    v_mfma_f32_16x16x32_bf16 v[116:119], v[60:63], a[152:155], v[116:119]
    ds_read_b128 v[56:59], v10 offset:27648
    s_waitcnt lgkmcnt(8)
    v_mfma_f32_16x16x32_bf16 v[112:115], v[64:67], a[76:79], v[112:115]
    v_mfma_f32_16x16x32_bf16 v[116:119], v[64:67], a[156:159], v[116:119]
    ds_read_b128 v[60:63], v10 offset:28672
    s_waitcnt lgkmcnt(8)
    v_mfma_f32_16x16x32_bf16 v[120:123], v[68:71], a[0:3], 0
    v_mfma_f32_16x16x32_bf16 v[124:127], v[68:71], a[80:83], 0
    buffer_load_dwordx4 v5, s[4:7], s49 offen offset:2048 lds
    ds_read_b128 v[64:67], v10 offset:29696
    s_waitcnt lgkmcnt(8)
    v_mfma_f32_16x16x32_bf16 v[120:123], v[32:35], a[4:7], v[120:123]
    v_mfma_f32_16x16x32_bf16 v[124:127], v[32:35], a[84:87], v[124:127]
    ds_read_b128 v[68:71], v10 offset:30720
    s_waitcnt lgkmcnt(8)
    v_mfma_f32_16x16x32_bf16 v[120:123], v[36:39], a[8:11], v[120:123]
    v_mfma_f32_16x16x32_bf16 v[124:127], v[36:39], a[88:91], v[124:127]
    ds_read_b128 v[32:35], v10 offset:31744
    s_waitcnt lgkmcnt(8)
    v_mfma_f32_16x16x32_bf16 v[120:123], v[40:43], a[12:15], v[120:123]
    v_mfma_f32_16x16x32_bf16 v[124:127], v[40:43], a[92:95], v[124:127]
    ds_read_b128 v[36:39], v10 offset:32768
    s_waitcnt lgkmcnt(8)
    v_mfma_f32_16x16x32_bf16 v[120:123], v[44:47], a[16:19], v[120:123]
    v_mfma_f32_16x16x32_bf16 v[124:127], v[44:47], a[96:99], v[124:127]
    buffer_load_dwordx4 v5, s[4:7], s49 offen offset:3072 lds
    ds_read_b128 v[40:43], v10 offset:33792
    s_waitcnt lgkmcnt(8)
    v_mfma_f32_16x16x32_bf16 v[120:123], v[48:51], a[20:23], v[120:123]
    v_mfma_f32_16x16x32_bf16 v[124:127], v[48:51], a[100:103], v[124:127]
    ds_read_b128 v[44:47], v10 offset:34816
    s_waitcnt lgkmcnt(8)
    v_mfma_f32_16x16x32_bf16 v[120:123], v[52:55], a[24:27], v[120:123]
    v_mfma_f32_16x16x32_bf16 v[124:127], v[52:55], a[104:107], v[124:127]
    ds_read_b128 v[48:51], v10 offset:35840
    s_waitcnt lgkmcnt(8)
    v_mfma_f32_16x16x32_bf16 v[120:123], v[56:59], a[28:31], v[120:123]
    v_mfma_f32_16x16x32_bf16 v[124:127], v[56:59], a[108:111], v[124:127]
    ds_read_b128 v[52:55], v10 offset:36864
    s_waitcnt lgkmcnt(8)
    v_mfma_f32_16x16x32_bf16 v[120:123], v[60:63], a[32:35], v[120:123]
    v_mfma_f32_16x16x32_bf16 v[124:127], v[60:63], a[112:115], v[124:127]
    s_add_u32 m0, s75, 8192
    s_add_u32 s49, s74, 8192
    buffer_load_dwordx4 v5, s[4:7], s49 offen offset:0 lds
    ds_read_b128 v[56:59], v10 offset:37888
    s_waitcnt lgkmcnt(8)
    v_mfma_f32_16x16x32_bf16 v[120:123], v[64:67], a[36:39], v[120:123]
    v_mfma_f32_16x16x32_bf16 v[124:127], v[64:67], a[116:119], v[124:127]
    ds_read_b128 v[60:63], v10 offset:38912
    s_waitcnt lgkmcnt(8)
    v_mfma_f32_16x16x32_bf16 v[120:123], v[68:71], a[40:43], v[120:123]
    v_mfma_f32_16x16x32_bf16 v[124:127], v[68:71], a[120:123], v[124:127]
    ds_read_b128 v[64:67], v10 offset:39936
    s_waitcnt lgkmcnt(8)
    v_mfma_f32_16x16x32_bf16 v[120:123], v[32:35], a[44:47], v[120:123]
    v_mfma_f32_16x16x32_bf16 v[124:127], v[32:35], a[124:127], v[124:127]
    s_waitcnt lgkmcnt(7)
    v_mfma_f32_16x16x32_bf16 v[120:123], v[36:39], a[48:51], v[120:123]
    v_mfma_f32_16x16x32_bf16 v[124:127], v[36:39], a[128:131], v[124:127]
    buffer_load_dwordx4 v5, s[4:7], s49 offen offset:1024 lds
    s_add_u32 s74, s74, 40960
    s_mul_i32 s49, s42, 20480
    s_add_u32 s49, s49, 40960
    s_sub_u32 s75, s49, s75
    s_waitcnt lgkmcnt(6)
    v_mfma_f32_16x16x32_bf16 v[120:123], v[40:43], a[52:55], v[120:123]
    v_mfma_f32_16x16x32_bf16 v[124:127], v[40:43], a[132:135], v[124:127]
    s_waitcnt lgkmcnt(5)
    v_mfma_f32_16x16x32_bf16 v[120:123], v[44:47], a[56:59], v[120:123]
    v_mfma_f32_16x16x32_bf16 v[124:127], v[44:47], a[136:139], v[124:127]
    s_waitcnt lgkmcnt(4)
    v_mfma_f32_16x16x32_bf16 v[120:123], v[48:51], a[60:63], v[120:123]
    v_mfma_f32_16x16x32_bf16 v[124:127], v[48:51], a[140:143], v[124:127]
    s_waitcnt lgkmcnt(3)
    v_mfma_f32_16x16x32_bf16 v[120:123], v[52:55], a[64:67], v[120:123]
    v_mfma_f32_16x16x32_bf16 v[124:127], v[52:55], a[144:147], v[124:127]
    s_waitcnt lgkmcnt(2)
    v_mfma_f32_16x16x32_bf16 v[120:123], v[56:59], a[68:71], v[120:123]
    v_mfma_f32_16x16x32_bf16 v[124:127], v[56:59], a[148:151], v[124:127]
    s_waitcnt lgkmcnt(1)
    v_mfma_f32_16x16x32_bf16 v[120:123], v[60:63], a[72:75], v[120:123]
    v_mfma_f32_16x16x32_bf16 v[124:127], v[60:63], a[152:155], v[124:127]
    s_waitcnt lgkmcnt(0)
    v_mfma_f32_16x16x32_bf16 v[120:123], v[64:67], a[76:79], v[120:123]
    v_mfma_f32_16x16x32_bf16 v[124:127], v[64:67], a[156:159], v[124:127]
    s_mov_b32 s64, s80
    s_mov_b32 s66, s71
    s_add_u32 s43, s43, 1
    s_mov_b32 s51, s79
    s_mov_b32 s79, s77
    s_mov_b32 s77, s78
    s_mov_b32 s78, s51
    s_add_u32 s84, s43, 3
    s_and_b32 s84, s84, 3
    s_add_u32 s85, s43, 4
    s_and_b32 s85, s85, 3
    s_add_u32 s86, s43, 5
    s_and_b32 s86, s86, 3
    s_add_u32 s87, s43, 6
    s_and_b32 s87, s87, 3
    s_mul_i32 s67, s84, 122880
    s_add_u32 s67, s67, s61
    s_mul_i32 s68, s84, 327680
    s_add_u32 s68, s68, s62
    s_mul_i32 s69, s86, 327680
    s_add_u32 s69, s69, s62
    s_mul_i32 s70, s84, 327680
    s_add_u32 s70, s70, s63
    s_mul_i32 s71, s85, 81920
    s_add_u32 s71, s71, s60
    s_mul_i32 s73, s87, 81920
    s_add_u32 s73, s73, s65
    s_sub_u32 s51, s43, s40
    s_sub_u32 s51, s51, 2
    s_and_b32 s80, s51, 7
    s_cmp_lt_u32 s51, 56
    s_cselect_b32 s80, s80, 8
    s_sub_u32 s51, s80, 1
    s_cmp_lt_u32 s51, 6
    s_cselect_b64 s[54:55], -1, 0
    s_and_b32 s51, s51, 7
    s_lshl_b32 s51, s51, 12
    s_add_u32 s99, s81, s51
    s_sub_u32 s51, s80, 4
    s_cmp_lt_u32 s51, 4
    s_cselect_b64 s[56:57], -1, 0
    s_cmp_eq_u32 s51, 0
    s_cselect_b64 s[58:59], -1, 0
    s_and_b32 s51, s51, 3
    s_mul_i32 s51, s51, 10485760
    s_add_u32 s44, s82, s51
    s_mul_i32 s51, s42, 3072
    s_add_u32 s72, s51, s78
    s_add_u32 s52, s51, s77
    v_add_u32 v161, s52, v167
    v_add_u32 v162, s79, v5
    v_add_u32 v163, s79, v167
    v_add_f32 v72, v72, v80
    v_cndmask_b32 v72, v72, 0, s[58:59]
    v_add_f32 v73, v73, v81
    v_cndmask_b32 v73, v73, 0, s[58:59]
    v_add_f32 v74, v74, v82
    v_cndmask_b32 v74, v74, 0, s[58:59]
    v_add_f32 v75, v75, v83
    v_cndmask_b32 v75, v75, 0, s[58:59]
    v_add_f32 v76, v76, v84
    v_cndmask_b32 v76, v76, 0, s[58:59]
    v_add_f32 v77, v77, v85
    v_cndmask_b32 v77, v77, 0, s[58:59]
    v_add_f32 v78, v78, v86
    v_cndmask_b32 v78, v78, 0, s[58:59]
    v_add_f32 v79, v79, v87
    v_cndmask_b32 v79, v79, 0, s[58:59]
    v_mov_b32 v16, -1
    v_mov_b32 v17, -1
    v_mov_b32 v18, -1
    v_mov_b32 v19, -1
    v_mov_b32 v20, -1
    v_mov_b32 v21, -1
    v_mov_b32 v22, -1
    v_mov_b32 v23, -1
    v_mov_b32 v24, -1
    v_mov_b32 v25, -1
    v_mov_b32 v26, -1
    v_mov_b32 v27, -1
    v_mov_b32 v196, -1
    v_mov_b32 v197, -1
    v_mov_b32 v198, -1
    v_mov_b32 v199, -1
    v_mov_b32 v200, -1
    v_mov_b32 v201, -1
    v_mov_b32 v202, -1
    v_mov_b32 v203, -1
    v_mov_b32 v204, -1
    v_mov_b32 v205, -1
    v_mov_b32 v206, -1
    v_mov_b32 v207, -1
    v_mov_b32 v108, -1
    v_mov_b32 v109, -1
    v_mov_b32 v110, -1
    v_mov_b32 v128, 0
    v_mov_b32 v129, 0
    v_mov_b32 v130, 0
    v_mov_b32 v131, 0
    v_mov_b32 v132, 0
    v_mov_b32 v133, 0
    v_mov_b32 v134, 0
    v_mov_b32 v135, 0
    v_cvt_pk_bf16_f32 v140, v112, v113
    v_cvt_pk_bf16_f32 v141, v114, v115
    v_cvt_pk_bf16_f32 v144, v116, v117
    v_cvt_pk_bf16_f32 v145, v118, v119
    v_cvt_pk_bf16_f32 v142, v120, v121
    v_cvt_pk_bf16_f32 v143, v122, v123
    v_cvt_pk_bf16_f32 v146, v124, v125
    v_cvt_pk_bf16_f32 v147, v126, v127
    ds_write_b128 v160, v[140:143] offset:0
    ds_write_b128 v160, v[144:147] offset:1024
    v_sub_u32 v11, v10, v5
    v_sub_u32 v11, 40960, v11
    v_add_u32 v10, v11, v5
    v_add_u32 v160, s72, v5
    s_and_b32 s51, s64, 7
    s_cmp_eq_u32 s51, 0
    s_cbranch_scc1 R_B_s
    s_cmp_ge_u32 s64, 4
    s_cbranch_scc1 PH_54
    s_cmp_ge_u32 s64, 2
    s_cbranch_scc1 PH_55
    v_swap_b32 v226, v228
    v_swap_b32 v227, v229
    v_swap_b32 v234, v236
    v_swap_b32 v235, v237
    v_mfma_f32_16x16x32_bf16 v[208:211], a[160:163], v[224:227], 0
    v_mfma_f32_16x16x32_bf16 v[212:215], a[164:167], v[224:227], 0
    v_mfma_f32_16x16x32_bf16 v[216:219], a[160:163], v[228:231], 0
    v_mfma_f32_16x16x32_bf16 v[220:223], a[164:167], v[228:231], 0
    v_mfma_f32_16x16x32_bf16 v[208:211], a[168:171], v[232:235], v[208:211]
    v_mfma_f32_16x16x32_bf16 v[212:215], a[172:175], v[232:235], v[212:215]
    v_mfma_f32_16x16x32_bf16 v[216:219], a[168:171], v[236:239], v[216:219]
    v_mfma_f32_16x16x32_bf16 v[220:223], a[172:175], v[236:239], v[220:223]
    s_nop 6
    s_branch R_B_s
PH_55:
    s_cmp_ge_u32 s64, 3
    s_cbranch_scc1 PH_56
    v_swap_b32 v226, v228
    v_swap_b32 v227, v229
    v_swap_b32 v234, v236
    v_swap_b32 v235, v237
    v_mfma_f32_16x16x32_bf16 v[208:211], a[176:179], v[224:227], v[208:211]
    v_mfma_f32_16x16x32_bf16 v[212:215], a[180:183], v[224:227], v[212:215]
    v_mfma_f32_16x16x32_bf16 v[216:219], a[176:179], v[228:231], v[216:219]
    v_mfma_f32_16x16x32_bf16 v[220:223], a[180:183], v[228:231], v[220:223]
    v_mfma_f32_16x16x32_bf16 v[208:211], a[184:187], v[232:235], v[208:211]
    v_mfma_f32_16x16x32_bf16 v[212:215], a[188:191], v[232:235], v[212:215]
    v_mfma_f32_16x16x32_bf16 v[216:219], a[184:187], v[236:239], v[216:219]
    v_mfma_f32_16x16x32_bf16 v[220:223], a[188:191], v[236:239], v[220:223]
    s_nop 6
    s_branch R_B_s
PH_56:
    v_swap_b32 v226, v228
    v_swap_b32 v227, v229
    v_swap_b32 v234, v236
    v_swap_b32 v235, v237
    v_mfma_f32_16x16x32_bf16 v[208:211], a[192:195], v[224:227], v[208:211]
    v_mfma_f32_16x16x32_bf16 v[212:215], a[196:199], v[224:227], v[212:215]
    v_mfma_f32_16x16x32_bf16 v[216:219], a[192:195], v[228:231], v[216:219]
    v_mfma_f32_16x16x32_bf16 v[220:223], a[196:199], v[228:231], v[220:223]
    v_mfma_f32_16x16x32_bf16 v[208:211], a[200:203], v[232:235], v[208:211]
    v_mfma_f32_16x16x32_bf16 v[212:215], a[204:207], v[232:235], v[212:215]
    v_mfma_f32_16x16x32_bf16 v[216:219], a[200:203], v[236:239], v[216:219]
    v_mfma_f32_16x16x32_bf16 v[220:223], a[204:207], v[236:239], v[220:223]
    s_nop 6
    s_branch R_B_s
PH_54:
    s_cmp_ge_u32 s64, 6
    s_cbranch_scc1 PH_57
    s_cmp_ge_u32 s64, 5
    s_cbranch_scc1 PH_58
    v_swap_b32 v226, v228
    v_swap_b32 v227, v229
    v_swap_b32 v234, v236
    v_swap_b32 v235, v237
    v_mfma_f32_16x16x32_bf16 v[208:211], a[208:211], v[224:227], v[208:211]
    v_mfma_f32_16x16x32_bf16 v[212:215], a[212:215], v[224:227], v[212:215]
    v_mfma_f32_16x16x32_bf16 v[216:219], a[208:211], v[228:231], v[216:219]
    v_mfma_f32_16x16x32_bf16 v[220:223], a[212:215], v[228:231], v[220:223]
    v_mfma_f32_16x16x32_bf16 v[208:211], a[216:219], v[232:235], v[208:211]
    v_mfma_f32_16x16x32_bf16 v[212:215], a[220:223], v[232:235], v[212:215]
    v_mfma_f32_16x16x32_bf16 v[216:219], a[216:219], v[236:239], v[216:219]
    v_mfma_f32_16x16x32_bf16 v[220:223], a[220:223], v[236:239], v[220:223]
    s_nop 6
    s_branch R_B_s
PH_58:
    v_swap_b32 v226, v228
    v_swap_b32 v227, v229
    v_swap_b32 v234, v236
    v_swap_b32 v235, v237
    v_mfma_f32_16x16x32_bf16 v[208:211], a[224:227], v[224:227], v[208:211]
    v_mfma_f32_16x16x32_bf16 v[212:215], a[228:231], v[224:227], v[212:215]
    v_mfma_f32_16x16x32_bf16 v[216:219], a[224:227], v[228:231], v[216:219]
    v_mfma_f32_16x16x32_bf16 v[220:223], a[228:231], v[228:231], v[220:223]
    v_mfma_f32_16x16x32_bf16 v[208:211], a[232:235], v[232:235], v[208:211]
    v_mfma_f32_16x16x32_bf16 v[212:215], a[236:239], v[232:235], v[212:215]
    v_mfma_f32_16x16x32_bf16 v[216:219], a[232:235], v[236:239], v[216:219]
    v_mfma_f32_16x16x32_bf16 v[220:223], a[236:239], v[236:239], v[220:223]
    s_nop 6
    s_branch R_B_s
PH_57:
    s_cmp_ge_u32 s64, 7
    s_cbranch_scc1 PH_59
    v_swap_b32 v226, v228
    v_swap_b32 v227, v229
    v_swap_b32 v234, v236
    v_swap_b32 v235, v237
    v_mfma_f32_16x16x32_bf16 v[208:211], a[240:243], v[224:227], v[208:211]
    v_mfma_f32_16x16x32_bf16 v[212:215], a[244:247], v[224:227], v[212:215]
    v_mfma_f32_16x16x32_bf16 v[216:219], a[240:243], v[228:231], v[216:219]
    v_mfma_f32_16x16x32_bf16 v[220:223], a[244:247], v[228:231], v[220:223]
    v_mfma_f32_16x16x32_bf16 v[208:211], a[248:251], v[232:235], v[208:211]
    v_mfma_f32_16x16x32_bf16 v[212:215], a[252:255], v[232:235], v[212:215]
    v_mfma_f32_16x16x32_bf16 v[216:219], a[248:251], v[236:239], v[216:219]
    v_mfma_f32_16x16x32_bf16 v[220:223], a[252:255], v[236:239], v[220:223]
    s_nop 4
    ds_write_b128 v168, v[208:211] offset:0
    ds_write_b128 v168, v[212:215] offset:1024
    ds_write_b128 v168, v[216:219] offset:2048
    ds_write_b128 v168, v[220:223] offset:3072
    s_branch R_B_s
PH_59:
    ds_read_b128 v[32:35], v169 offset:0
    ds_read_b128 v[36:39], v169 offset:4096
    ds_read_b128 v[40:43], v169 offset:8192
    ds_read_b128 v[44:47], v169 offset:12288
    v_pk_add_f32 v[72:73], v[72:73], v[76:77]
    v_pk_add_f32 v[74:75], v[74:75], v[78:79]
    s_waitcnt lgkmcnt(0)
    v_pk_add_f32 v[32:33], v[32:33], v[40:41]
    v_pk_add_f32 v[34:35], v[34:35], v[42:43]
    v_pk_add_f32 v[36:37], v[36:37], v[44:45]
    v_pk_add_f32 v[38:39], v[38:39], v[46:47]
    v_pk_add_f32 v[32:33], v[32:33], v[36:37]
    v_pk_add_f32 v[34:35], v[34:35], v[38:39]
    v_cvt_pk_bf16_f32 v11, v32, v33
    v_lshlrev_b32 v32, 16, v11
    v_and_b32 v33, 0xffff0000, v11
    v_pk_add_f32 v[32:33], v[32:33], v[172:173]
    v_cvt_pk_bf16_f32 v11, v32, v33
    v_lshlrev_b32 v32, 16, v11
    v_and_b32 v33, 0xffff0000, v11
    v_mul_f32 v11, 0xbfb8aa3b, v32
    v_mul_f32 v12, 0xbfb8aa3b, v33
    v_exp_f32 v11, v11
    v_exp_f32 v12, v12
    v_add_f32 v11, 1.0, v11
    v_add_f32 v12, 1.0, v12
    v_rcp_f32 v11, v11
    v_rcp_f32 v12, v12
    v_mul_f32 v32, v32, v11
    v_mul_f32 v33, v33, v12
    v_cvt_pk_bf16_f32 v11, v32, v33
    v_lshlrev_b32 v32, 16, v11
    v_and_b32 v33, 0xffff0000, v11
    v_cvt_pk_bf16_f32 v11, v72, v73
    v_lshlrev_b32 v72, 16, v11
    v_and_b32 v73, 0xffff0000, v11
    v_pk_mul_f32 v[72:73], v[72:73], v[32:33]
    v_cvt_pk_bf16_f32 v11, v72, v73
    v_lshlrev_b32 v72, 16, v11
    v_and_b32 v73, 0xffff0000, v11
    v_lshlrev_b32 v11, 16, v104
    v_and_b32 v12, 0xffff0000, v104
    v_add_f32 v72, v72, v11
    v_add_f32 v73, v73, v12
    v_cvt_pk_bf16_f32 v106, v72, v73
    v_cvt_pk_bf16_f32 v11, v34, v35
    v_lshlrev_b32 v34, 16, v11
    v_and_b32 v35, 0xffff0000, v11
    v_pk_add_f32 v[34:35], v[34:35], v[174:175]
    v_cvt_pk_bf16_f32 v11, v34, v35
    v_lshlrev_b32 v34, 16, v11
    v_and_b32 v35, 0xffff0000, v11
    v_mul_f32 v11, 0xbfb8aa3b, v34
    v_mul_f32 v12, 0xbfb8aa3b, v35
    v_exp_f32 v11, v11
    v_exp_f32 v12, v12
    v_add_f32 v11, 1.0, v11
    v_add_f32 v12, 1.0, v12
    v_rcp_f32 v11, v11
    v_rcp_f32 v12, v12
    v_mul_f32 v34, v34, v11
    v_mul_f32 v35, v35, v12
    v_cvt_pk_bf16_f32 v11, v34, v35
    v_lshlrev_b32 v34, 16, v11
    v_and_b32 v35, 0xffff0000, v11
    v_cvt_pk_bf16_f32 v11, v74, v75
    v_lshlrev_b32 v74, 16, v11
    v_and_b32 v75, 0xffff0000, v11
    v_pk_mul_f32 v[74:75], v[74:75], v[34:35]
    v_cvt_pk_bf16_f32 v11, v74, v75
    v_lshlrev_b32 v74, 16, v11
    v_and_b32 v75, 0xffff0000, v11
    v_lshlrev_b32 v11, 16, v105
    v_and_b32 v12, 0xffff0000, v105
    v_add_f32 v74, v74, v11
    v_add_f32 v75, v75, v12
    v_cvt_pk_bf16_f32 v107, v74, v75
    buffer_store_dwordx2 v[106:107], v170, s[36:39], s83 offen
    s_add_u32 s83, s83, 327680
    s_add_u32 s82, s82, 655360
    s_add_u32 s81, s81, 786432
R_B_s:
R_J_s:
    s_waitcnt vmcnt(0)
    buffer_load_dwordx4 v[16:19], v6, s[4:7], s66 offen offset:0 sc1
    buffer_load_dwordx4 v[20:23], v7, s[4:7], s66 offen offset:0 sc1
    buffer_load_dwordx4 v[24:27], v8, s[4:7], s66 offen offset:0 sc1
    s_mov_b64 exec, s[54:55]
    buffer_load_dwordx4 v[224:227], v5, s[4:7], s99 offen offset:0
    buffer_load_dwordx4 v[228:231], v5, s[4:7], s99 offen offset:1024
    buffer_load_dwordx4 v[232:235], v5, s[4:7], s99 offen offset:2048
    buffer_load_dwordx4 v[236:239], v5, s[4:7], s99 offen offset:3072
    s_mov_b64 exec, s[56:57]
    buffer_load_dwordx4 v[80:83], v5, s[4:7], s44 offen
    s_add_u32 s44, s44, 5242880
    buffer_load_dwordx4 v[84:87], v5, s[4:7], s44 offen
    s_mov_b64 exec, -1
    s_branch R_loop_s
R_last:
    v_mov_b32 v88, 0
    v_mov_b32 v89, 0
    v_mov_b32 v90, 0
    v_mov_b32 v91, 0
    s_cmp_lt_u32 s42, 2
    s_cbranch_scc1 R_l1
    buffer_store_dwordx4 v[88:91], v155, s[4:7], s68 offen offset:0 sc1
    s_waitcnt vmcnt(0)
    s_mov_b32 s47, 0
P_60:
    buffer_load_dwordx4 v[176:179], v156, s[4:7], s70 offen offset:0 sc1
    buffer_load_dwordx4 v[180:183], v156, s[4:7], s70 offen offset:2048 sc1
    buffer_load_dwordx4 v[184:187], v157, s[4:7], s70 offen offset:0 sc1
    buffer_load_dwordx4 v[188:191], v157, s[4:7], s70 offen offset:2048 sc1
    s_add_u32 s47, s47, 1
    s_cmp_gt_u32 s47, s46
    s_waitcnt vmcnt(0)
    v_max3_u32 v11, v176, v177, v178
    v_max3_u32 v11, v11, v179, v180
    v_max3_u32 v11, v11, v181, v182
    v_max3_u32 v11, v11, v183, v184
    v_max3_u32 v11, v11, v185, v186
    v_max3_u32 v11, v11, v187, v188
    v_max3_u32 v11, v11, v189, v190
    v_max_u32 v11, v11, v191
    v_cmp_eq_u32 vcc, -1, v11
    s_cbranch_vccz Po_62
    s_cbranch_scc0 P_60
    s_mov_b32 s46, 0
Po_62:
    s_branch R_l2
R_l1:
    s_waitcnt vmcnt(0)
    ds_read_b128 v[32:35], v162 offset:0
    ds_read_b128 v[36:39], v162 offset:1024
    ds_read_b128 v[40:43], v162 offset:3072
    ds_read_b128 v[44:47], v162 offset:4096
    ds_read_b128 v[48:51], v162 offset:6144
    ds_read_b128 v[52:55], v162 offset:7168
    ds_read_b128 v[56:59], v162 offset:9216
    ds_read_b128 v[60:63], v162 offset:10240
    ds_read_b64 v[64:65], v163 offset:2048
    ds_read_b64 v[66:67], v163 offset:2560
    ds_read_b64 v[68:69], v163 offset:5120
    ds_read_b64 v[70:71], v163 offset:5632
    ds_read_b64 v[16:17], v163 offset:8192
    ds_read_b64 v[18:19], v163 offset:8704
    ds_read_b64 v[20:21], v163 offset:11264
    ds_read_b64 v[22:23], v163 offset:11776
    s_mov_b32 s47, 0
P_63:
    buffer_load_dwordx4 v[176:179], v5, s[4:7], s73 offen offset:0 sc1
    buffer_load_dwordx4 v[180:183], v5, s[4:7], s73 offen offset:1024 sc1
    buffer_load_dwordx4 v[184:187], v5, s[4:7], s73 offen offset:2048 sc1
    buffer_load_dwordx4 v[188:191], v5, s[4:7], s73 offen offset:3072 sc1
    buffer_load_dwordx4 v[192:195], v159, s[4:7], s73 offen offset:0 sc1
    s_add_u32 s47, s47, 1
    s_cmp_gt_u32 s47, s46
    s_waitcnt vmcnt(0)
    v_max3_u32 v11, v176, v177, v178
    v_max3_u32 v11, v11, v179, v180
    v_max3_u32 v11, v11, v181, v182
    v_max3_u32 v11, v11, v183, v184
    v_max3_u32 v11, v11, v185, v186
    v_max3_u32 v11, v11, v187, v188
    v_max3_u32 v11, v11, v189, v190
    v_max3_u32 v11, v11, v191, v192
    v_max3_u32 v11, v11, v193, v194
    v_max_u32 v11, v11, v195
    v_cmp_eq_u32 vcc, -1, v11
    s_cbranch_vccz Po_65
    s_cbranch_scc0 P_63
    s_mov_b32 s46, 0
Po_65:
    v_mov_b32 v88, v192
    v_mov_b32 v89, v192
    v_mov_b32 v90, v193
    v_mov_b32 v91, v193
    v_mov_b32 v92, v194
    v_mov_b32 v93, v194
    v_mov_b32 v94, v195
    v_mov_b32 v95, v195
    s_waitcnt lgkmcnt(0)
    v_mfma_f32_16x16x32_bf16 v[128:131], v[32:35], v[176:179], 0
    v_mfma_f32_16x16x32_bf16 v[132:135], v[36:39], v[176:179], 0
    v_mfma_f32_16x16x32_bf16 v[128:131], v[40:43], v[180:183], v[128:131]
    v_mfma_f32_16x16x32_bf16 v[132:135], v[44:47], v[180:183], v[132:135]
    v_mfma_f32_16x16x32_bf16 v[128:131], v[48:51], v[184:187], v[128:131]
    v_mfma_f32_16x16x32_bf16 v[132:135], v[52:55], v[184:187], v[132:135]
    v_mfma_f32_16x16x32_bf16 v[128:131], v[56:59], v[188:191], v[128:131]
    v_mfma_f32_16x16x32_bf16 v[132:135], v[60:63], v[188:191], v[132:135]
    v_mfma_f32_16x16x16_bf16 v[128:131], v[64:65], v[88:89], v[128:131]
    v_mfma_f32_16x16x16_bf16 v[132:135], v[66:67], v[88:89], v[132:135]
    v_mfma_f32_16x16x16_bf16 v[128:131], v[68:69], v[90:91], v[128:131]
    v_mfma_f32_16x16x16_bf16 v[132:135], v[70:71], v[90:91], v[132:135]
    v_mfma_f32_16x16x16_bf16 v[128:131], v[16:17], v[92:93], v[128:131]
    v_mfma_f32_16x16x16_bf16 v[132:135], v[18:19], v[92:93], v[132:135]
    v_mfma_f32_16x16x16_bf16 v[128:131], v[20:21], v[94:95], v[128:131]
    v_mfma_f32_16x16x16_bf16 v[132:135], v[22:23], v[94:95], v[132:135]
    s_nop 6
    buffer_store_dwordx4 v[128:131], v5, s[4:7], s76 offen offset:0 sc1
    buffer_store_dwordx4 v[132:135], v5, s[4:7], s76 offen offset:1024 sc1
    s_add_u32 s76, s76, 81920
R_l2:
    s_mov_b32 s64, s80
    v_add_f32 v72, v72, v80
    v_cndmask_b32 v72, v72, 0, s[58:59]
    v_add_f32 v73, v73, v81
    v_cndmask_b32 v73, v73, 0, s[58:59]
    v_add_f32 v74, v74, v82
    v_cndmask_b32 v74, v74, 0, s[58:59]
    v_add_f32 v75, v75, v83
    v_cndmask_b32 v75, v75, 0, s[58:59]
    v_add_f32 v76, v76, v84
    v_cndmask_b32 v76, v76, 0, s[58:59]
    v_add_f32 v77, v77, v85
    v_cndmask_b32 v77, v77, 0, s[58:59]
    v_add_f32 v78, v78, v86
    v_cndmask_b32 v78, v78, 0, s[58:59]
    v_add_f32 v79, v79, v87
    v_cndmask_b32 v79, v79, 0, s[58:59]
    s_and_b32 s51, s64, 7
    s_cmp_eq_u32 s51, 0
    s_cbranch_scc1 R_B_l
    s_cmp_ge_u32 s64, 4
    s_cbranch_scc1 PH_66
    s_cmp_ge_u32 s64, 2
    s_cbranch_scc1 PH_67
    v_swap_b32 v226, v228
    v_swap_b32 v227, v229
    v_swap_b32 v234, v236
    v_swap_b32 v235, v237
    v_mfma_f32_16x16x32_bf16 v[208:211], a[160:163], v[224:227], 0
    v_mfma_f32_16x16x32_bf16 v[212:215], a[164:167], v[224:227], 0
    v_mfma_f32_16x16x32_bf16 v[216:219], a[160:163], v[228:231], 0
    v_mfma_f32_16x16x32_bf16 v[220:223], a[164:167], v[228:231], 0
    v_mfma_f32_16x16x32_bf16 v[208:211], a[168:171], v[232:235], v[208:211]
    v_mfma_f32_16x16x32_bf16 v[212:215], a[172:175], v[232:235], v[212:215]
    v_mfma_f32_16x16x32_bf16 v[216:219], a[168:171], v[236:239], v[216:219]
    v_mfma_f32_16x16x32_bf16 v[220:223], a[172:175], v[236:239], v[220:223]
    s_nop 6
    s_branch R_B_l
PH_67:
    s_cmp_ge_u32 s64, 3
    s_cbranch_scc1 PH_68
    v_swap_b32 v226, v228
    v_swap_b32 v227, v229
    v_swap_b32 v234, v236
    v_swap_b32 v235, v237
    v_mfma_f32_16x16x32_bf16 v[208:211], a[176:179], v[224:227], v[208:211]
    v_mfma_f32_16x16x32_bf16 v[212:215], a[180:183], v[224:227], v[212:215]
    v_mfma_f32_16x16x32_bf16 v[216:219], a[176:179], v[228:231], v[216:219]
    v_mfma_f32_16x16x32_bf16 v[220:223], a[180:183], v[228:231], v[220:223]
    v_mfma_f32_16x16x32_bf16 v[208:211], a[184:187], v[232:235], v[208:211]
    v_mfma_f32_16x16x32_bf16 v[212:215], a[188:191], v[232:235], v[212:215]
    v_mfma_f32_16x16x32_bf16 v[216:219], a[184:187], v[236:239], v[216:219]
    v_mfma_f32_16x16x32_bf16 v[220:223], a[188:191], v[236:239], v[220:223]
    s_nop 6
    s_branch R_B_l
PH_68:
    v_swap_b32 v226, v228
    v_swap_b32 v227, v229
    v_swap_b32 v234, v236
    v_swap_b32 v235, v237
    v_mfma_f32_16x16x32_bf16 v[208:211], a[192:195], v[224:227], v[208:211]
    v_mfma_f32_16x16x32_bf16 v[212:215], a[196:199], v[224:227], v[212:215]
    v_mfma_f32_16x16x32_bf16 v[216:219], a[192:195], v[228:231], v[216:219]
    v_mfma_f32_16x16x32_bf16 v[220:223], a[196:199], v[228:231], v[220:223]
    v_mfma_f32_16x16x32_bf16 v[208:211], a[200:203], v[232:235], v[208:211]
    v_mfma_f32_16x16x32_bf16 v[212:215], a[204:207], v[232:235], v[212:215]
    v_mfma_f32_16x16x32_bf16 v[216:219], a[200:203], v[236:239], v[216:219]
    v_mfma_f32_16x16x32_bf16 v[220:223], a[204:207], v[236:239], v[220:223]
    s_nop 6
    s_branch R_B_l
PH_66:
    s_cmp_ge_u32 s64, 6
    s_cbranch_scc1 PH_69
    s_cmp_ge_u32 s64, 5
    s_cbranch_scc1 PH_70
    v_swap_b32 v226, v228
    v_swap_b32 v227, v229
    v_swap_b32 v234, v236
    v_swap_b32 v235, v237
    v_mfma_f32_16x16x32_bf16 v[208:211], a[208:211], v[224:227], v[208:211]
    v_mfma_f32_16x16x32_bf16 v[212:215], a[212:215], v[224:227], v[212:215]
    v_mfma_f32_16x16x32_bf16 v[216:219], a[208:211], v[228:231], v[216:219]
    v_mfma_f32_16x16x32_bf16 v[220:223], a[212:215], v[228:231], v[220:223]
    v_mfma_f32_16x16x32_bf16 v[208:211], a[216:219], v[232:235], v[208:211]
    v_mfma_f32_16x16x32_bf16 v[212:215], a[220:223], v[232:235], v[212:215]
    v_mfma_f32_16x16x32_bf16 v[216:219], a[216:219], v[236:239], v[216:219]
    v_mfma_f32_16x16x32_bf16 v[220:223], a[220:223], v[236:239], v[220:223]
    s_nop 6
    s_branch R_B_l
PH_70:
    v_swap_b32 v226, v228
    v_swap_b32 v227, v229
    v_swap_b32 v234, v236
    v_swap_b32 v235, v237
    v_mfma_f32_16x16x32_bf16 v[208:211], a[224:227], v[224:227], v[208:211]
    v_mfma_f32_16x16x32_bf16 v[212:215], a[228:231], v[224:227], v[212:215]
    v_mfma_f32_16x16x32_bf16 v[216:219], a[224:227], v[228:231], v[216:219]
    v_mfma_f32_16x16x32_bf16 v[220:223], a[228:231], v[228:231], v[220:223]
    v_mfma_f32_16x16x32_bf16 v[208:211], a[232:235], v[232:235], v[208:211]
    v_mfma_f32_16x16x32_bf16 v[212:215], a[236:239], v[232:235], v[212:215]
    v_mfma_f32_16x16x32_bf16 v[216:219], a[232:235], v[236:239], v[216:219]
    v_mfma_f32_16x16x32_bf16 v[220:223], a[236:239], v[236:239], v[220:223]
    s_nop 6
    s_branch R_B_l
PH_69:
    s_cmp_ge_u32 s64, 7
    s_cbranch_scc1 PH_71
    v_swap_b32 v226, v228
    v_swap_b32 v227, v229
    v_swap_b32 v234, v236
    v_swap_b32 v235, v237
    v_mfma_f32_16x16x32_bf16 v[208:211], a[240:243], v[224:227], v[208:211]
    v_mfma_f32_16x16x32_bf16 v[212:215], a[244:247], v[224:227], v[212:215]
    v_mfma_f32_16x16x32_bf16 v[216:219], a[240:243], v[228:231], v[216:219]
    v_mfma_f32_16x16x32_bf16 v[220:223], a[244:247], v[228:231], v[220:223]
    v_mfma_f32_16x16x32_bf16 v[208:211], a[248:251], v[232:235], v[208:211]
    v_mfma_f32_16x16x32_bf16 v[212:215], a[252:255], v[232:235], v[212:215]
    v_mfma_f32_16x16x32_bf16 v[216:219], a[248:251], v[236:239], v[216:219]
    v_mfma_f32_16x16x32_bf16 v[220:223], a[252:255], v[236:239], v[220:223]
    s_nop 4
    ds_write_b128 v168, v[208:211] offset:0
    ds_write_b128 v168, v[212:215] offset:1024
    ds_write_b128 v168, v[216:219] offset:2048
    ds_write_b128 v168, v[220:223] offset:3072
    s_branch R_B_l
PH_71:
    ds_read_b128 v[32:35], v169 offset:0
    ds_read_b128 v[36:39], v169 offset:4096
    ds_read_b128 v[40:43], v169 offset:8192
    ds_read_b128 v[44:47], v169 offset:12288
    v_pk_add_f32 v[72:73], v[72:73], v[76:77]
    v_pk_add_f32 v[74:75], v[74:75], v[78:79]
    s_waitcnt lgkmcnt(0)
    v_pk_add_f32 v[32:33], v[32:33], v[40:41]
    v_pk_add_f32 v[34:35], v[34:35], v[42:43]
    v_pk_add_f32 v[36:37], v[36:37], v[44:45]
    v_pk_add_f32 v[38:39], v[38:39], v[46:47]
    v_pk_add_f32 v[32:33], v[32:33], v[36:37]
    v_pk_add_f32 v[34:35], v[34:35], v[38:39]
    v_cvt_pk_bf16_f32 v11, v32, v33
    v_lshlrev_b32 v32, 16, v11
    v_and_b32 v33, 0xffff0000, v11
    v_pk_add_f32 v[32:33], v[32:33], v[172:173]
    v_cvt_pk_bf16_f32 v11, v32, v33
    v_lshlrev_b32 v32, 16, v11
    v_and_b32 v33, 0xffff0000, v11
    v_mul_f32 v11, 0xbfb8aa3b, v32
    v_mul_f32 v12, 0xbfb8aa3b, v33
    v_exp_f32 v11, v11
    v_exp_f32 v12, v12
    v_add_f32 v11, 1.0, v11
    v_add_f32 v12, 1.0, v12
    v_rcp_f32 v11, v11
    v_rcp_f32 v12, v12
    v_mul_f32 v32, v32, v11
    v_mul_f32 v33, v33, v12
    v_cvt_pk_bf16_f32 v11, v32, v33
    v_lshlrev_b32 v32, 16, v11
    v_and_b32 v33, 0xffff0000, v11
    v_cvt_pk_bf16_f32 v11, v72, v73
    v_lshlrev_b32 v72, 16, v11
    v_and_b32 v73, 0xffff0000, v11
    v_pk_mul_f32 v[72:73], v[72:73], v[32:33]
    v_cvt_pk_bf16_f32 v11, v72, v73
    v_lshlrev_b32 v72, 16, v11
    v_and_b32 v73, 0xffff0000, v11
    v_lshlrev_b32 v11, 16, v104
    v_and_b32 v12, 0xffff0000, v104
    v_add_f32 v72, v72, v11
    v_add_f32 v73, v73, v12
    v_cvt_pk_bf16_f32 v106, v72, v73
    v_cvt_pk_bf16_f32 v11, v34, v35
    v_lshlrev_b32 v34, 16, v11
    v_and_b32 v35, 0xffff0000, v11
    v_pk_add_f32 v[34:35], v[34:35], v[174:175]
    v_cvt_pk_bf16_f32 v11, v34, v35
    v_lshlrev_b32 v34, 16, v11
    v_and_b32 v35, 0xffff0000, v11
    v_mul_f32 v11, 0xbfb8aa3b, v34
    v_mul_f32 v12, 0xbfb8aa3b, v35
    v_exp_f32 v11, v11
    v_exp_f32 v12, v12
    v_add_f32 v11, 1.0, v11
    v_add_f32 v12, 1.0, v12
    v_rcp_f32 v11, v11
    v_rcp_f32 v12, v12
    v_mul_f32 v34, v34, v11
    v_mul_f32 v35, v35, v12
    v_cvt_pk_bf16_f32 v11, v34, v35
    v_lshlrev_b32 v34, 16, v11
    v_and_b32 v35, 0xffff0000, v11
    v_cvt_pk_bf16_f32 v11, v74, v75
    v_lshlrev_b32 v74, 16, v11
    v_and_b32 v75, 0xffff0000, v11
    v_pk_mul_f32 v[74:75], v[74:75], v[34:35]
    v_cvt_pk_bf16_f32 v11, v74, v75
    v_lshlrev_b32 v74, 16, v11
    v_and_b32 v75, 0xffff0000, v11
    v_lshlrev_b32 v11, 16, v105
    v_and_b32 v12, 0xffff0000, v105
    v_add_f32 v74, v74, v11
    v_add_f32 v75, v75, v12
    v_cvt_pk_bf16_f32 v107, v74, v75
    buffer_store_dwordx2 v[106:107], v170, s[36:39], s83 offen
    s_add_u32 s83, s83, 327680
    s_add_u32 s82, s82, 655360
    s_add_u32 s81, s81, 786432
R_B_l:
    s_add_u32 s43, s43, 1
    s_mov_b32 s51, s79
    s_mov_b32 s79, s77
    s_mov_b32 s77, s78
    s_mov_b32 s78, s51
    s_add_u32 s84, s43, 3
    s_and_b32 s84, s84, 3
    s_add_u32 s85, s43, 4
    s_and_b32 s85, s85, 3
    s_add_u32 s86, s43, 5
    s_and_b32 s86, s86, 3
    s_add_u32 s87, s43, 6
    s_and_b32 s87, s87, 3
    s_mul_i32 s67, s84, 122880
    s_add_u32 s67, s67, s61
    s_mul_i32 s68, s84, 327680
    s_add_u32 s68, s68, s62
    s_mul_i32 s69, s86, 327680
    s_add_u32 s69, s69, s62
    s_mul_i32 s70, s84, 327680
    s_add_u32 s70, s70, s63
    s_mul_i32 s71, s85, 81920
    s_add_u32 s71, s71, s60
    s_mul_i32 s73, s87, 81920
    s_add_u32 s73, s73, s65
    s_sub_u32 s51, s43, s40
    s_sub_u32 s51, s51, 2
    s_and_b32 s80, s51, 7
    s_cmp_lt_u32 s51, 56
    s_cselect_b32 s80, s80, 8
    s_sub_u32 s51, s80, 1
    s_cmp_lt_u32 s51, 6
    s_cselect_b64 s[54:55], -1, 0
    s_and_b32 s51, s51, 7
    s_lshl_b32 s51, s51, 12
    s_add_u32 s99, s81, s51
    s_sub_u32 s51, s80, 4
    s_cmp_lt_u32 s51, 4
    s_cselect_b64 s[56:57], -1, 0
    s_cmp_eq_u32 s51, 0
    s_cselect_b64 s[58:59], -1, 0
    s_and_b32 s51, s51, 3
    s_mul_i32 s51, s51, 10485760
    s_add_u32 s44, s82, s51
    s_mul_i32 s51, s42, 3072
    s_add_u32 s72, s51, s78
    s_add_u32 s52, s51, s77
    v_add_u32 v161, s52, v167
    v_add_u32 v162, s79, v5
    v_add_u32 v163, s79, v167
    s_waitcnt lgkmcnt(0)
    s_barrier
    s_cmp_gt_u32 s42, 1
    s_cbranch_scc1 R_t1
    ds_read_b128 v[32:35], v162 offset:0
    ds_read_b128 v[36:39], v162 offset:1024
    ds_read_b128 v[40:43], v162 offset:3072
    ds_read_b128 v[44:47], v162 offset:4096
    ds_read_b128 v[48:51], v162 offset:6144
    ds_read_b128 v[52:55], v162 offset:7168
    ds_read_b128 v[56:59], v162 offset:9216
    ds_read_b128 v[60:63], v162 offset:10240
    ds_read_b64 v[64:65], v163 offset:2048
    ds_read_b64 v[66:67], v163 offset:2560
    ds_read_b64 v[68:69], v163 offset:5120
    ds_read_b64 v[70:71], v163 offset:5632
    ds_read_b64 v[16:17], v163 offset:8192
    ds_read_b64 v[18:19], v163 offset:8704
    ds_read_b64 v[20:21], v163 offset:11264
    ds_read_b64 v[22:23], v163 offset:11776
    s_mov_b32 s47, 0
P_72:
    buffer_load_dwordx4 v[176:179], v5, s[4:7], s73 offen offset:0 sc1
    buffer_load_dwordx4 v[180:183], v5, s[4:7], s73 offen offset:1024 sc1
    buffer_load_dwordx4 v[184:187], v5, s[4:7], s73 offen offset:2048 sc1
    buffer_load_dwordx4 v[188:191], v5, s[4:7], s73 offen offset:3072 sc1
    buffer_load_dwordx4 v[192:195], v159, s[4:7], s73 offen offset:0 sc1
    s_add_u32 s47, s47, 1
    s_cmp_gt_u32 s47, s46
    s_waitcnt vmcnt(0)
    v_max3_u32 v11, v176, v177, v178
    v_max3_u32 v11, v11, v179, v180
    v_max3_u32 v11, v11, v181, v182
    v_max3_u32 v11, v11, v183, v184
    v_max3_u32 v11, v11, v185, v186
    v_max3_u32 v11, v11, v187, v188
    v_max3_u32 v11, v11, v189, v190
    v_max3_u32 v11, v11, v191, v192
    v_max3_u32 v11, v11, v193, v194
    v_max_u32 v11, v11, v195
    v_cmp_eq_u32 vcc, -1, v11
    s_cbranch_vccz Po_74
    s_cbranch_scc0 P_72
    s_mov_b32 s46, 0
Po_74:
    v_mov_b32 v88, v192
    v_mov_b32 v89, v192
    v_mov_b32 v90, v193
    v_mov_b32 v91, v193
    v_mov_b32 v92, v194
    v_mov_b32 v93, v194
    v_mov_b32 v94, v195
    v_mov_b32 v95, v195
    s_waitcnt lgkmcnt(0)
    v_mfma_f32_16x16x32_bf16 v[128:131], v[32:35], v[176:179], 0
    v_mfma_f32_16x16x32_bf16 v[132:135], v[36:39], v[176:179], 0
    v_mfma_f32_16x16x32_bf16 v[128:131], v[40:43], v[180:183], v[128:131]
    v_mfma_f32_16x16x32_bf16 v[132:135], v[44:47], v[180:183], v[132:135]
    v_mfma_f32_16x16x32_bf16 v[128:131], v[48:51], v[184:187], v[128:131]
    v_mfma_f32_16x16x32_bf16 v[132:135], v[52:55], v[184:187], v[132:135]
    v_mfma_f32_16x16x32_bf16 v[128:131], v[56:59], v[188:191], v[128:131]
    v_mfma_f32_16x16x32_bf16 v[132:135], v[60:63], v[188:191], v[132:135]
    v_mfma_f32_16x16x16_bf16 v[128:131], v[64:65], v[88:89], v[128:131]
    v_mfma_f32_16x16x16_bf16 v[132:135], v[66:67], v[88:89], v[132:135]
    v_mfma_f32_16x16x16_bf16 v[128:131], v[68:69], v[90:91], v[128:131]
    v_mfma_f32_16x16x16_bf16 v[132:135], v[70:71], v[90:91], v[132:135]
    v_mfma_f32_16x16x16_bf16 v[128:131], v[16:17], v[92:93], v[128:131]
    v_mfma_f32_16x16x16_bf16 v[132:135], v[18:19], v[92:93], v[132:135]
    v_mfma_f32_16x16x16_bf16 v[128:131], v[20:21], v[94:95], v[128:131]
    v_mfma_f32_16x16x16_bf16 v[132:135], v[22:23], v[94:95], v[132:135]
    s_nop 6
    buffer_store_dwordx4 v[128:131], v5, s[4:7], s76 offen offset:0 sc1
    buffer_store_dwordx4 v[132:135], v5, s[4:7], s76 offen offset:1024 sc1
    s_add_u32 s76, s76, 81920
    s_add_u32 s51, s81, 0
    buffer_load_dwordx4 v[32:35], v5, s[4:7], s51 offen offset:0
    buffer_load_dwordx4 v[36:39], v5, s[4:7], s51 offen offset:1024
    buffer_load_dwordx4 v[40:43], v5, s[4:7], s51 offen offset:2048
    buffer_load_dwordx4 v[44:47], v5, s[4:7], s51 offen offset:3072
    s_add_u32 s51, s81, 4096
    buffer_load_dwordx4 v[48:51], v5, s[4:7], s51 offen offset:0
    buffer_load_dwordx4 v[52:55], v5, s[4:7], s51 offen offset:1024
    buffer_load_dwordx4 v[56:59], v5, s[4:7], s51 offen offset:2048
    buffer_load_dwordx4 v[60:63], v5, s[4:7], s51 offen offset:3072
    s_add_u32 s51, s81, 8192
    buffer_load_dwordx4 v[64:67], v5, s[4:7], s51 offen offset:0
    buffer_load_dwordx4 v[68:71], v5, s[4:7], s51 offen offset:1024
    buffer_load_dwordx4 v[72:75], v5, s[4:7], s51 offen offset:2048
    buffer_load_dwordx4 v[76:79], v5, s[4:7], s51 offen offset:3072
    s_add_u32 s51, s81, 12288
    buffer_load_dwordx4 v[80:83], v5, s[4:7], s51 offen offset:0
    buffer_load_dwordx4 v[84:87], v5, s[4:7], s51 offen offset:1024
    buffer_load_dwordx4 v[88:91], v5, s[4:7], s51 offen offset:2048
    buffer_load_dwordx4 v[92:95], v5, s[4:7], s51 offen offset:3072
    s_add_u32 s51, s81, 16384
    buffer_load_dwordx4 v[96:99], v5, s[4:7], s51 offen offset:0
    buffer_load_dwordx4 v[100:103], v5, s[4:7], s51 offen offset:1024
    buffer_load_dwordx4 v[104:107], v5, s[4:7], s51 offen offset:2048
    buffer_load_dwordx4 v[108:111], v5, s[4:7], s51 offen offset:3072
    s_add_u32 s51, s81, 20480
    buffer_load_dwordx4 v[112:115], v5, s[4:7], s51 offen offset:0
    buffer_load_dwordx4 v[116:119], v5, s[4:7], s51 offen offset:1024
    buffer_load_dwordx4 v[120:123], v5, s[4:7], s51 offen offset:2048
    buffer_load_dwordx4 v[124:127], v5, s[4:7], s51 offen offset:3072
    v_mov_b32 v12, 0
    v_mov_b32 v13, 0
    v_and_b32 v14, 127, v0
    v_lshlrev_b32 v14, 3, v14
    v_add_u32 v15, 8192, v14
    s_waitcnt vmcnt(24)
    buffer_store_dwordx2 v[12:13], v14, s[4:7], s68 offen offset:0 sc1
    buffer_store_dwordx2 v[12:13], v15, s[4:7], s68 offen offset:0 sc1
    s_waitcnt vmcnt(2)
    s_branch R_t1b
R_t1:
    s_add_u32 s51, s81, 0
    buffer_load_dwordx4 v[32:35], v5, s[4:7], s51 offen offset:0
    buffer_load_dwordx4 v[36:39], v5, s[4:7], s51 offen offset:1024
    buffer_load_dwordx4 v[40:43], v5, s[4:7], s51 offen offset:2048
    buffer_load_dwordx4 v[44:47], v5, s[4:7], s51 offen offset:3072
    s_add_u32 s51, s81, 4096
    buffer_load_dwordx4 v[48:51], v5, s[4:7], s51 offen offset:0
    buffer_load_dwordx4 v[52:55], v5, s[4:7], s51 offen offset:1024
    buffer_load_dwordx4 v[56:59], v5, s[4:7], s51 offen offset:2048
    buffer_load_dwordx4 v[60:63], v5, s[4:7], s51 offen offset:3072
    s_add_u32 s51, s81, 8192
    buffer_load_dwordx4 v[64:67], v5, s[4:7], s51 offen offset:0
    buffer_load_dwordx4 v[68:71], v5, s[4:7], s51 offen offset:1024
    buffer_load_dwordx4 v[72:75], v5, s[4:7], s51 offen offset:2048
    buffer_load_dwordx4 v[76:79], v5, s[4:7], s51 offen offset:3072
    s_add_u32 s51, s81, 12288
    buffer_load_dwordx4 v[80:83], v5, s[4:7], s51 offen offset:0
    buffer_load_dwordx4 v[84:87], v5, s[4:7], s51 offen offset:1024
    buffer_load_dwordx4 v[88:91], v5, s[4:7], s51 offen offset:2048
    buffer_load_dwordx4 v[92:95], v5, s[4:7], s51 offen offset:3072
    s_add_u32 s51, s81, 16384
    buffer_load_dwordx4 v[96:99], v5, s[4:7], s51 offen offset:0
    buffer_load_dwordx4 v[100:103], v5, s[4:7], s51 offen offset:1024
    buffer_load_dwordx4 v[104:107], v5, s[4:7], s51 offen offset:2048
    buffer_load_dwordx4 v[108:111], v5, s[4:7], s51 offen offset:3072
    s_add_u32 s51, s81, 20480
    buffer_load_dwordx4 v[112:115], v5, s[4:7], s51 offen offset:0
    buffer_load_dwordx4 v[116:119], v5, s[4:7], s51 offen offset:1024
    buffer_load_dwordx4 v[120:123], v5, s[4:7], s51 offen offset:2048
    buffer_load_dwordx4 v[124:127], v5, s[4:7], s51 offen offset:3072
    s_waitcnt vmcnt(0)
R_t1b:
    v_swap_b32 v34, v36
    v_swap_b32 v35, v37
    v_swap_b32 v42, v44
    v_swap_b32 v43, v45
    v_swap_b32 v50, v52
    v_swap_b32 v51, v53
    v_swap_b32 v58, v60
    v_swap_b32 v59, v61
    v_swap_b32 v66, v68
    v_swap_b32 v67, v69
    v_swap_b32 v74, v76
    v_swap_b32 v75, v77
    v_swap_b32 v82, v84
    v_swap_b32 v83, v85
    v_swap_b32 v90, v92
    v_swap_b32 v91, v93
    v_swap_b32 v98, v100
    v_swap_b32 v99, v101
    v_swap_b32 v106, v108
    v_swap_b32 v107, v109
    v_swap_b32 v114, v116
    v_swap_b32 v115, v117
    v_swap_b32 v122, v124
    v_swap_b32 v123, v125
    v_mfma_f32_16x16x32_bf16 v[208:211], a[160:163], v[32:35], 0
    v_mfma_f32_16x16x32_bf16 v[212:215], a[164:167], v[32:35], 0
    v_mfma_f32_16x16x32_bf16 v[216:219], a[160:163], v[36:39], 0
    v_mfma_f32_16x16x32_bf16 v[220:223], a[164:167], v[36:39], 0
    v_mfma_f32_16x16x32_bf16 v[208:211], a[168:171], v[40:43], v[208:211]
    v_mfma_f32_16x16x32_bf16 v[212:215], a[172:175], v[40:43], v[212:215]
    v_mfma_f32_16x16x32_bf16 v[216:219], a[168:171], v[44:47], v[216:219]
    v_mfma_f32_16x16x32_bf16 v[220:223], a[172:175], v[44:47], v[220:223]
    v_mfma_f32_16x16x32_bf16 v[208:211], a[176:179], v[48:51], v[208:211]
    v_mfma_f32_16x16x32_bf16 v[212:215], a[180:183], v[48:51], v[212:215]
    v_mfma_f32_16x16x32_bf16 v[216:219], a[176:179], v[52:55], v[216:219]
    v_mfma_f32_16x16x32_bf16 v[220:223], a[180:183], v[52:55], v[220:223]
    v_mfma_f32_16x16x32_bf16 v[208:211], a[184:187], v[56:59], v[208:211]
    v_mfma_f32_16x16x32_bf16 v[212:215], a[188:191], v[56:59], v[212:215]
    v_mfma_f32_16x16x32_bf16 v[216:219], a[184:187], v[60:63], v[216:219]
    v_mfma_f32_16x16x32_bf16 v[220:223], a[188:191], v[60:63], v[220:223]
    v_mfma_f32_16x16x32_bf16 v[208:211], a[192:195], v[64:67], v[208:211]
    v_mfma_f32_16x16x32_bf16 v[212:215], a[196:199], v[64:67], v[212:215]
    v_mfma_f32_16x16x32_bf16 v[216:219], a[192:195], v[68:71], v[216:219]
    v_mfma_f32_16x16x32_bf16 v[220:223], a[196:199], v[68:71], v[220:223]
    v_mfma_f32_16x16x32_bf16 v[208:211], a[200:203], v[72:75], v[208:211]
    v_mfma_f32_16x16x32_bf16 v[212:215], a[204:207], v[72:75], v[212:215]
    v_mfma_f32_16x16x32_bf16 v[216:219], a[200:203], v[76:79], v[216:219]
    v_mfma_f32_16x16x32_bf16 v[220:223], a[204:207], v[76:79], v[220:223]
    v_mfma_f32_16x16x32_bf16 v[208:211], a[208:211], v[80:83], v[208:211]
    v_mfma_f32_16x16x32_bf16 v[212:215], a[212:215], v[80:83], v[212:215]
    v_mfma_f32_16x16x32_bf16 v[216:219], a[208:211], v[84:87], v[216:219]
    v_mfma_f32_16x16x32_bf16 v[220:223], a[212:215], v[84:87], v[220:223]
    v_mfma_f32_16x16x32_bf16 v[208:211], a[216:219], v[88:91], v[208:211]
    v_mfma_f32_16x16x32_bf16 v[212:215], a[220:223], v[88:91], v[212:215]
    v_mfma_f32_16x16x32_bf16 v[216:219], a[216:219], v[92:95], v[216:219]
    v_mfma_f32_16x16x32_bf16 v[220:223], a[220:223], v[92:95], v[220:223]
    v_mfma_f32_16x16x32_bf16 v[208:211], a[224:227], v[96:99], v[208:211]
    v_mfma_f32_16x16x32_bf16 v[212:215], a[228:231], v[96:99], v[212:215]
    v_mfma_f32_16x16x32_bf16 v[216:219], a[224:227], v[100:103], v[216:219]
    v_mfma_f32_16x16x32_bf16 v[220:223], a[228:231], v[100:103], v[220:223]
    v_mfma_f32_16x16x32_bf16 v[208:211], a[232:235], v[104:107], v[208:211]
    v_mfma_f32_16x16x32_bf16 v[212:215], a[236:239], v[104:107], v[212:215]
    v_mfma_f32_16x16x32_bf16 v[216:219], a[232:235], v[108:111], v[216:219]
    v_mfma_f32_16x16x32_bf16 v[220:223], a[236:239], v[108:111], v[220:223]
    v_mfma_f32_16x16x32_bf16 v[208:211], a[240:243], v[112:115], v[208:211]
    v_mfma_f32_16x16x32_bf16 v[212:215], a[244:247], v[112:115], v[212:215]
    v_mfma_f32_16x16x32_bf16 v[216:219], a[240:243], v[116:119], v[216:219]
    v_mfma_f32_16x16x32_bf16 v[220:223], a[244:247], v[116:119], v[220:223]
    v_mfma_f32_16x16x32_bf16 v[208:211], a[248:251], v[120:123], v[208:211]
    v_mfma_f32_16x16x32_bf16 v[212:215], a[252:255], v[120:123], v[212:215]
    v_mfma_f32_16x16x32_bf16 v[216:219], a[248:251], v[124:127], v[216:219]
    v_mfma_f32_16x16x32_bf16 v[220:223], a[252:255], v[124:127], v[220:223]
    s_nop 4
    ds_write_b128 v168, v[208:211] offset:0
    ds_write_b128 v168, v[212:215] offset:1024
    ds_write_b128 v168, v[216:219] offset:2048
    ds_write_b128 v168, v[220:223] offset:3072
    s_cmp_lt_u32 s42, 2
    s_cbranch_scc1 R_t2
    s_mov_b32 s47, 0
P_75:
    buffer_load_dwordx4 v[176:179], v156, s[4:7], s70 offen offset:0 sc1
    buffer_load_dwordx4 v[180:183], v156, s[4:7], s70 offen offset:2048 sc1
    buffer_load_dwordx4 v[184:187], v157, s[4:7], s70 offen offset:0 sc1
    buffer_load_dwordx4 v[188:191], v157, s[4:7], s70 offen offset:2048 sc1
    s_add_u32 s47, s47, 1
    s_cmp_gt_u32 s47, s46
    s_waitcnt vmcnt(0)
    v_max3_u32 v11, v176, v177, v178
    v_max3_u32 v11, v11, v179, v180
    v_max3_u32 v11, v11, v181, v182
    v_max3_u32 v11, v11, v183, v184
    v_max3_u32 v11, v11, v185, v186
    v_max3_u32 v11, v11, v187, v188
    v_max3_u32 v11, v11, v189, v190
    v_max_u32 v11, v11, v191
    v_cmp_eq_u32 vcc, -1, v11
    s_cbranch_vccz Po_77
    s_cbranch_scc0 P_75
    s_mov_b32 s46, 0
Po_77:
R_t2:
    s_waitcnt lgkmcnt(0)
    s_barrier
    s_mov_b32 s51, s82
    buffer_load_dwordx4 v[72:75], v5, s[4:7], s51 offen
    s_add_u32 s51, s51, 5242880
    buffer_load_dwordx4 v[76:79], v5, s[4:7], s51 offen
    s_add_u32 s51, s51, 5242880
    buffer_load_dwordx4 v[80:83], v5, s[4:7], s51 offen
    s_add_u32 s51, s51, 5242880
    buffer_load_dwordx4 v[84:87], v5, s[4:7], s51 offen
    s_add_u32 s51, s51, 5242880
    buffer_load_dwordx4 v[88:91], v5, s[4:7], s51 offen
    s_add_u32 s51, s51, 5242880
    buffer_load_dwordx4 v[92:95], v5, s[4:7], s51 offen
    s_add_u32 s51, s51, 5242880
    buffer_load_dwordx4 v[96:99], v5, s[4:7], s51 offen
    s_add_u32 s51, s51, 5242880
    buffer_load_dwordx4 v[100:103], v5, s[4:7], s51 offen
    buffer_load_dwordx2 v[104:105], v170, s[28:31], s83 offen
    s_waitcnt vmcnt(0)
    ds_read_b128 v[32:35], v169 offset:0
    ds_read_b128 v[36:39], v169 offset:4096
    ds_read_b128 v[40:43], v169 offset:8192
    ds_read_b128 v[44:47], v169 offset:12288
    v_pk_add_f32 v[72:73], v[72:73], v[88:89]
    v_pk_add_f32 v[74:75], v[74:75], v[90:91]
    v_pk_add_f32 v[76:77], v[76:77], v[92:93]
    v_pk_add_f32 v[78:79], v[78:79], v[94:95]
    v_pk_add_f32 v[80:81], v[80:81], v[96:97]
    v_pk_add_f32 v[82:83], v[82:83], v[98:99]
    v_pk_add_f32 v[84:85], v[84:85], v[100:101]
    v_pk_add_f32 v[86:87], v[86:87], v[102:103]
    v_pk_add_f32 v[72:73], v[72:73], v[80:81]
    v_pk_add_f32 v[74:75], v[74:75], v[82:83]
    v_pk_add_f32 v[76:77], v[76:77], v[84:85]
    v_pk_add_f32 v[78:79], v[78:79], v[86:87]
    v_pk_add_f32 v[72:73], v[72:73], v[76:77]
    v_pk_add_f32 v[74:75], v[74:75], v[78:79]
    s_waitcnt lgkmcnt(0)
    v_pk_add_f32 v[32:33], v[32:33], v[40:41]
    v_pk_add_f32 v[34:35], v[34:35], v[42:43]
    v_pk_add_f32 v[36:37], v[36:37], v[44:45]
    v_pk_add_f32 v[38:39], v[38:39], v[46:47]
    v_pk_add_f32 v[32:33], v[32:33], v[36:37]
    v_pk_add_f32 v[34:35], v[34:35], v[38:39]
    v_cvt_pk_bf16_f32 v11, v32, v33
    v_lshlrev_b32 v32, 16, v11
    v_and_b32 v33, 0xffff0000, v11
    v_pk_add_f32 v[32:33], v[32:33], v[172:173]
    v_cvt_pk_bf16_f32 v11, v32, v33
    v_lshlrev_b32 v32, 16, v11
    v_and_b32 v33, 0xffff0000, v11
    v_mul_f32 v11, 0xbfb8aa3b, v32
    v_mul_f32 v12, 0xbfb8aa3b, v33
    v_exp_f32 v11, v11
    v_exp_f32 v12, v12
    v_add_f32 v11, 1.0, v11
    v_add_f32 v12, 1.0, v12
    v_rcp_f32 v11, v11
    v_rcp_f32 v12, v12
    v_mul_f32 v32, v32, v11
    v_mul_f32 v33, v33, v12
    v_cvt_pk_bf16_f32 v11, v32, v33
    v_lshlrev_b32 v32, 16, v11
    v_and_b32 v33, 0xffff0000, v11
    v_cvt_pk_bf16_f32 v11, v72, v73
    v_lshlrev_b32 v72, 16, v11
    v_and_b32 v73, 0xffff0000, v11
    v_pk_mul_f32 v[72:73], v[72:73], v[32:33]
    v_cvt_pk_bf16_f32 v11, v72, v73
    v_lshlrev_b32 v72, 16, v11
    v_and_b32 v73, 0xffff0000, v11
    v_lshlrev_b32 v11, 16, v104
    v_and_b32 v12, 0xffff0000, v104
    v_add_f32 v72, v72, v11
    v_add_f32 v73, v73, v12
    v_cvt_pk_bf16_f32 v106, v72, v73
    v_cvt_pk_bf16_f32 v11, v34, v35
    v_lshlrev_b32 v34, 16, v11
    v_and_b32 v35, 0xffff0000, v11
    v_pk_add_f32 v[34:35], v[34:35], v[174:175]
    v_cvt_pk_bf16_f32 v11, v34, v35
    v_lshlrev_b32 v34, 16, v11
    v_and_b32 v35, 0xffff0000, v11
    v_mul_f32 v11, 0xbfb8aa3b, v34
    v_mul_f32 v12, 0xbfb8aa3b, v35
    v_exp_f32 v11, v11
    v_exp_f32 v12, v12
    v_add_f32 v11, 1.0, v11
    v_add_f32 v12, 1.0, v12
    v_rcp_f32 v11, v11
    v_rcp_f32 v12, v12
    v_mul_f32 v34, v34, v11
    v_mul_f32 v35, v35, v12
    v_cvt_pk_bf16_f32 v11, v34, v35
    v_lshlrev_b32 v34, 16, v11
    v_and_b32 v35, 0xffff0000, v11
    v_cvt_pk_bf16_f32 v11, v74, v75
    v_lshlrev_b32 v74, 16, v11
    v_and_b32 v75, 0xffff0000, v11
    v_pk_mul_f32 v[74:75], v[74:75], v[34:35]
    v_cvt_pk_bf16_f32 v11, v74, v75
    v_lshlrev_b32 v74, 16, v11
    v_and_b32 v75, 0xffff0000, v11
    v_lshlrev_b32 v11, 16, v105
    v_and_b32 v12, 0xffff0000, v105
    v_add_f32 v74, v74, v11
    v_add_f32 v75, v75, v12
    v_cvt_pk_bf16_f32 v107, v74, v75
    buffer_store_dwordx2 v[106:107], v170, s[36:39], s83 offen
    s_add_u32 s83, s83, 327680
    s_add_u32 s82, s82, 655360
    s_add_u32 s81, s81, 786432
K_end:
    s_endpgm
.section .rodata,"a"
.p2align 6
.amdhsa_kernel recurrent_scan__memory_aug_recurrent_mem_tr__dense_activation_squared_relu__prompt_kernel
  .amdhsa_next_free_vgpr 512
  .amdhsa_next_free_sgpr 102
  .amdhsa_accum_offset 256
  .amdhsa_group_segment_fixed_size 0
  .amdhsa_kernarg_size 120
  .amdhsa_user_sgpr_count 2
  .amdhsa_user_sgpr_kernarg_segment_ptr 1
  .amdhsa_system_sgpr_workgroup_id_x 1
  .amdhsa_float_denorm_mode_32 3
.end_amdhsa_kernel
```
